```python
import torch

def _softmax(x, axis=-1):
    return torch.softmax(x, dim=axis)
def _gelu(x):
    return torch.nn.functional.gelu(x, approximate="tanh")
def _silu(x):
    return torch.nn.functional.silu(x)
def _sigmoid(x):
    return torch.sigmoid(x)
def _layernorm(x, axis=-1, eps=1e-5):
    m = x.mean(dim=axis, keepdim=True)
    v = x.var(dim=axis, keepdim=True, unbiased=False)
    return (x - m) / torch.sqrt(v + eps)
def _scatter_add(tgt, idx, src, axis=0):
    return tgt.clone().index_add_(axis, idx, src)
def _segment_sum(src, seg, n):
    out = torch.zeros((n,) + src.shape[1:], dtype=src.dtype)
    return out.index_add_(0, seg, src)
def _pad(x, pw):
    flat = tuple(v for pair in reversed(pw) for v in pair)
    return torch.nn.functional.pad(x, flat)

kernel_name = 'gated_mix__linear_kernel_hedgehog__mixer_s_mlp__prompt'

def setup_inputs():

    _w = (lambda a: (lambda t: t.to(torch.bfloat16) if t.is_floating_point() else t)(torch.as_tensor(a)))
    def _A_setup():
        B, S, D, H = 1, 2048, 640, 32
        Dh = D // H
        return {
            "x": _w((lambda *s: torch.randn(*s, dtype=torch.bfloat16) * 0.05)(B, S, D)),
            "wqkv": _w((lambda *s: torch.randn(*s, dtype=torch.bfloat16) * 3.2)(D, 3 * D)),
            "w_phi": _w((lambda *s: torch.randn(*s, dtype=torch.bfloat16) * 3.2)(H, Dh, Dh) * (Dh ** -0.5)),
            "wo": _w((lambda *s: torch.randn(*s, dtype=torch.bfloat16) * 1.6)(D, D)),
        }
    _A_in = _A_setup()

    def _B_setup():
        B, S, D, F = 1, 2048, 640, 1536
        return {
            "x":  _w((lambda *s: torch.randn(*s, dtype=torch.bfloat16) * 0.05)(B, S, D)),
            "w1": _w((lambda *s: torch.randn(*s, dtype=torch.bfloat16) * 3.2)(D, D) * (D ** -0.5)),
            "w2": _w((lambda *s: torch.randn(*s, dtype=torch.bfloat16) * 3.2)(D, D) * (D ** -0.5)),
            "w3": _w((lambda *s: torch.randn(*s, dtype=torch.bfloat16) * 3.2)(D, F) * (D ** -0.5)),
            "w4": _w((lambda *s: torch.randn(*s, dtype=torch.bfloat16) * 3.2)(F, D) * (F ** -0.5)),
        }
    _B_in = _B_setup()

    return {
        "A_x": _A_in["x"],
        "A_wqkv": _A_in["wqkv"],
        "A_w_phi": _A_in["w_phi"],
        "A_wo": _A_in["wo"],
        "B_x": _B_in["x"],
        "B_w1": _B_in["w1"],
        "B_w2": _B_in["w2"],
        "B_w3": _B_in["w3"],
        "B_w4": _B_in["w4"],
        "gate_w": _w((lambda *s: torch.randn(*s, dtype=torch.bfloat16) * 0.05)(640) * 16.0),
    }

def reference(A_x, A_wqkv, A_w_phi, A_wo, B_x, B_w1, B_w2, B_w3, B_w4, gate_w):
    def _A_ref(x, wqkv, w_phi, wo):
        B, S, D = x.shape
        H = 32; Dh = D // H
        qkv = (lambda x, *d: x.permute(*d))((x @ wqkv).reshape(B, S, 3, H, Dh), 2, 0, 3, 1, 4)
        q, k, v = qkv[0], qkv[1], qkv[2]
        pq = torch.einsum("bhsd,hdf->bhsf", q, w_phi)
        pk = torch.einsum("bhsd,hdf->bhsf", k, w_phi)
        phi_q = torch.concatenate([_softmax(pq, axis=-1), _softmax(-pq, axis=-1)], axis=-1)
        phi_k = torch.concatenate([_softmax(pk, axis=-1), _softmax(-pk, axis=-1)], axis=-1)
        kv = torch.einsum("bhsf,bhsd->bhfd", phi_k, v)
        z  = torch.einsum("bhsf->bhf", phi_k)
        num = torch.einsum("bhqf,bhfd->bhqd", phi_q, kv)
        den = torch.einsum("bhqf,bhf->bhq", phi_q, z)[..., None] + 1e-6
        o = num / den
        return (lambda x, *d: x.permute(*d))(o, 0, 2, 1, 3).reshape(B, S, D) @ wo

    def _B_ref(x, w1, w2, w3, w4):
        B, S, D = x.shape
        h = _gelu(_layernorm(x, axis=-1) @ w1)
        c = D // 4
        g0 = _pad(h[:, :, 0*c:1*c], ((0, 0), (1, 0), (0, 0)))[:, :S, :]
        g1 = _pad(h[:, :, 1*c:2*c], ((0, 0), (0, 1), (0, 0)))[:, 1:, :]
        g2 = _pad(h[:, :, 2*c:3*c], ((0, 0), (2, 0), (0, 0)))[:, :S, :]
        g3 = _pad(h[:, :, 3*c:   ], ((0, 0), (0, 2), (0, 0)))[:, 2:, :]
        hs = torch.concatenate([g0, g1, g2, g3], axis=-1) @ w2
        x1 = x + hs
        h2 = _gelu(_layernorm(x1, axis=-1) @ w3) @ w4
        return x1 + h2

    x = A_x
    g = _sigmoid((x * gate_w).sum(-1, keepdims=True))
    a = _A_ref(x, A_wqkv, A_w_phi, A_wo)
    b = _B_ref(x, B_w1, B_w2, B_w3, B_w4)
    return g * a + (1 - g) * b
```

```asm
; @launch grid=(256,1,1) block=(256,1,1) lds=163840
.amdgcn_target "amdgcn-amd-amdhsa--gfx950"
.text
.globl gated_mix__linear_kernel_hedgehog__mixer_s_mlp__prompt_kernel
.p2align 8
.type gated_mix__linear_kernel_hedgehog__mixer_s_mlp__prompt_kernel,@function
gated_mix__linear_kernel_hedgehog__mixer_s_mlp__prompt_kernel:
    s_cmp_ge_u32 s2, 256
    s_cbranch_scc1 Lend
    s_load_dwordx16 s[16:31], s[0:1], 0
    s_load_dwordx8 s[32:39], s[0:1], 64
    s_load_dwordx2 s[40:41], s[0:1], 96
    s_getpc_b64 s[64:65]
    s_lshr_b32 s48, s2, 3
    s_lshl_b32 s48, s48, 8
    v_add_u32 v1, s48, v0
    v_and_b32 v1, 0xffffffc3, v1
    v_lshrrev_b32 v2, 6, v1
    v_and_b32 v1, 3, v1
    v_mad_u32_u24 v1, v2, 4, v1
    v_lshlrev_b32 v1, 7, v1
    v_cmp_gt_u32 vcc, 43988, v1
    s_nop 0
    s_and_b64 exec, vcc, 15
    s_cbranch_execz Lnopf
    global_load_dword v1, v1, s[64:65]
Lnopf:
    s_mov_b64 exec, -1
    v_and_b32 v2, 63, v0
    v_lshrrev_b32 v8, 6, v0
    v_lshlrev_b32 v3, 4, v2
    v_readfirstlane_b32 s3, v8
    v_and_b32 v4, 15, v2
    v_lshrrev_b32 v5, 4, v2
    s_and_b32 s48, s2, 7
    s_lshr_b32 s46, s2, 3
    s_lshr_b32 s49, s48, 1
    s_and_b32 s44, s48, 1
    s_lshl_b32 s42, s49, 3
    s_lshr_b32 s50, s46, 2
    s_add_u32 s42, s42, s50
    s_lshl_b32 s43, s44, 2
    s_and_b32 s50, s46, 3
    s_add_u32 s43, s43, s50
    s_lshl_b32 s45, s49, 5
    s_add_u32 s45, s45, s46
    s_and_b32 s63, s3, 1
    s_lshr_b32 s68, s3, 1
    s_cmp_eq_u32 s3, 0
    s_cselect_b32 s60, 0, 1073741824
    s_lshl_b32 s61, s3, 10
    s_lshl_b32 s62, s3, 12
    s_lshr_b32 s48, s43, 2
    s_add_u32 s69, s48, 1
    s_sub_u32 s49, 0, s69
    s_bitcmp1_b32 s43, 1
    s_cselect_b32 s69, s49, s69
    s_cselect_b32 s70, 0, 8
    s_lshl_b32 s71, s42, 6
    s_sub_u32 s71, s71, s70
    v_lshrrev_b32 v8, 3, v2
    v_and_b32 v9, 7, v2
    v_xor_b32_e64 v9, v9, v8
    v_mul_u32_u24 v8, 1280, v8
    v_lshl_add_u32 v6, v9, 4, v8
    s_mov_b32 s72, 1280
    s_mov_b32 s49, 0
    s_mov_b32 s74, 1048576
    s_mov_b32 s48, s45
    s_mov_b32 s81, 160
    s_mov_b32 s84, 40
    s_mov_b32 s75, 102400
    s_mov_b32 s82, 40960
    s_mov_b32 s76, 4
    s_mov_b32 s77, 32
    s_mov_b32 s78, 64
    s_mov_b32 s79, 8
    s_mov_b32 s80, 128
    s_sub_u32 s53, s45, 40
    s_cmp_ge_u32 s45, 40
    s_cselect_b32 s48, s53, s48
    s_cselect_b32 s72, 3840, s72
    s_cselect_b32 s49, 1280, s49
    s_cselect_b32 s74, 1867776, s74
    s_cselect_b32 s77, 40, s77
    s_cselect_b32 s78, 80, s78
    s_cselect_b32 s79, 40, s79
    s_cselect_b32 s80, 32, s80
    s_sub_u32 s53, s45, 80
    s_cmp_ge_u32 s45, 80
    s_cselect_b32 s48, s53, s48
    s_cselect_b32 s72, 3840, s72
    s_cselect_b32 s49, 2560, s49
    s_cselect_b32 s74, 2686976, s74
    s_cselect_b32 s77, 40, s77
    s_cselect_b32 s78, 80, s78
    s_cselect_b32 s79, 40, s79
    s_cselect_b32 s80, 32, s80
    s_mul_i32 s52, s44, 640
    s_add_u32 s49, s49, s52
    s_lshr_b32 s50, s48, 1
    s_lshl_b32 s51, s48, 4
    s_lshl_b32 s54, s44, 1
    s_add_u32 s54, s54, s63
    s_mul_i32 s54, s54, 204800
    s_lshl_b32 s55, s50, 10
    s_add_u32 s54, s54, s55
    s_mul_i32 s55, s68, 20480
    s_add_u32 s54, s54, s55
    s_cmp_eq_u32 s68, 0
    s_cselect_b32 s83, 0, 1073741824
    s_mul_i32 s52, s63, 320
    s_mul_i32 s53, s68, s77
    s_add_u32 s77, s52, s53
    s_add_u32 s80, s80, s52
    s_mul_i32 s73, s51, s72
    s_add_u32 s73, s73, s49
    s_and_b32 s55, s48, 1
    s_lshl_b32 s55, s55, 9
    s_add_u32 s74, s74, s54
    s_add_u32 s74, s74, s55
    s_cmp_ge_u32 s45, 120
    s_cselect_b32 s73, 1073741824, s73
    s_cselect_b32 s74, 1073741824, s74
    s_lshl_b32 s48, s3, 6
    s_add_u32 s48, s48, 0
    v_add_u32 v8, s48, v2
    v_mul_u32_u24 v9, 1639, v8
    v_lshrrev_b32 v9, 16, v9
    v_mul_u32_u24 v10, 40, v9
    v_sub_u32 v8, v8, v10
    v_mul_u32_u24 v9, s72, v9
    v_lshl_add_u32 v9, v8, 4, v9
    s_mov_b32 s49, s73
    v_add_u32 v16, s49, v9
    s_lshl_b32 s48, s3, 6
    s_add_u32 s48, s48, 256
    v_add_u32 v8, s48, v2
    v_mul_u32_u24 v9, 1639, v8
    v_lshrrev_b32 v9, 16, v9
    v_mul_u32_u24 v10, 40, v9
    v_sub_u32 v8, v8, v10
    v_mul_u32_u24 v9, s72, v9
    v_lshl_add_u32 v9, v8, 4, v9
    s_mov_b32 s49, s73
    v_add_u32 v17, s49, v9
    s_lshl_b32 s48, s3, 6
    s_add_u32 s48, s48, 512
    v_add_u32 v8, s48, v2
    v_mul_u32_u24 v9, 1639, v8
    v_lshrrev_b32 v9, 16, v9
    v_mul_u32_u24 v10, 40, v9
    v_sub_u32 v8, v8, v10
    v_mul_u32_u24 v9, s72, v9
    v_lshl_add_u32 v9, v8, 4, v9
    s_mov_b32 s49, s73
    s_cmp_ge_u32 s3, 2
    s_cselect_b32 s49, 1073741824, s49
    v_add_u32 v18, s49, v9
    s_lshl_b32 s48, s3, 4
    s_add_u32 s48, s48, s71
    s_mul_i32 s86, s48, 1280
    s_cmp_lt_i32 s48, 0
    s_cselect_b32 s85, 1073741824, s86
    s_add_u32 s86, s86, 10240
    s_lshl_b32 s87, s3, 11
    s_waitcnt lgkmcnt(0)
    s_mov_b32 s8, s26
    s_mov_b32 s9, s27
    s_mov_b32 s10, 819200
    s_mov_b32 s11, 0x20000
    s_cmp_ge_u32 s45, 40
    s_cselect_b32 s8, s18, s8
    s_cselect_b32 s9, s19, s9
    s_cselect_b32 s10, 2457600, s10
    s_add_u32 m0, s61, 153600
    s_nop 0
    buffer_load_dwordx4 v16, s[8:11], 0 offen nt lds
    s_add_u32 m0, s61, 157696
    s_nop 0
    buffer_load_dwordx4 v17, s[8:11], 0 offen nt lds
    s_add_u32 s57, s61, 161792
    s_cmp_ge_u32 s3, 2
    s_cselect_b32 m0, 163840, s57
    s_nop 0
    buffer_load_dwordx4 v18, s[8:11], 0 offen nt lds
    s_mov_b32 s4, s16
    s_mov_b32 s5, s17
    s_mov_b32 s6, 2621440
    s_mov_b32 s7, 0x20000
    s_mov_b32 s12, s40
    s_mov_b32 s13, s41
    s_mov_b32 s14, 27852800
    s_mov_b32 s15, 0x20000
    s_load_dword s47, s[40:41], 0
    s_and_b32 s88, s46, 1
    s_add_u32 s88, s88, 0
    s_and_b32 s88, s88, 3
    s_bitcmp1_b32 s88, 1
    s_cselect_b32 s89, s86, s85
    s_cselect_b32 s57, 1024, 0
    s_bitcmp1_b32 s88, 0
    s_cselect_b32 s88, 640, 0
    s_add_u32 s89, s89, s88
    s_mul_i32 s88, s88, 72
    s_add_u32 s88, s88, s57
    s_add_u32 s88, s88, s87
    s_mov_b32 m0, s88
    s_nop 0
    s_nop 0
    buffer_load_dwordx4 v6, s[4:7], s89 offen nt lds
    s_add_u32 m0, s88, 9216
    s_add_u32 s89, s89, 128
    buffer_load_dwordx4 v6, s[4:7], s89 offen nt lds
    s_add_u32 m0, s88, 18432
    s_add_u32 s89, s89, 128
    buffer_load_dwordx4 v6, s[4:7], s89 offen nt lds
    s_add_u32 m0, s88, 27648
    s_add_u32 s89, s89, 128
    buffer_load_dwordx4 v6, s[4:7], s89 offen nt lds
    s_add_u32 m0, s88, 36864
    s_add_u32 s89, s89, 128
    buffer_load_dwordx4 v6, s[4:7], s89 offen nt lds
    v_lshrrev_b32_e64 v8, 5, v2
    v_bfe_u32 v9, v2, 4, 1
    v_bfe_u32 v10, v2, 2, 2
    v_lshl_add_u32 v9, v9, 3, v10
    v_mul_u32_u24 v9, 640, v9
    v_mad_u32_u24 v9, v8, s81, v9
    v_add_u32 v9, 153600, v9
    v_and_b32 v10, 3, v2
    v_lshl_add_u32 v16, v10, 3, v9
    v_add_u32 v16, s77, v16
    v_add_u32 v17, s78, v16
    v_mad_u32_u24 v18, v10, s79, v9
    v_add_u32 v18, s80, v18
    v_mul_u32_u24 v8, s75, v8
    v_and_b32 v10, 31, v2
    v_lshl_add_u32 v8, v10, 4, v8
    v_add_u32 v20, s74, v8
    v_add_u32 v21, s82, v20
    v_add_u32 v22, s82, v21
    v_add_u32 v22, s83, v22
    v_mov_b32 v8, 0x3f803f80
    v_accvgpr_write_b32 a0, v8
    v_accvgpr_write_b32 a1, v8
    v_accvgpr_write_b32 a2, v8
    v_accvgpr_write_b32 a3, v8
    v_and_b32 v7, 7, v2
    v_lshlrev_b32 v7, 4, v7
    v_and_b32 v19, 31, v2
    v_lshlrev_b32 v19, 7, v19
    v_mov_b32_e64 v24, 0
    v_mov_b32 v26, 159744
    v_add_u32 v27, 90112, v3
    s_lshl_b32 s59, s42, 2
    s_add_u32 s59, s59, s3
    s_lshl_b32 s58, s42, 7
    s_mul_i32 s48, s3, 20480
    s_mul_i32 s49, s43, 102400
    s_add_u32 s16, s49, s48
    s_add_u32 s17, s49, s61
    s_mul_i32 s49, s43, 245760
    s_add_u32 s90, s49, s48
    s_add_u32 s39, s49, s61
    s_mul_i32 s48, s3, 49152
    s_add_u32 s38, s49, s48
    s_add_u32 s91, s3, 1
    s_and_b32 s91, s91, 3
    s_add_u32 s92, s3, 2
    s_and_b32 s92, s92, 3
    s_add_u32 s93, s3, 3
    s_and_b32 s93, s93, 3
    s_lshl_b32 s48, s3, 12
    v_add_u32 v28, s48, v3
    s_lshl_b32 s48, s3, 4
    v_add_u32 v36, s48, v4
    s_lshl_b32 s48, s91, 12
    v_add_u32 v29, s48, v3
    s_lshl_b32 s48, s91, 4
    v_add_u32 v37, s48, v4
    s_lshl_b32 s48, s92, 12
    v_add_u32 v30, s48, v3
    s_lshl_b32 s48, s92, 4
    v_add_u32 v38, s48, v4
    s_lshl_b32 s48, s93, 12
    v_add_u32 v31, s48, v3
    s_lshl_b32 s48, s93, 4
    v_add_u32 v39, s48, v4
    s_mul_i32 s49, s43, 10
    v_lshrrev_b32 v12, 1, v5
    v_add_u32 v12, s49, v12
    s_lshl_b32 s49, s3, 1
    v_add_u32 v13, s49, v12
    v_add_u32 v12, 8, v12
    v_and_b32 v14, 1, v5
    v_lshlrev_b32 v14, 3, v14
    s_sub_u32 s48, s70, s69
    v_add_u32 v8, s48, v36
    v_lshrrev_b32 v9, 3, v8
    v_and_b32 v8, 7, v8
    v_lshlrev_b32 v9, 10, v9
    v_lshl_add_u32 v9, v8, 7, v9
    v_xor_b32 v10, v5, v8
    v_lshl_add_u32 v40, v10, 4, v9
    v_xor_b32 v41, 64, v40
    s_sub_u32 s48, s70, s69
    v_add_u32 v8, s48, v37
    v_lshrrev_b32 v9, 3, v8
    v_and_b32 v8, 7, v8
    v_lshlrev_b32 v9, 10, v9
    v_lshl_add_u32 v9, v8, 7, v9
    v_xor_b32 v10, v5, v8
    v_lshl_add_u32 v42, v10, 4, v9
    v_xor_b32 v43, 64, v42
    s_sub_u32 s48, s70, s69
    v_add_u32 v8, s48, v38
    v_lshrrev_b32 v9, 3, v8
    v_and_b32 v8, 7, v8
    v_lshlrev_b32 v9, 10, v9
    v_lshl_add_u32 v9, v8, 7, v9
    v_xor_b32 v10, v5, v8
    v_lshl_add_u32 v44, v10, 4, v9
    v_xor_b32 v45, 64, v44
    s_sub_u32 s48, s70, s69
    v_add_u32 v8, s48, v39
    v_lshrrev_b32 v9, 3, v8
    v_and_b32 v8, 7, v8
    v_lshlrev_b32 v9, 10, v9
    v_lshl_add_u32 v9, v8, 7, v9
    v_xor_b32 v10, v5, v8
    v_lshl_add_u32 v46, v10, 4, v9
    v_xor_b32 v47, 64, v46
    s_mov_b32 s48, s70
    v_add_u32 v8, s48, v36
    v_lshrrev_b32 v9, 3, v8
    v_and_b32 v8, 7, v8
    v_lshlrev_b32 v9, 10, v9
    v_lshl_add_u32 v9, v8, 7, v9
    v_xor_b32 v10, v5, v8
    v_lshl_add_u32 v48, v10, 4, v9
    v_xor_b32 v49, 64, v48
    v_lshrrev_b32 v10, 3, v13
    v_mul_u32_u24 v10, 9216, v10
    v_and_b32 v11, 7, v13
    v_xor_b32 v11, v11, v8
    v_lshl_add_u32 v11, v11, 4, v14
    v_add3_u32 v56, v9, v10, v11
    v_lshrrev_b32 v10, 3, v12
    v_mul_u32_u24 v10, 9216, v10
    v_and_b32 v11, 7, v12
    v_xor_b32_e64 v11, v11, v8
    v_lshl_add_u32 v11, v11, 4, v14
    v_add3_u32 v60, v9, v10, v11
    s_mov_b32 s48, s70
    v_add_u32 v8, s48, v37
    v_lshrrev_b32 v9, 3, v8
    v_and_b32 v8, 7, v8
    v_lshlrev_b32 v9, 10, v9
    v_lshl_add_u32 v9, v8, 7, v9
    v_xor_b32 v10, v5, v8
    v_lshl_add_u32 v50, v10, 4, v9
    v_xor_b32 v51, 64, v50
    v_lshrrev_b32 v10, 3, v13
    v_mul_u32_u24 v10, 9216, v10
    v_and_b32 v11, 7, v13
    v_xor_b32 v11, v11, v8
    v_lshl_add_u32 v11, v11, 4, v14
    v_add3_u32 v57, v9, v10, v11
    s_mov_b32 s48, s70
    v_add_u32 v8, s48, v38
    v_lshrrev_b32 v9, 3, v8
    v_and_b32 v8, 7, v8
    v_lshlrev_b32 v9, 10, v9
    v_lshl_add_u32 v9, v8, 7, v9
    v_xor_b32 v10, v5, v8
    v_lshl_add_u32 v52, v10, 4, v9
    v_xor_b32 v53, 64, v52
    v_lshrrev_b32 v10, 3, v13
    v_mul_u32_u24 v10, 9216, v10
    v_and_b32 v11, 7, v13
    v_xor_b32 v11, v11, v8
    v_lshl_add_u32 v11, v11, 4, v14
    v_add3_u32 v58, v9, v10, v11
    s_mov_b32 s48, s70
    v_add_u32 v8, s48, v39
    v_lshrrev_b32 v9, 3, v8
    v_and_b32 v8, 7, v8
    v_lshlrev_b32 v9, 10, v9
    v_lshl_add_u32 v9, v8, 7, v9
    v_xor_b32 v10, v5, v8
    v_lshl_add_u32 v54, v10, 4, v9
    v_xor_b32 v55, 64, v54
    v_lshrrev_b32 v10, 3, v13
    v_mul_u32_u24 v10, 9216, v10
    v_and_b32 v11, 7, v13
    v_xor_b32 v11, v11, v8
    v_lshl_add_u32 v11, v11, 4, v14
    v_add3_u32 v59, v9, v10, v11
    v_lshrrev_b32 v8, 1, v5
    v_lshlrev_b32 v8, 8, v8
    v_lshl_add_u32 v8, v4, 4, v8
    v_and_b32_e64 v9, 1, v5
    s_mul_i32 s48, s3, 20480
    s_add_u32 s48, s48, 2048
    v_lshl_add_u32 v25, v9, 30, v8
    v_add_u32 v25, s48, v25
    s_lshl_b32 s48, s3, 9
    v_add_u32 v8, s48, v8
    v_add_u32 v9, s3, v9
    v_add_u32 v10, 0, v9
    v_and_b32 v10, 3, v10
    v_mul_u32_u24 v10, 20480, v10
    v_add_u32 v64, v10, v8
    v_add_u32 v10, 2, v9
    v_and_b32 v10, 3, v10
    v_mul_u32_u24 v10, 20480, v10
    v_add_u32 v65, v10, v8
    s_mov_b32 s66, 0x3fb8aa3b
    s_mov_b32 s67, 0x3fb8aa3b
    v_mov_b32 v66, 0xc0135761
    v_mov_b32 v67, 0xc0135761
    s_mov_b32 s8, s20
    s_mov_b32 s9, s21
    s_mov_b32 s10, 25600
    s_mov_b32 s11, 0x20000
    s_mul_i32 s48, s43, 3200
    s_add_u32 s48, s48, s61
    s_add_u32 m0, s61, 126976
    s_nop 0
    buffer_load_dwordx4 v3, s[8:11], s48 offen lds
    s_mov_b32 s8, s34
    s_mov_b32 s9, s35
    s_mov_b32 s10, 1280
    s_mov_b32 s11, 0x20000
    buffer_load_dwordx4 v[68:71], v3, s[8:11], s61 offen
    s_mov_b32 s8, s28
    s_mov_b32 s9, s29
    s_mov_b32 s10, 819200
    s_mov_b32 s11, 0x20000
    s_mov_b32 s72, 1280
    s_mov_b32 s49, 0
    s_mov_b32 s74, 3506176
    s_mov_b32 s48, s45
    s_mov_b32 s81, 160
    s_mov_b32 s84, 40
    s_mov_b32 s75, 102400
    s_mov_b32 s82, 40960
    s_mov_b32 s76, 4
    s_mov_b32 s77, 32
    s_mov_b32 s78, 64
    s_mov_b32 s79, 8
    s_mov_b32 s80, 128
    s_sub_u32 s53, s45, 40
    s_cmp_ge_u32 s45, 40
    s_cselect_b32 s48, s53, s48
    s_cselect_b32 s72, 3840, s72
    s_cselect_b32 s49, 0, s49
    s_cselect_b32 s74, 4325376, s74
    s_cselect_b32 s77, 40, s77
    s_cselect_b32 s78, 80, s78
    s_cselect_b32 s79, 40, s79
    s_cselect_b32 s80, 32, s80
    s_cselect_b32 s8, s18, s8
    s_cselect_b32 s9, s19, s9
    s_cselect_b32 s10, 2457600, s10
    s_sub_u32 s53, s45, 80
    s_cmp_ge_u32 s45, 80
    s_cselect_b32 s48, s53, s48
    s_cselect_b32 s72, 1280, s72
    s_cselect_b32 s49, 0, s49
    s_cselect_b32 s74, 5144576, s74
    s_cselect_b32 s77, 32, s77
    s_cselect_b32 s78, 64, s78
    s_cselect_b32 s79, 8, s79
    s_cselect_b32 s80, 128, s80
    s_cselect_b32 s8, s22, s8
    s_cselect_b32 s9, s23, s9
    s_cselect_b32 s10, 819200, s10
    s_mul_i32 s52, s44, 640
    s_add_u32 s49, s49, s52
    s_lshr_b32 s50, s48, 1
    s_lshl_b32 s51, s48, 4
    s_mul_i32 s52, s48, 52
    s_lshr_b32 s52, s52, 8
    s_mul_i32 s53, s52, 5
    s_sub_u32 s53, s48, s53
    s_mul_i32 s54, s53, 20
    s_mov_b32 s55, 4
    s_cmp_eq_u32 s53, 4
    s_cselect_b32 s54, 16, s54
    s_cselect_b32 s55, 20, s55
    s_mul_i32 s52, s52, 80
    s_add_u32 s52, s52, s54
    s_cmp_ge_u32 s45, 80
    s_cselect_b32 s51, s52, s51
    s_cselect_b32 s76, s55, s76
    s_lshl_b32 s54, s44, 1
    s_add_u32 s54, s54, s63
    s_mul_i32 s54, s54, 204800
    s_lshl_b32 s55, s50, 10
    s_add_u32 s54, s54, s55
    s_mul_i32 s55, s68, 20480
    s_add_u32 s54, s54, s55
    s_cmp_eq_u32 s68, 0
    s_cselect_b32 s83, 0, 1073741824
    s_mul_i32 s52, s63, 320
    s_mul_i32 s53, s68, s77
    s_add_u32 s77, s52, s53
    s_add_u32 s80, s80, s52
    s_mul_i32 s73, s51, s72
    s_add_u32 s73, s73, s49
    s_and_b32 s55, s48, 1
    s_lshl_b32 s55, s55, 9
    s_add_u32 s74, s74, s54
    s_add_u32 s74, s74, s55
    s_cmp_ge_u32 s45, 120
    s_cselect_b32 s73, 1073741824, s73
    s_cselect_b32 s74, 1073741824, s74
    s_lshl_b32 s48, s3, 6
    s_add_u32 s48, s48, 0
    v_add_u32 v8, s48, v2
    v_mul_u32_u24 v9, 1639, v8
    v_lshrrev_b32 v9, 16, v9
    v_mul_u32_u24 v10, 40, v9
    v_sub_u32 v8, v8, v10
    v_lshrrev_b32 v10, 2, v9
    v_and_b32 v9, 3, v9
    v_mad_u32_u24 v9, v10, s76, v9
    v_mul_u32_u24 v9, s72, v9
    v_lshl_add_u32 v9, v8, 4, v9
    s_mov_b32 s49, s73
    v_add_u32 v12, s49, v9
    s_lshl_b32 s48, s3, 6
    s_add_u32 s48, s48, 256
    v_add_u32 v8, s48, v2
    v_mul_u32_u24 v9, 1639, v8
    v_lshrrev_b32 v9, 16, v9
    v_mul_u32_u24 v10, 40, v9
    v_sub_u32 v8, v8, v10
    v_lshrrev_b32 v10, 2, v9
    v_and_b32 v9, 3, v9
    v_mad_u32_u24 v9, v10, s76, v9
    v_mul_u32_u24 v9, s72, v9
    v_lshl_add_u32 v9, v8, 4, v9
    s_mov_b32 s49, s73
    v_add_u32 v13, s49, v9
    s_lshl_b32 s48, s3, 6
    s_add_u32 s48, s48, 512
    v_add_u32 v8, s48, v2
    v_mul_u32_u24 v9, 1639, v8
    v_lshrrev_b32 v9, 16, v9
    v_mul_u32_u24 v10, 40, v9
    v_sub_u32 v8, v8, v10
    v_lshrrev_b32 v10, 2, v9
    v_and_b32 v9, 3, v9
    v_mad_u32_u24 v9, v10, s76, v9
    v_mul_u32_u24 v9, s72, v9
    v_lshl_add_u32 v9, v8, 4, v9
    s_mov_b32 s49, s73
    s_cmp_ge_u32 s3, 2
    s_cselect_b32 s49, 1073741824, s49
    v_add_u32 v14, s49, v9
    s_add_u32 m0, s61, 92160
    s_nop 0
    buffer_load_dwordx4 v12, s[8:11], 0 offen nt lds
    s_add_u32 m0, s61, 96256
    s_nop 0
    buffer_load_dwordx4 v13, s[8:11], 0 offen nt lds
    s_add_u32 s57, s61, 100352
    s_cmp_ge_u32 s3, 2
    s_cselect_b32 m0, 163840, s57
    s_nop 0
    buffer_load_dwordx4 v14, s[8:11], 0 offen nt lds
    v_lshrrev_b32 v8, 5, v2
    v_bfe_u32 v9, v2, 4, 1
    v_bfe_u32 v10, v2, 2, 2
    v_lshl_add_u32 v9, v9, 3, v10
    v_mul_u32_u24 v9, 640, v9
    v_mad_u32_u24 v9, v8, s81, v9
    v_add_u32 v9, 92160, v9
    v_and_b32 v10, 3, v2
    v_lshl_add_u32 v72, v10, 3, v9
    v_add_u32 v72, s77, v72
    v_add_u32 v73, s78, v72
    v_mad_u32_u24 v74, v10, s79, v9
    v_add_u32 v74, s80, v74
    v_mul_u32_u24 v8, s75, v8
    v_and_b32 v10, 31, v2
    v_lshl_add_u32 v8, v10, 4, v8
    v_add_u32 v76, s74, v8
    v_add_u32 v77, s82, v76
    v_add_u32 v78, s82, v77
    v_add_u32 v78, s83, v78
    s_waitcnt vmcnt(10)
    s_barrier
    s_waitcnt lgkmcnt(0)
    s_add_u32 s47, s47, 1
    v_mov_b32_e64 v23, s47
    s_mov_b32 s40, 0xbdd2d3e8
    s_mov_b32 s41, 0xbdd2d3e8
    ds_read_b64_tr_b16 v[80:81], v16
    ds_read_b64_tr_b16 v[82:83], v16 offset:2560
    ds_read_b64_tr_b16 v[84:85], v17
    ds_read_b64_tr_b16 v[86:87], v17 offset:2560
    ds_read_b64_tr_b16 v[88:89], v18
    ds_read_b64_tr_b16 v[90:91], v18 offset:2560
    s_waitcnt lgkmcnt(4)
    buffer_store_dwordx4 v[80:83], v20, s[12:15], 0 offen sc1
    s_waitcnt lgkmcnt(2)
    buffer_store_dwordx4 v[84:87], v21, s[12:15], 0 offen sc1
    s_waitcnt lgkmcnt(0)
    buffer_store_dwordx4 v[88:91], v22, s[12:15], 0 offen sc1
    s_nop 1
    s_and_b32 s88, s46, 1
    s_add_u32 s88, s88, 1
    s_and_b32 s88, s88, 3
    s_bitcmp1_b32 s88, 1
    s_cselect_b32 s89, s86, s85
    s_cselect_b32 s57, 1024, 0
    s_bitcmp1_b32 s88, 0
    s_cselect_b32 s88, 640, 0
    s_add_u32 s89, s89, s88
    s_mul_i32 s88, s88, 72
    s_add_u32 s88, s88, s57
    s_add_u32 s88, s88, s87
    s_mov_b32 m0, s88
    s_nop 0
    s_nop 0
    buffer_load_dwordx4 v6, s[4:7], s89 offen nt lds
    s_add_u32 m0, s88, 9216
    s_add_u32 s89, s89, 128
    buffer_load_dwordx4 v6, s[4:7], s89 offen nt lds
    s_add_u32 m0, s88, 18432
    s_add_u32 s89, s89, 128
    buffer_load_dwordx4 v6, s[4:7], s89 offen nt lds
    s_mov_b32 s8, s30
    s_mov_b32 s9, s31
    s_mov_b32 s10, 1966080
    s_mov_b32 s11, 0x20000
    s_mov_b32 s72, 3072
    s_mov_b32 s81, 384
    s_mov_b32 s84, 48
    s_mov_b32 s78, 128
    s_mov_b32 s79, 8
    s_mov_b32 s74, 7929856
    s_mov_b32 s75, 245760
    s_mov_b32 s82, 81920
    s_mov_b32 s83, 0
    s_mov_b32 s76, 4
    s_lshl_b32 s77, s3, 5
    s_add_u32 s80, s77, 256
    s_sub_u32 s48, s45, 96
    s_lshl_b32 s53, s44, 1
    s_mul_i32 s49, s53, 768
    s_lshr_b32 s50, s48, 1
    s_mul_i32 s51, s53, 491520
    s_lshl_b32 s55, s50, 10
    s_add_u32 s51, s51, s55
    s_mul_i32 s55, s3, 20480
    s_add_u32 s51, s51, s55
    s_lshr_b32 s50, s45, 1
    s_mul_i32 s52, s50, 43
    s_lshr_b32 s52, s52, 8
    s_mul_i32 s53, s52, 6
    s_sub_u32 s53, s50, s53
    s_and_b32 s54, s53, 1
    s_lshr_b32 s53, s53, 1
    s_lshl_b32 s53, s53, 4
    s_lshl_b32 s52, s52, 1
    s_add_u32 s52, s52, s53
    s_add_u32 s50, s52, s54
    s_lshl_b32 s54, s44, 1
    s_add_u32 s54, s54, s63
    s_mul_i32 s54, s54, 491520
    s_lshl_b32 s55, s50, 10
    s_add_u32 s54, s54, s55
    s_mul_i32 s55, s68, 49152
    s_add_u32 s54, s54, s55
    s_mul_i32 s53, s44, 640
    s_cmp_eq_u32 s68, 0
    s_cselect_b32 s55, 0, 1073741824
    s_mul_i32 s52, s63, 320
    s_lshl_b32 s50, s68, 5
    s_add_u32 s50, s50, s52
    s_add_u32 s52, s52, 128
    s_cmp_lt_u32 s45, 96
    s_cselect_b32 s48, s45, s48
    s_cselect_b32 s49, s53, s49
    s_cselect_b32 s51, s54, s51
    s_cselect_b32 s72, 1280, s72
    s_cselect_b32 s81, 160, s81
    s_cselect_b32 s84, 40, s84
    s_cselect_b32 s78, 64, s78
    s_cselect_b32 s74, 5963776, s74
    s_cselect_b32 s82, 98304, s82
    s_cselect_b32 s83, s55, s83
    s_cselect_b32 s77, s50, s77
    s_cselect_b32 s80, s52, s80
    s_cselect_b32 s8, s32, s8
    s_cselect_b32 s9, s33, s9
    s_mov_b32 s54, s51
    s_lshl_b32 s51, s48, 4
    s_mul_i32 s73, s51, s72
    s_add_u32 s73, s73, s49
    s_and_b32 s55, s48, 1
    s_lshl_b32 s55, s55, 9
    s_add_u32 s74, s74, s54
    s_add_u32 s74, s74, s55
    s_lshl_b32 s48, s3, 6
    s_add_u32 s48, s48, 0
    v_add_u32 v8, s48, v2
    v_mul_u32_u24 v9, 1366, v8
    v_lshrrev_b32 v9, 16, v9
    v_mul_u32_u24 v10, 48, v9
    v_sub_u32 v8, v8, v10
    v_mul_u32_u24 v9, s72, v9
    v_lshl_add_u32 v9, v8, 4, v9
    s_mov_b32 s49, s73
    v_add_u32 v16, s49, v9
    v_cmp_gt_u32 vcc, s84, v8
    v_mov_b32 v10, 1073741824
    s_nop 0
    v_cndmask_b32 v16, v10, v16, vcc
    s_lshl_b32 s48, s3, 6
    s_add_u32 s48, s48, 256
    v_add_u32 v8, s48, v2
    v_mul_u32_u24 v9, 1366, v8
    v_lshrrev_b32 v9, 16, v9
    v_mul_u32_u24 v10, 48, v9
    v_sub_u32 v8, v8, v10
    v_mul_u32_u24 v9, s72, v9
    v_lshl_add_u32 v9, v8, 4, v9
    s_mov_b32 s49, s73
    v_add_u32 v17, s49, v9
    v_cmp_gt_u32 vcc, s84, v8
    v_mov_b32 v10, 1073741824
    s_nop 0
    v_cndmask_b32 v17, v10, v17, vcc
    s_lshl_b32 s48, s3, 6
    s_add_u32 s48, s48, 512
    v_add_u32 v8, s48, v2
    v_mul_u32_u24 v9, 1366, v8
    v_lshrrev_b32 v9, 16, v9
    v_mul_u32_u24 v10, 48, v9
    v_sub_u32 v8, v8, v10
    v_mul_u32_u24 v9, s72, v9
    v_lshl_add_u32 v9, v8, 4, v9
    s_mov_b32 s49, s73
    v_add_u32 v18, s49, v9
    v_cmp_gt_u32 vcc, s84, v8
    v_mov_b32 v10, 1073741824
    s_nop 0
    v_cndmask_b32 v18, v10, v18, vcc
    v_lshrrev_b32 v8, 5, v2
    v_bfe_u32 v9, v2, 4, 1
    v_bfe_u32 v10, v2, 2, 2
    v_lshl_add_u32 v9, v9, 3, v10
    v_mul_u32_u24 v9, 768, v9
    v_mad_u32_u24 v9, v8, s81, v9
    v_add_u32 v9, 102400, v9
    v_and_b32 v10, 3, v2
    v_lshl_add_u32 v20, v10, 3, v9
    v_add_u32 v20, s77, v20
    v_add_u32 v21, s78, v20
    v_mad_u32_u24 v22, v10, s79, v9
    v_add_u32 v22, s80, v22
    v_mul_u32_u24 v8, s75, v8
    v_and_b32 v10, 31, v2
    v_lshl_add_u32 v8, v10, 4, v8
    v_add_u32 v80, s74, v8
    v_add_u32 v81, s82, v80
    v_add_u32 v82, s82, v81
    v_add_u32 v82, s83, v82
    s_mov_b32 s24, s8
    s_mov_b32 s25, s9
    s_mov_b32 s26, s10
    s_mov_b32 s27, 0x20000
    s_waitcnt vmcnt(3)
    s_barrier
    s_lshl_b32 s69, s44, 7
    s_add_u32 s69, s69, s45
    s_lshl_b32 s69, s69, 4
    s_add_u32 s69, s69, 4096
    s_add_u32 s69, s69, s60
    s_mov_b64 exec, 1
    buffer_store_dword v23, v24, s[12:15], s69 offen sc1
    s_mov_b64 exec, -1
    s_nop 0
    ds_read_b64_tr_b16 v[84:85], v72
    ds_read_b64_tr_b16 v[86:87], v72 offset:2560
    ds_read_b64_tr_b16 v[88:89], v73
    ds_read_b64_tr_b16 v[90:91], v73 offset:2560
    ds_read_b64_tr_b16 v[92:93], v74
    ds_read_b64_tr_b16 v[94:95], v74 offset:2560
    s_add_u32 m0, s88, 27648
    s_add_u32 s89, s89, 128
    buffer_load_dwordx4 v6, s[4:7], s89 offen nt lds
    s_add_u32 m0, s88, 36864
    s_add_u32 s89, s89, 128
    buffer_load_dwordx4 v6, s[4:7], s89 offen nt lds
    s_and_b32 s88, s46, 1
    s_add_u32 s88, s88, 2
    s_and_b32 s88, s88, 3
    s_bitcmp1_b32 s88, 1
    s_cselect_b32 s89, s86, s85
    s_cselect_b32 s57, 1024, 0
    s_bitcmp1_b32 s88, 0
    s_cselect_b32 s88, 640, 0
    s_add_u32 s89, s89, s88
    s_mul_i32 s88, s88, 72
    s_add_u32 s88, s88, s57
    s_add_u32 s88, s88, s87
    s_mov_b32 m0, s88
    s_nop 0
    s_nop 0
    buffer_load_dwordx4 v6, s[4:7], s89 offen nt lds
    s_add_u32 m0, s88, 9216
    s_add_u32 s89, s89, 128
    buffer_load_dwordx4 v6, s[4:7], s89 offen nt lds
    s_add_u32 m0, s88, 18432
    s_add_u32 s89, s89, 128
    buffer_load_dwordx4 v6, s[4:7], s89 offen nt lds
    s_add_u32 m0, s88, 27648
    s_add_u32 s89, s89, 128
    buffer_load_dwordx4 v6, s[4:7], s89 offen nt lds
    s_mov_b32 s8, s30
    s_mov_b32 s9, s31
    s_mov_b32 s10, 1966080
    s_mov_b32 s11, 0x20000
    s_mov_b32 s72, 3072
    s_mov_b32 s81, 384
    s_mov_b32 s84, 48
    s_mov_b32 s78, 128
    s_mov_b32 s79, 8
    s_mov_b32 s74, 7929856
    s_mov_b32 s75, 245760
    s_mov_b32 s82, 81920
    s_mov_b32 s83, 0
    s_mov_b32 s76, 4
    s_lshl_b32 s77, s3, 5
    s_add_u32 s80, s77, 256
    s_add_u32 s48, s45, 32
    s_lshl_b32 s53, s44, 1
    s_sub_u32 s54, s45, 8
    s_add_u32 s55, s53, 1
    s_cmp_ge_u32 s45, 8
    s_cselect_b32 s48, s54, s48
    s_cselect_b32 s53, s55, s53
    s_mul_i32 s49, s53, 768
    s_lshr_b32 s50, s48, 1
    s_mul_i32 s51, s53, 491520
    s_lshl_b32 s55, s50, 10
    s_add_u32 s51, s51, s55
    s_mul_i32 s55, s3, 20480
    s_add_u32 s51, s51, s55
    s_mov_b32 s54, s51
    s_lshl_b32 s51, s48, 4
    s_mul_i32 s73, s51, s72
    s_add_u32 s73, s73, s49
    s_and_b32 s55, s48, 1
    s_lshl_b32 s55, s55, 9
    s_add_u32 s74, s74, s54
    s_add_u32 s74, s74, s55
    s_cmp_ge_u32 s45, 48
    s_cselect_b32 s73, 1073741824, s73
    s_cselect_b32 s74, 1073741824, s74
    s_add_u32 m0, s88, 36864
    s_add_u32 s89, s89, 128
    buffer_load_dwordx4 v6, s[4:7], s89 offen nt lds
    s_and_b32 s88, s46, 1
    s_add_u32 s88, s88, 3
    s_and_b32 s88, s88, 3
    s_bitcmp1_b32 s88, 1
    s_cselect_b32 s89, s86, s85
    s_cselect_b32 s57, 1024, 0
    s_bitcmp1_b32 s88, 0
    s_cselect_b32 s88, 640, 0
    s_add_u32 s89, s89, s88
    s_mul_i32 s88, s88, 72
    s_add_u32 s88, s88, s57
    s_add_u32 s88, s88, s87
    s_mov_b32 m0, s88
    s_nop 0
    buffer_load_dwordx4 v6, s[4:7], s89 offen nt lds
    s_lshl_b32 s48, s3, 6
    s_add_u32 s48, s48, 0
    v_add_u32 v8, s48, v2
    v_mul_u32_u24 v9, 1366, v8
    v_lshrrev_b32 v9, 16, v9
    v_mul_u32_u24 v10, 48, v9
    v_sub_u32 v8, v8, v10
    v_mul_u32_u24 v9, s72, v9
    v_lshl_add_u32 v9, v8, 4, v9
    s_mov_b32 s49, s73
    v_add_u32 v72, s49, v9
    v_cmp_gt_u32 vcc, s84, v8
    v_mov_b32 v10, 1073741824
    s_nop 0
    v_cndmask_b32 v72, v10, v72, vcc
    s_lshl_b32 s48, s3, 6
    s_add_u32 s48, s48, 256
    v_add_u32 v8, s48, v2
    v_mul_u32_u24 v9, 1366, v8
    v_lshrrev_b32 v9, 16, v9
    v_mul_u32_u24 v10, 48, v9
    v_sub_u32 v8, v8, v10
    v_mul_u32_u24 v9, s72, v9
    v_lshl_add_u32 v9, v8, 4, v9
    s_mov_b32 s49, s73
    v_add_u32 v73, s49, v9
    v_cmp_gt_u32 vcc, s84, v8
    v_mov_b32 v10, 1073741824
    s_nop 0
    v_cndmask_b32 v73, v10, v73, vcc
    s_lshl_b32 s48, s3, 6
    s_add_u32 s48, s48, 512
    v_add_u32 v8, s48, v2
    v_mul_u32_u24 v9, 1366, v8
    v_lshrrev_b32 v9, 16, v9
    v_mul_u32_u24 v10, 48, v9
    v_sub_u32 v8, v8, v10
    v_mul_u32_u24 v9, s72, v9
    v_lshl_add_u32 v9, v8, 4, v9
    s_mov_b32 s49, s73
    v_add_u32 v74, s49, v9
    v_cmp_gt_u32 vcc, s84, v8
    v_mov_b32 v10, 1073741824
    s_nop 0
    v_cndmask_b32_e64 v74, v10, v74, vcc
    s_add_u32 m0, s88, 9216
    s_add_u32 s89, s89, 128
    buffer_load_dwordx4 v6, s[4:7], s89 offen nt lds
    s_add_u32 m0, s88, 18432
    s_add_u32 s89, s89, 128
    buffer_load_dwordx4 v6, s[4:7], s89 offen nt lds
    v_lshrrev_b32_e64 v8, 5, v2
    v_bfe_u32 v9, v2, 4, 1
    v_bfe_u32 v10, v2, 2, 2
    v_lshl_add_u32 v9, v9, 3, v10
    v_mul_u32_u24 v9, 768, v9
    v_mad_u32_u24 v9, v8, s81, v9
    v_add_u32 v9, 114688, v9
    v_and_b32 v10, 3, v2
    v_lshl_add_u32 v96, v10, 3, v9
    v_add_u32 v96, s77, v96
    v_add_u32 v97, s78, v96
    v_mad_u32_u24 v98, v10, s79, v9
    v_add_u32 v98, s80, v98
    v_mul_u32_u24 v8, s75, v8
    v_and_b32 v10, 31, v2
    v_lshl_add_u32 v8, v10, 4, v8
    v_add_u32 v100, s74, v8
    v_add_u32 v101, s82, v100
    v_add_u32 v102, s82, v101
    v_add_u32 v102, s83, v102
    v_mov_b32 v8, 0
    v_mov_b32 v9, 0
    v_mov_b32 v10, 0
    v_mov_b32 v11, 0
    v_add_u32 v12, 159744, v3
    ds_write_b128 v12, v[8:11]
    s_and_b32 s48, s61, 1024
    s_add_u32 s48, s48, 161792
    v_add_u32 v14, s48, v3
    s_cmp_lt_u32 s3, 2
    s_cselect_b64 exec, -1, 0
    ds_write_b128 v14, v[68:71]
    s_mov_b64 exec, -1
    s_add_u32 m0, s88, 27648
    s_add_u32 s89, s89, 128
    buffer_load_dwordx4 v6, s[4:7], s89 offen nt lds
    s_add_u32 m0, s88, 36864
    s_add_u32 s89, s89, 128
    buffer_load_dwordx4 v6, s[4:7], s89 offen nt lds
    v_bfe_u32 v12, v2, 2, 2
    v_lshl_add_u32 v13, v5, 2, v12
    v_mul_u32_u24 v13, 40, v13
    v_mul_u32_u24 v12, 40, v12
    s_mul_i32 s48, s3, 800
    s_add_u32 s48, s48, 126976
    v_and_b32 v14, 3, v2
    v_lshlrev_b32 v14, 3, v14
    v_add_u32 v13, s48, v13
    v_add_u32 v15, v13, v14
    v_add_u32 v12, s48, v12
    v_add_u32 v12, 640, v12
    v_add_u32 v14, v12, v14
    s_mov_b64 vcc, 0xffff
    v_cndmask_b32 v12, v26, v12, vcc
    v_cndmask_b32 v14, v26, v14, vcc
    s_lshl_b32 s48, s3, 9
    s_add_u32 s48, s48, 155648
    v_lshl_add_u32 v75, v2, 3, s48
    s_lshl_b32 s48, s3, 9
    s_lshl_b32 s49, s3, 7
    s_add_u32 s48, s48, s49
    s_add_u32 s48, s48, 155648
    v_lshl_add_u32 v68, v4, 3, s48
    s_lshl_b32 s48, s91, 9
    s_lshl_b32 s49, s3, 7
    s_add_u32 s48, s48, s49
    s_add_u32 s48, s48, 155648
    v_lshl_add_u32 v69, v4, 3, s48
    s_lshl_b32 s48, s92, 9
    s_lshl_b32 s49, s3, 7
    s_add_u32 s48, s48, s49
    s_add_u32 s48, s48, 155648
    v_lshl_add_u32 v70, v4, 3, s48
    s_lshl_b32 s48, s93, 9
    s_lshl_b32 s49, s3, 7
    s_add_u32 s48, s48, s49
    s_add_u32 s48, s48, 155648
    v_lshl_add_u32 v71, v4, 3, s48
    s_add_u32 s89, s71, 64
    s_mul_i32 s89, s89, 10
    s_add_u32 s89, s89, s3
    s_lshl_b32 s89, s89, 7
    s_add_u32 s89, s89, 0
    s_mul_i32 s88, s3, 9216
    s_add_u32 s88, s88, 8192
    s_mov_b32 m0, s88
    s_nop 0
    buffer_load_dwordx4 v6, s[4:7], s89 offen lds
    s_add_u32 s89, s71, 64
    s_mul_i32 s89, s89, 10
    s_add_u32 s89, s89, s3
    s_lshl_b32 s89, s89, 7
    s_add_u32 s89, s89, 512
    s_mul_i32 s88, s3, 9216
    s_add_u32 s88, s88, 45056
    s_mov_b32 m0, s88
    s_nop 0
    buffer_load_dwordx4 v6, s[4:7], s89 offen lds
    s_add_u32 s89, s71, 64
    s_mul_i32 s89, s89, 10
    s_add_u32 s89, s89, s3
    s_lshl_b32 s89, s89, 7
    s_add_u32 s89, s89, 1024
    s_mul_i32 s88, s3, 9216
    s_add_u32 s88, s88, 81920
    s_cmp_ge_u32 s3, 2
    s_cselect_b32 s88, 163840, s88
    s_cselect_b32 s89, 1073741824, s89
    s_mov_b32 m0, s88
    s_nop 0
    buffer_load_dwordx4 v6, s[4:7], s89 offen lds
    s_lshl_b32 s18, s44, 11
    s_add_u32 s18, s18, 4096
    buffer_load_dword v104, v3, s[12:15], s18 offen offset:0 sc1
    buffer_load_dword v105, v3, s[12:15], s18 offen offset:1024 sc1
    s_mul_i32 s19, s59, 20480
    s_mul_i32 s20, s59, 49152
    s_lshl_b32 s21, s43, 4
    s_add_u32 s21, s21, s58
    s_add_u32 s21, s21, s60
    s_lshl_b32 s28, s43, 12
    s_add_u32 s22, s28, s58
    s_add_u32 s22, s22, s60
    s_mul_i32 s23, s42, 81920
    s_mul_i32 s48, s43, 2560
    s_add_u32 s23, s23, s48
    s_waitcnt vmcnt(2) lgkmcnt(0)
    s_barrier
    ds_read_b64_tr_b16 a[4:5], v15
    ds_read_b64_tr_b16 a[6:7], v14
    ds_read_b64_tr_b16 a[8:9], v13 offset:32
    ds_read_b64_tr_b16 a[10:11], v12 offset:32
    s_waitcnt vmcnt(0)
    v_cmp_ne_u32 vcc, s47, v104
    v_cmp_ne_u32 s[64:65], s47, v105
    s_nop 1
    s_or_b64 vcc, vcc, s[64:65]
    s_cbranch_vccnz Lslow1
Lback2:
    s_nop 0
    s_add_u32 m0, s61, 151552
    s_add_u32 s56, s17, 1130496
    buffer_load_dwordx4 v3, s[12:15], s56 offen sc1 lds
    s_add_u32 s18, s16, 1048576
    buffer_load_dwordx4 a[84:87], v3, s[12:15], s18 offen offset:0 sc1
    buffer_load_dwordx4 a[88:91], v3, s[12:15], s18 offen offset:1024 sc1
    buffer_load_dwordx4 a[92:95], v3, s[12:15], s18 offen offset:2048 sc1
    buffer_load_dwordx4 a[96:99], v3, s[12:15], s18 offen offset:3072 sc1
    s_add_u32 m0, s61, 147456
    s_add_u32 s56, s17, 1134592
    buffer_load_dwordx4 v3, s[12:15], s56 offen sc1 lds
    s_add_u32 s29, s16, 1052672
    buffer_load_dwordx4 a[100:103], v3, s[12:15], s29 offen offset:0 sc1
    buffer_load_dwordx4 a[104:107], v3, s[12:15], s29 offen offset:1024 sc1
    buffer_load_dwordx4 a[108:111], v3, s[12:15], s29 offen offset:2048 sc1
    buffer_store_dwordx4 v[84:87], v76, s[12:15], 0 offen sc1
    buffer_store_dwordx4 v[88:91], v77, s[12:15], 0 offen sc1
    buffer_store_dwordx4 v[92:95], v78, s[12:15], 0 offen sc1
    ds_read_b64 v[76:77], v56
    ds_read_b64 v[78:79], v57
    ds_read_b64 v[84:85], v58
    ds_read_b64 v[86:87], v59
    ds_read_b64 v[88:89], v60
    v_add_u32 v8, 55296, v40
    v_add_u32 v9, 55296, v41
    ds_read_b128 a[12:15], v40 offset:0
    ds_read_b128 a[16:19], v41 offset:0
    ds_read_b128 a[20:23], v40 offset:9216
    ds_read_b128 a[24:27], v41 offset:9216
    ds_read_b128 a[28:31], v40 offset:18432
    ds_read_b128 a[32:35], v41 offset:18432
    ds_read_b128 a[36:39], v40 offset:27648
    ds_read_b128 a[40:43], v41 offset:27648
    ds_read_b128 a[44:47], v40 offset:36864
    ds_read_b128 a[48:51], v41 offset:36864
    ds_read_b128 a[52:55], v40 offset:46080
    ds_read_b128 a[56:59], v41 offset:46080
    s_waitcnt lgkmcnt(11)
    v_mfma_f32_16x16x32_bf16 v[120:123], a[0:3], a[12:15], 0
    v_mfma_f32_16x16x32_bf16 v[124:127], a[12:15], a[12:15], 0
    ds_read_b128 a[60:63], v8 offset:0
    s_waitcnt lgkmcnt(11)
    v_mfma_f32_16x16x32_bf16 v[120:123], a[0:3], a[16:19], v[120:123]
    v_mfma_f32_16x16x32_bf16 v[124:127], a[16:19], a[16:19], v[124:127]
    ds_read_b128 a[64:67], v9 offset:0
    s_waitcnt lgkmcnt(11)
    v_mfma_f32_16x16x32_bf16 v[120:123], a[0:3], a[20:23], v[120:123]
    v_mfma_f32_16x16x32_bf16 v[124:127], a[20:23], a[20:23], v[124:127]
    ds_read_b128 a[12:15], v8 offset:9216
    s_waitcnt lgkmcnt(11)
    v_mfma_f32_16x16x32_bf16 v[120:123], a[0:3], a[24:27], v[120:123]
    v_mfma_f32_16x16x32_bf16 v[124:127], a[24:27], a[24:27], v[124:127]
    ds_read_b128 a[16:19], v9 offset:9216
    s_waitcnt lgkmcnt(11)
    v_mfma_f32_16x16x32_bf16 v[120:123], a[0:3], a[28:31], v[120:123]
    v_mfma_f32_16x16x32_bf16 v[124:127], a[28:31], a[28:31], v[124:127]
    ds_read_b128 a[20:23], v8 offset:18432
    s_waitcnt lgkmcnt(11)
    v_mfma_f32_16x16x32_bf16 v[120:123], a[0:3], a[32:35], v[120:123]
    v_mfma_f32_16x16x32_bf16 v[124:127], a[32:35], a[32:35], v[124:127]
    ds_read_b128 a[24:27], v9 offset:18432
    s_waitcnt lgkmcnt(11)
    v_mfma_f32_16x16x32_bf16 v[120:123], a[0:3], a[36:39], v[120:123]
    v_mfma_f32_16x16x32_bf16 v[124:127], a[36:39], a[36:39], v[124:127]
    ds_read_b128 a[28:31], v8 offset:27648
    s_waitcnt lgkmcnt(11)
    v_mfma_f32_16x16x32_bf16 v[120:123], a[0:3], a[40:43], v[120:123]
    v_mfma_f32_16x16x32_bf16 v[124:127], a[40:43], a[40:43], v[124:127]
    ds_read_b128 a[32:35], v9 offset:27648
    s_waitcnt lgkmcnt(11)
    v_mfma_f32_16x16x32_bf16 v[120:123], a[0:3], a[44:47], v[120:123]
    v_mfma_f32_16x16x32_bf16 v[124:127], a[44:47], a[44:47], v[124:127]
    s_waitcnt lgkmcnt(10)
    v_mfma_f32_16x16x32_bf16 v[120:123], a[0:3], a[48:51], v[120:123]
    v_mfma_f32_16x16x32_bf16 v[124:127], a[48:51], a[48:51], v[124:127]
    s_waitcnt lgkmcnt(9)
    v_mfma_f32_16x16x32_bf16 v[120:123], a[0:3], a[52:55], v[120:123]
    v_mfma_f32_16x16x32_bf16 v[124:127], a[52:55], a[52:55], v[124:127]
    s_waitcnt lgkmcnt(8)
    v_mfma_f32_16x16x32_bf16 v[120:123], a[0:3], a[56:59], v[120:123]
    v_mfma_f32_16x16x32_bf16 v[124:127], a[56:59], a[56:59], v[124:127]
    s_waitcnt lgkmcnt(7)
    v_mfma_f32_16x16x32_bf16 v[120:123], a[0:3], a[60:63], v[120:123]
    v_mfma_f32_16x16x32_bf16 v[124:127], a[60:63], a[60:63], v[124:127]
    s_waitcnt lgkmcnt(6)
    v_mfma_f32_16x16x32_bf16 v[120:123], a[0:3], a[64:67], v[120:123]
    v_mfma_f32_16x16x32_bf16 v[124:127], a[64:67], a[64:67], v[124:127]
    buffer_load_dwordx4 a[112:115], v3, s[12:15], s29 offen offset:3072 sc1
    s_waitcnt lgkmcnt(5)
    v_mfma_f32_16x16x32_bf16 v[120:123], a[0:3], a[12:15], v[120:123]
    v_mfma_f32_16x16x32_bf16 v[124:127], a[12:15], a[12:15], v[124:127]
    s_waitcnt lgkmcnt(4)
    v_mfma_f32_16x16x32_bf16 v[120:123], a[0:3], a[16:19], v[120:123]
    v_mfma_f32_16x16x32_bf16 v[124:127], a[16:19], a[16:19], v[124:127]
    s_waitcnt lgkmcnt(3)
    v_mfma_f32_16x16x32_bf16 v[120:123], a[0:3], a[20:23], v[120:123]
    s_add_u32 m0, s61, 143360
    s_add_u32 s56, s17, 1138688
    buffer_load_dwordx4 v3, s[12:15], s56 offen sc1 lds
    v_mfma_f32_16x16x32_bf16 v[124:127], a[20:23], a[20:23], v[124:127]
    s_waitcnt lgkmcnt(2)
    v_mfma_f32_16x16x32_bf16 v[120:123], a[0:3], a[24:27], v[120:123]
    v_mfma_f32_16x16x32_bf16 v[124:127], a[24:27], a[24:27], v[124:127]
    s_waitcnt lgkmcnt(1)
    v_mfma_f32_16x16x32_bf16 v[120:123], a[0:3], a[28:31], v[120:123]
    s_add_u32 s18, s16, 1056768
    buffer_load_dwordx4 a[116:119], v3, s[12:15], s18 offen offset:0 sc1
    v_mfma_f32_16x16x32_bf16 v[124:127], a[28:31], a[28:31], v[124:127]
    s_waitcnt lgkmcnt(0)
    v_mfma_f32_16x16x32_bf16 v[120:123], a[0:3], a[32:35], v[120:123]
    v_mfma_f32_16x16x32_bf16 v[124:127], a[32:35], a[32:35], v[124:127]
    s_waitcnt vmcnt(14)
    s_barrier
    ds_read_b128 a[12:15], v40 offset:0
    ds_read_b128 a[28:31], v27 offset:61440
    ds_read_b128 a[16:19], v42 offset:0
    ds_read_b128 a[20:23], v44 offset:0
    ds_read_b128 a[24:27], v46 offset:0
    ds_read_b128 a[36:39], v41 offset:0
    ds_read_b128 a[52:55], v27 offset:62464
    ds_read_b128 a[40:43], v43 offset:0
    ds_read_b128 a[44:47], v45 offset:0
    ds_read_b128 a[48:51], v47 offset:0
    s_waitcnt vmcnt(13) lgkmcnt(9)
    v_mfma_f32_16x16x32_bf16 v[56:59], a[84:87], a[12:15], 0
    ds_read_b128 a[60:63], v40 offset:9216
    ds_read_b128 a[76:79], v27 offset:63488
    s_mov_b32 vcc_lo, 0x22222222
    s_mov_b32 vcc_hi, 0x22222222
    v_cndmask_b32 v129, v124, v125, vcc
    s_mov_b32 vcc_lo, 0x44444444
    s_mov_b32 vcc_hi, 0x44444444
    v_cndmask_b32_e64 v129, v129, v126, vcc
    s_mov_b32 vcc_lo, 0x88888888
    s_mov_b32 vcc_hi, 0x88888888
    v_cndmask_b32_e64 v129, v129, v127, vcc
    v_mfma_f32_16x16x32_bf16 v[112:115], a[84:87], a[0:3], 0
    buffer_load_dwordx4 a[120:123], v3, s[12:15], s18 offen offset:1024 sc1
    v_mul_f32 v128, 0xbacccccd, v120
    s_waitcnt lgkmcnt(10)
    v_mfma_f32_16x16x32_bf16 v[108:111], a[28:31], a[12:15], 0
    v_mul_f32 v129, 0x3acccccd, v129
    v_mfma_f32_16x16x32_bf16 v[116:119], a[28:31], a[0:3], 0
    buffer_load_dwordx4 a[124:127], v3, s[12:15], s18 offen offset:2048 sc1
    v_fma_f32 v129, -v128, v128, v129
    s_waitcnt lgkmcnt(9)
    v_mfma_f32_16x16x32_bf16 v[60:63], a[84:87], a[16:19], 0
    ds_read_b128 a[64:67], v42 offset:9216
    ds_read_b128 a[68:71], v44 offset:9216
    v_max_f32 v129, 0, v129
    s_waitcnt lgkmcnt(10)
    v_mfma_f32_16x16x32_bf16 v[92:95], a[84:87], a[20:23], 0
    ds_read_b128 a[72:75], v46 offset:9216
    v_add_f32 v129, 0x3727c5ac, v129
    s_waitcnt lgkmcnt(10)
    v_mfma_f32_16x16x32_bf16 v[104:107], a[84:87], a[24:27], 0
    buffer_load_dwordx4 a[128:131], v3, s[12:15], s18 offen offset:3072 sc1
    v_rsq_f32 v129, v129
    s_waitcnt vmcnt(15) lgkmcnt(5)
    v_mfma_f32_16x16x32_bf16 v[56:59], a[88:91], a[36:39], v[56:59]
    ds_read_b128 a[12:15], v41 offset:9216
    ds_read_b128 a[28:31], v27 offset:64512
    v_lshlrev_b32 v130, 3, v36
    v_mfma_f32_16x16x32_bf16 v[112:115], a[88:91], a[0:3], v[112:115]
    s_add_u32 m0, s61, 139264
    s_add_u32 s56, s17, 1142784
    buffer_load_dwordx4 v3, s[12:15], s56 offen sc1 lds
    v_add_u32 v130, 160768, v130
    v_mfma_f32_16x16x32_bf16 v[108:111], a[52:55], a[36:39], v[108:111]
    s_mov_b32 exec_lo, 0xf0000f
    s_mov_b32 exec_hi, 0xf0000f00
    ds_write_b64 v130, v[128:129]
    s_mov_b64 exec, -1
    s_nop 0
    v_mfma_f32_16x16x32_bf16 v[116:119], a[52:55], a[0:3], v[116:119]
    s_add_u32 s29, s16, 1060864
    buffer_load_dwordx4 a[84:87], v3, s[12:15], s29 offen offset:0 sc1
    v_mfma_f32_16x16x32_bf16 v[60:63], a[88:91], a[40:43], v[60:63]
    ds_read_b128 a[16:19], v43 offset:9216
    ds_read_b128 a[20:23], v45 offset:9216
    v_mfma_f32_16x16x32_bf16 v[92:95], a[88:91], a[44:47], v[92:95]
    ds_read_b128 a[24:27], v47 offset:9216
    v_mfma_f32_16x16x32_bf16 v[104:107], a[88:91], a[48:51], v[104:107]
    buffer_load_dwordx4 a[132:135], v3, s[12:15], s29 offen offset:1024 sc1
    s_waitcnt vmcnt(15)
    s_waitcnt lgkmcnt(0)
    s_barrier
    v_mfma_f32_16x16x32_bf16 v[56:59], a[92:95], a[60:63], v[56:59]
    ds_read_b128 a[36:39], v40 offset:18432
    ds_read_b128 a[52:55], v27 offset:57344
    v_lshlrev_b32 v128, 3, v36
    v_mfma_f32_16x16x32_bf16 v[112:115], a[92:95], a[0:3], v[112:115]
    v_add_u32 v128, 160768, v128
    v_mfma_f32_16x16x32_bf16 v[108:111], a[76:79], a[60:63], v[108:111]
    ds_read_b64 v[132:133], v128
    v_mfma_f32_16x16x32_bf16 v[116:119], a[76:79], a[0:3], v[116:119]
    v_lshlrev_b32_e64 v129, 3, v37
    v_mfma_f32_16x16x32_bf16 v[60:63], a[92:95], a[64:67], v[60:63]
    ds_read_b128 a[40:43], v42 offset:18432
    ds_read_b128 a[44:47], v44 offset:18432
    v_add_u32 v129, 160768, v129
    v_mfma_f32_16x16x32_bf16 v[92:95], a[92:95], a[68:71], v[92:95]
    ds_read_b128 a[48:51], v46 offset:18432
    ds_read_b64 v[134:135], v129
    v_mfma_f32_16x16x32_bf16 v[104:107], a[92:95], a[72:75], v[104:107]
    v_lshlrev_b32_e64 v130, 3, v38
    v_mfma_f32_16x16x32_bf16 v[56:59], a[96:99], a[12:15], v[56:59]
    ds_read_b128 a[60:63], v41 offset:18432
    ds_read_b128 a[76:79], v27 offset:58368
    v_add_u32 v130, 160768, v130
    v_mfma_f32_16x16x32_bf16 v[112:115], a[96:99], a[0:3], v[112:115]
    ds_read_b64 v[136:137], v130
    v_mfma_f32_16x16x32_bf16 v[108:111], a[28:31], a[12:15], v[108:111]
    v_lshlrev_b32_e64 v131, 3, v39
    v_mfma_f32_16x16x32_bf16 v[116:119], a[28:31], a[0:3], v[116:119]
    v_add_u32 v131, 160768, v131
    v_mfma_f32_16x16x32_bf16 v[60:63], a[96:99], a[16:19], v[60:63]
    ds_read_b128 a[64:67], v43 offset:18432
    ds_read_b128 a[68:71], v45 offset:18432
    ds_read_b64 v[138:139], v131
    v_mfma_f32_16x16x32_bf16 v[92:95], a[96:99], a[20:23], v[92:95]
    ds_read_b128 a[72:75], v47 offset:18432
    v_mfma_f32_16x16x32_bf16 v[104:107], a[96:99], a[24:27], v[104:107]
    s_waitcnt vmcnt(14) lgkmcnt(8)
    s_nop 0
    v_mfma_f32_16x16x32_bf16 v[56:59], a[100:103], a[36:39], v[56:59]
    ds_read_b128 a[12:15], v40 offset:27648
    ds_read_b128 a[28:31], v27 offset:59392
    v_mfma_f32_16x16x32_bf16 v[112:115], a[100:103], a[0:3], v[112:115]
    v_mfma_f32_16x16x32_bf16 v[108:111], a[52:55], a[36:39], v[108:111]
    v_mfma_f32_16x16x32_bf16 v[116:119], a[52:55], a[0:3], v[116:119]
    s_waitcnt lgkmcnt(3)
    s_nop 0
    v_mfma_f32_16x16x32_bf16 v[60:63], a[100:103], a[40:43], v[60:63]
    ds_read_b128 a[16:19], v42 offset:27648
    ds_read_b128 a[20:23], v44 offset:27648
    v_mfma_f32_16x16x32_bf16 v[92:95], a[100:103], a[44:47], v[92:95]
    ds_read_b128 a[24:27], v46 offset:27648
    v_mfma_f32_16x16x32_bf16 v[104:107], a[100:103], a[48:51], v[104:107]
    s_waitcnt vmcnt(13) lgkmcnt(5)
    s_nop 0
    v_mfma_f32_16x16x32_bf16 v[56:59], a[104:107], a[60:63], v[56:59]
    ds_read_b128 a[36:39], v41 offset:27648
    ds_read_b128 a[52:55], v27 offset:60416
    v_mfma_f32_16x16x32_bf16 v[112:115], a[104:107], a[0:3], v[112:115]
    v_mfma_f32_16x16x32_bf16 v[108:111], a[76:79], a[60:63], v[108:111]
    v_mfma_f32_16x16x32_bf16 v[116:119], a[76:79], a[0:3], v[116:119]
    v_mfma_f32_16x16x32_bf16 v[60:63], a[104:107], a[64:67], v[60:63]
    ds_read_b128 a[40:43], v43 offset:27648
    ds_read_b128 a[44:47], v45 offset:27648
    v_mfma_f32_16x16x32_bf16 v[92:95], a[104:107], a[68:71], v[92:95]
    ds_read_b128 a[48:51], v47 offset:27648
    v_mfma_f32_16x16x32_bf16 v[104:107], a[104:107], a[72:75], v[104:107]
    buffer_load_dwordx4 a[88:91], v3, s[12:15], s29 offen offset:2048 sc1
    buffer_load_dwordx4 a[92:95], v3, s[12:15], s29 offen offset:3072 sc1
    s_add_u32 m0, s61, 151552
    s_add_u32 s56, s17, 1146880
    buffer_load_dwordx4 v3, s[12:15], s56 offen sc1 lds
    s_waitcnt vmcnt(12)
    s_add_u32 s18, s16, 1064960
    buffer_load_dwordx4 a[96:99], v3, s[12:15], s18 offen offset:0 sc1
    s_waitcnt vmcnt(11)
    s_waitcnt lgkmcnt(0)
    s_barrier
    v_mfma_f32_16x16x32_bf16 v[56:59], a[108:111], a[12:15], v[56:59]
    s_lshl_b32 s69, s44, 7
    s_add_u32 s69, s69, s45
    s_lshl_b32 s69, s69, 4
    s_add_u32 s69, s69, 8192
    s_add_u32 s69, s69, s60
    s_mov_b64 exec, 1
    buffer_store_dword v23, v24, s[12:15], s69 offen sc1
    s_mov_b64 exec, -1
    ds_read_b128 a[60:63], v40 offset:36864
    ds_read_b128 a[76:79], v27 offset:53248
    v_mfma_f32_16x16x32_bf16 v[112:115], a[108:111], a[0:3], v[112:115]
    v_mfma_f32_16x16x32_bf16 v[108:111], a[28:31], a[12:15], v[108:111]
    v_mfma_f32_16x16x32_bf16 v[116:119], a[28:31], a[0:3], v[116:119]
    v_mfma_f32_16x16x32_bf16 v[60:63], a[108:111], a[16:19], v[60:63]
    ds_read_b128 a[64:67], v42 offset:36864
    ds_read_b128 a[68:71], v44 offset:36864
    v_mfma_f32_16x16x32_bf16 v[92:95], a[108:111], a[20:23], v[92:95]
    ds_read_b128 a[72:75], v46 offset:36864
    v_mfma_f32_16x16x32_bf16 v[104:107], a[108:111], a[24:27], v[104:107]
    v_mfma_f32_16x16x32_bf16 v[56:59], a[112:115], a[36:39], v[56:59]
    ds_read_b128 a[12:15], v41 offset:36864
    ds_read_b128 a[28:31], v27 offset:54272
    v_mfma_f32_16x16x32_bf16 v[112:115], a[112:115], a[0:3], v[112:115]
    v_mfma_f32_16x16x32_bf16 v[108:111], a[52:55], a[36:39], v[108:111]
    buffer_load_dwordx4 a[100:103], v3, s[12:15], s18 offen offset:1024 sc1
    v_mfma_f32_16x16x32_bf16 v[116:119], a[52:55], a[0:3], v[116:119]
    v_mfma_f32_16x16x32_bf16 v[60:63], a[112:115], a[40:43], v[60:63]
    ds_read_b128 a[16:19], v43 offset:36864
    ds_read_b128 a[20:23], v45 offset:36864
    v_mfma_f32_16x16x32_bf16 v[92:95], a[112:115], a[44:47], v[92:95]
    ds_read_b128 a[24:27], v47 offset:36864
    v_mfma_f32_16x16x32_bf16 v[104:107], a[112:115], a[48:51], v[104:107]
    s_waitcnt vmcnt(12) lgkmcnt(5)
    s_nop 0
    v_mfma_f32_16x16x32_bf16 v[56:59], a[116:119], a[60:63], v[56:59]
    ds_read_b128 a[36:39], v40 offset:46080
    ds_read_b128 a[52:55], v27 offset:55296
    v_mfma_f32_16x16x32_bf16 v[112:115], a[116:119], a[0:3], v[112:115]
    buffer_load_dwordx4 a[104:107], v3, s[12:15], s18 offen offset:2048 sc1
    v_mfma_f32_16x16x32_bf16 v[108:111], a[76:79], a[60:63], v[108:111]
    v_mfma_f32_16x16x32_bf16 v[116:119], a[76:79], a[0:3], v[116:119]
    v_mfma_f32_16x16x32_bf16 v[60:63], a[116:119], a[64:67], v[60:63]
    ds_read_b128 a[40:43], v42 offset:46080
    ds_read_b128 a[44:47], v44 offset:46080
    v_mfma_f32_16x16x32_bf16 v[92:95], a[116:119], a[68:71], v[92:95]
    ds_read_b128 a[48:51], v46 offset:46080
    v_mfma_f32_16x16x32_bf16 v[104:107], a[116:119], a[72:75], v[104:107]
    buffer_load_dwordx4 a[108:111], v3, s[12:15], s18 offen offset:3072 sc1
    s_waitcnt vmcnt(13) lgkmcnt(5)
    s_nop 0
    v_mfma_f32_16x16x32_bf16 v[56:59], a[120:123], a[12:15], v[56:59]
    ds_read_b128 a[60:63], v41 offset:46080
    ds_read_b128 a[76:79], v27 offset:56320
    v_mfma_f32_16x16x32_bf16 v[112:115], a[120:123], a[0:3], v[112:115]
    v_mfma_f32_16x16x32_bf16 v[108:111], a[28:31], a[12:15], v[108:111]
    s_add_u32 m0, s61, 147456
    s_add_u32 s56, s17, 1949696
    buffer_load_dwordx4 v3, s[12:15], s56 offen sc1 lds
    v_mfma_f32_16x16x32_bf16 v[116:119], a[28:31], a[0:3], v[116:119]
    v_mfma_f32_16x16x32_bf16 v[60:63], a[120:123], a[16:19], v[60:63]
    ds_read_b128 a[64:67], v43 offset:46080
    ds_read_b128 a[68:71], v45 offset:46080
    v_mfma_f32_16x16x32_bf16 v[92:95], a[120:123], a[20:23], v[92:95]
    ds_read_b128 a[72:75], v47 offset:46080
    v_mfma_f32_16x16x32_bf16 v[104:107], a[120:123], a[24:27], v[104:107]
    s_waitcnt vmcnt(11)
    s_waitcnt lgkmcnt(0)
    s_barrier
    s_nop 0
    v_add_u32 v40, 55296, v40
    v_add_u32 v41, 55296, v41
    v_add_u32 v42, 55296, v42
    v_add_u32 v43, 55296, v43
    v_add_u32 v44, 55296, v44
    v_add_u32 v45, 55296, v45
    v_add_u32 v46, 55296, v46
    v_add_u32 v47, 55296, v47
    v_mfma_f32_16x16x32_bf16 v[56:59], a[124:127], a[36:39], v[56:59]
    ds_read_b128 a[12:15], v40 offset:0
    ds_read_b128 a[28:31], v27 offset:49152
    v_mfma_f32_16x16x32_bf16 v[112:115], a[124:127], a[0:3], v[112:115]
    s_add_u32 m0, s61, 143360
    s_add_u32 s56, s17, 2768896
    buffer_load_dwordx4 v3, s[12:15], s56 offen sc1 lds
    v_mfma_f32_16x16x32_bf16 v[108:111], a[52:55], a[36:39], v[108:111]
    v_mfma_f32_16x16x32_bf16 v[116:119], a[52:55], a[0:3], v[116:119]
    s_add_u32 s29, s16, 1867776
    buffer_load_dwordx4 a[112:115], v3, s[12:15], s29 offen offset:0 sc1
    v_mfma_f32_16x16x32_bf16 v[60:63], a[124:127], a[40:43], v[60:63]
    ds_read_b128 a[16:19], v42 offset:0
    ds_read_b128 a[20:23], v44 offset:0
    v_mfma_f32_16x16x32_bf16 v[92:95], a[124:127], a[44:47], v[92:95]
    ds_read_b128 a[24:27], v46 offset:0
    v_mfma_f32_16x16x32_bf16 v[104:107], a[124:127], a[48:51], v[104:107]
    s_add_u32 s18, s16, 2686976
    buffer_load_dwordx4 a[116:119], v3, s[12:15], s18 offen offset:0 sc1
    v_mfma_f32_16x16x32_bf16 v[56:59], a[128:131], a[60:63], v[56:59]
    ds_read_b128 a[36:39], v41 offset:0
    ds_read_b128 a[52:55], v27 offset:50176
    v_mfma_f32_16x16x32_bf16 v[112:115], a[128:131], a[0:3], v[112:115]
    buffer_load_dwordx4 a[120:123], v3, s[12:15], s29 offen offset:1024 sc1
    v_mfma_f32_16x16x32_bf16 v[108:111], a[76:79], a[60:63], v[108:111]
    v_mfma_f32_16x16x32_bf16 v[116:119], a[76:79], a[0:3], v[116:119]
    v_mfma_f32_16x16x32_bf16 v[60:63], a[128:131], a[64:67], v[60:63]
    ds_read_b128 a[40:43], v43 offset:0
    ds_read_b128 a[44:47], v45 offset:0
    v_mfma_f32_16x16x32_bf16 v[92:95], a[128:131], a[68:71], v[92:95]
    ds_read_b128 a[48:51], v47 offset:0
    v_mfma_f32_16x16x32_bf16 v[104:107], a[128:131], a[72:75], v[104:107]
    buffer_load_dwordx4 a[124:127], v3, s[12:15], s18 offen offset:1024 sc1
    s_waitcnt vmcnt(15) lgkmcnt(5)
    s_nop 0
    v_mfma_f32_16x16x32_bf16 v[56:59], a[84:87], a[12:15], v[56:59]
    ds_read_b128 a[60:63], v40 offset:9216
    ds_read_b128 a[76:79], v27 offset:51200
    v_mfma_f32_16x16x32_bf16 v[112:115], a[84:87], a[0:3], v[112:115]
    v_mfma_f32_16x16x32_bf16 v[108:111], a[28:31], a[12:15], v[108:111]
    v_mfma_f32_16x16x32_bf16 v[116:119], a[28:31], a[0:3], v[116:119]
    buffer_load_dwordx4 a[128:131], v3, s[12:15], s29 offen offset:2048 sc1
    v_mfma_f32_16x16x32_bf16 v[60:63], a[84:87], a[16:19], v[60:63]
    ds_read_b128 a[64:67], v42 offset:9216
    ds_read_b128 a[68:71], v44 offset:9216
    v_mfma_f32_16x16x32_bf16 v[92:95], a[84:87], a[20:23], v[92:95]
    ds_read_b128 a[72:75], v46 offset:9216
    v_mfma_f32_16x16x32_bf16 v[104:107], a[84:87], a[24:27], v[104:107]
    s_waitcnt vmcnt(15) lgkmcnt(5)
    s_nop 0
    v_mfma_f32_16x16x32_bf16 v[56:59], a[132:135], a[36:39], v[56:59]
    ds_read_b128 a[12:15], v41 offset:9216
    ds_read_b128 a[28:31], v27 offset:52224
    v_mfma_f32_16x16x32_bf16 v[112:115], a[132:135], a[0:3], v[112:115]
    buffer_load_dwordx4 a[84:87], v3, s[12:15], s18 offen offset:2048 sc1
    v_mfma_f32_16x16x32_bf16 v[108:111], a[52:55], a[36:39], v[108:111]
    v_mfma_f32_16x16x32_bf16 v[116:119], a[52:55], a[0:3], v[116:119]
    v_mfma_f32_16x16x32_bf16 v[60:63], a[132:135], a[40:43], v[60:63]
    ds_read_b128 a[16:19], v43 offset:9216
    ds_read_b128 a[20:23], v45 offset:9216
    v_mfma_f32_16x16x32_bf16 v[92:95], a[132:135], a[44:47], v[92:95]
    ds_read_b128 a[24:27], v47 offset:9216
    v_mfma_f32_16x16x32_bf16 v[104:107], a[132:135], a[48:51], v[104:107]
    buffer_load_dwordx4 a[136:139], v3, s[12:15], s29 offen offset:3072 sc1
    s_waitcnt vmcnt(14)
    s_waitcnt lgkmcnt(0)
    s_barrier
    s_nop 0
    v_mfma_f32_16x16x32_bf16 v[56:59], a[88:91], a[60:63], v[56:59]
    ds_read_b128 a[36:39], v40 offset:18432
    ds_read_b128 a[52:55], v27 offset:61440
    v_mfma_f32_16x16x32_bf16 v[112:115], a[88:91], a[0:3], v[112:115]
    buffer_load_dwordx4 a[132:135], v3, s[12:15], s18 offen offset:3072 sc1
    v_mfma_f32_16x16x32_bf16 v[108:111], a[76:79], a[60:63], v[108:111]
    v_mfma_f32_16x16x32_bf16 v[116:119], a[76:79], a[0:3], v[116:119]
    v_mfma_f32_16x16x32_bf16 v[60:63], a[88:91], a[64:67], v[60:63]
    ds_read_b128 a[40:43], v42 offset:18432
    ds_read_b128 a[44:47], v44 offset:18432
    v_mfma_f32_16x16x32_bf16 v[92:95], a[88:91], a[68:71], v[92:95]
    ds_read_b128 a[48:51], v46 offset:18432
    v_mfma_f32_16x16x32_bf16 v[104:107], a[88:91], a[72:75], v[104:107]
    v_mfma_f32_16x16x32_bf16 v[56:59], a[92:95], a[12:15], v[56:59]
    ds_read_b128 a[60:63], v41 offset:18432
    ds_read_b128 a[76:79], v27 offset:62464
    v_mfma_f32_16x16x32_bf16 v[112:115], a[92:95], a[0:3], v[112:115]
    s_add_u32 m0, s61, 139264
    s_add_u32 s56, s17, 1953792
    buffer_load_dwordx4 v3, s[12:15], s56 offen sc1 lds
    v_mfma_f32_16x16x32_bf16 v[108:111], a[28:31], a[12:15], v[108:111]
    v_mfma_f32_16x16x32_bf16 v[116:119], a[28:31], a[0:3], v[116:119]
    v_mfma_f32_16x16x32_bf16 v[60:63], a[92:95], a[16:19], v[60:63]
    ds_read_b128 a[64:67], v43 offset:18432
    ds_read_b128 a[68:71], v45 offset:18432
    v_mfma_f32_16x16x32_bf16 v[92:95], a[92:95], a[20:23], v[92:95]
    ds_read_b128 a[72:75], v47 offset:18432
    v_mfma_f32_16x16x32_bf16 v[104:107], a[92:95], a[24:27], v[104:107]
    s_add_u32 m0, s61, 135168
    s_add_u32 s56, s17, 2772992
    buffer_load_dwordx4 v3, s[12:15], s56 offen sc1 lds
    s_waitcnt vmcnt(16) lgkmcnt(5)
    s_nop 0
    v_mfma_f32_16x16x32_bf16 v[56:59], a[96:99], a[36:39], v[56:59]
    ds_read_b128 a[12:15], v40 offset:27648
    ds_read_b128 a[28:31], v27 offset:63488
    v_mfma_f32_16x16x32_bf16 v[112:115], a[96:99], a[0:3], v[112:115]
    s_add_u32 s29, s16, 1871872
    buffer_load_dwordx4 a[88:91], v3, s[12:15], s29 offen offset:0 sc1
    v_mfma_f32_16x16x32_bf16 v[108:111], a[52:55], a[36:39], v[108:111]
    v_mfma_f32_16x16x32_bf16 v[116:119], a[52:55], a[0:3], v[116:119]
    v_mfma_f32_16x16x32_bf16 v[60:63], a[96:99], a[40:43], v[60:63]
    ds_read_b128 a[16:19], v42 offset:27648
    ds_read_b128 a[20:23], v44 offset:27648
    v_mfma_f32_16x16x32_bf16 v[92:95], a[96:99], a[44:47], v[92:95]
    ds_read_b128 a[24:27], v46 offset:27648
    v_mfma_f32_16x16x32_bf16 v[104:107], a[96:99], a[48:51], v[104:107]
    s_add_u32 s18, s16, 2691072
    buffer_load_dwordx4 a[92:95], v3, s[12:15], s18 offen offset:0 sc1
    s_waitcnt vmcnt(16) lgkmcnt(5)
    s_nop 0
    v_mfma_f32_16x16x32_bf16 v[56:59], a[100:103], a[60:63], v[56:59]
    ds_read_b128 a[36:39], v41 offset:27648
    ds_read_b128 a[52:55], v27 offset:64512
    v_mfma_f32_16x16x32_bf16 v[112:115], a[100:103], a[0:3], v[112:115]
    v_mfma_f32_16x16x32_bf16 v[108:111], a[76:79], a[60:63], v[108:111]
    v_mfma_f32_16x16x32_bf16 v[116:119], a[76:79], a[0:3], v[116:119]
    buffer_load_dwordx4 a[96:99], v3, s[12:15], s29 offen offset:1024 sc1
    v_mfma_f32_16x16x32_bf16 v[60:63], a[100:103], a[64:67], v[60:63]
    ds_read_b128 a[40:43], v43 offset:27648
    ds_read_b128 a[44:47], v45 offset:27648
    v_mfma_f32_16x16x32_bf16 v[92:95], a[100:103], a[68:71], v[92:95]
    ds_read_b128 a[48:51], v47 offset:27648
    v_mfma_f32_16x16x32_bf16 v[104:107], a[100:103], a[72:75], v[104:107]
    s_waitcnt vmcnt(16) lgkmcnt(5)
    s_nop 0
    v_mfma_f32_16x16x32_bf16 v[56:59], a[104:107], a[12:15], v[56:59]
    v_mfma_f32_16x16x32_bf16 v[112:115], a[104:107], a[0:3], v[112:115]
    buffer_load_dwordx4 a[100:103], v3, s[12:15], s18 offen offset:1024 sc1
    v_mfma_f32_16x16x32_bf16 v[108:111], a[28:31], a[12:15], v[108:111]
    v_mfma_f32_16x16x32_bf16 v[116:119], a[28:31], a[0:3], v[116:119]
    v_mfma_f32_16x16x32_bf16 v[60:63], a[104:107], a[16:19], v[60:63]
    v_mfma_f32_16x16x32_bf16 v[92:95], a[104:107], a[20:23], v[92:95]
    v_mfma_f32_16x16x32_bf16 v[104:107], a[104:107], a[24:27], v[104:107]
    buffer_load_dwordx4 a[140:143], v3, s[12:15], s29 offen offset:2048 sc1
    s_waitcnt vmcnt(17) lgkmcnt(0)
    s_nop 0
    v_mfma_f32_16x16x32_bf16 v[56:59], a[108:111], a[36:39], v[56:59]
    v_mfma_f32_16x16x32_bf16 v[112:115], a[108:111], a[0:3], v[112:115]
    v_mfma_f32_16x16x32_bf16 v[108:111], a[52:55], a[36:39], v[108:111]
    v_mfma_f32_16x16x32_bf16 v[116:119], a[52:55], a[0:3], v[116:119]
    buffer_load_dwordx4 a[104:107], v3, s[12:15], s18 offen offset:2048 sc1
    v_mfma_f32_16x16x32_bf16 v[60:63], a[108:111], a[40:43], v[60:63]
    v_mfma_f32_16x16x32_bf16 v[92:95], a[108:111], a[44:47], v[92:95]
    v_mfma_f32_16x16x32_bf16 v[104:107], a[108:111], a[48:51], v[104:107]
    s_nop 1
    s_nop 0
    v_fma_f32 v56, v112, v132, v56
    v_fma_f32 v57, v113, v132, v57
    v_fma_f32 v58, v114, v132, v58
    v_fma_f32 v59, v115, v132, v59
    v_fma_f32 v60, v112, v134, v60
    v_fma_f32 v61, v113, v134, v61
    v_fma_f32 v62, v114, v134, v62
    v_fma_f32 v63, v115, v134, v63
    v_fma_f32 v92, v112, v136, v92
    v_fma_f32 v93, v113, v136, v93
    v_fma_f32 v94, v114, v136, v94
    v_fma_f32 v95, v115, v136, v95
    v_pk_fma_f32 v[104:105], v[112:113], v[138:139], v[104:105] op_sel_hi:[1,0,1]
    buffer_load_dwordx4 a[108:111], v3, s[12:15], s29 offen offset:3072 sc1
    v_pk_fma_f32 v[106:107], v[114:115], v[138:139], v[106:107] op_sel_hi:[1,0,1]
    v_pk_fma_f32 v[108:109], v[116:117], v[132:133], v[108:109] op_sel_hi:[1,0,1]
    v_pk_fma_f32 v[110:111], v[118:119], v[132:133], v[110:111] op_sel_hi:[1,0,1]
    v_pk_mul_f32 v[56:57], v[56:57], v[132:133] op_sel:[0,1] op_sel_hi:[1,1]
    v_pk_mul_f32 v[58:59], v[58:59], v[132:133] op_sel:[0,1] op_sel_hi:[1,1]
    v_pk_mul_f32 v[60:61], v[60:61], v[134:135] op_sel:[0,1] op_sel_hi:[1,1]
    v_pk_mul_f32 v[62:63], v[62:63], v[134:135] op_sel:[0,1] op_sel_hi:[1,1]
    v_pk_mul_f32 v[92:93], v[92:93], v[136:137] op_sel:[0,1] op_sel_hi:[1,1]
    v_pk_mul_f32 v[40:41], v[56:57], v[56:57]
    v_pk_mul_f32 v[42:43], v[58:59], v[58:59]
    v_pk_mul_f32 v[44:45], v[60:61], v[60:61]
    v_pk_mul_f32 v[46:47], v[62:63], v[62:63]
    v_pk_mul_f32 v[120:121], v[92:93], v[92:93]
    v_pk_fma_f32 v[40:41], v[40:41], s[40:41], v[66:67]
    v_pk_fma_f32 v[42:43], v[42:43], s[40:41], v[66:67]
    v_pk_fma_f32 v[44:45], v[44:45], s[40:41], v[66:67]
    buffer_load_dwordx4 a[144:147], v3, s[12:15], s18 offen offset:3072 sc1
    v_pk_fma_f32 v[46:47], v[46:47], s[40:41], v[66:67]
    v_pk_fma_f32 v[120:121], v[120:121], s[40:41], v[66:67]
    v_pk_mul_f32 v[40:41], v[40:41], v[56:57]
    v_pk_mul_f32 v[42:43], v[42:43], v[58:59]
    v_pk_mul_f32 v[44:45], v[44:45], v[60:61]
    v_pk_mul_f32 v[46:47], v[46:47], v[62:63]
    v_pk_mul_f32 v[120:121], v[120:121], v[92:93]
    v_exp_f32 v40, v40
    v_exp_f32 v41, v41
    v_exp_f32 v42, v42
    v_exp_f32 v43, v43
    v_exp_f32_e64 v44, v44
    s_add_u32 m0, s61, 131072
    s_add_u32 s56, s17, 1957888
    buffer_load_dwordx4 v3, s[12:15], s56 offen sc1 lds
    v_exp_f32 v45, v45
    v_exp_f32 v46, v46
    v_exp_f32 v47, v47
    v_exp_f32 v120, v120
    v_exp_f32_e64 v121, v121
    v_pk_add_f32 v[40:41], v[40:41], 1.0 op_sel_hi:[1,0]
    v_pk_add_f32 v[42:43], v[42:43], 1.0 op_sel_hi:[1,0]
    v_pk_add_f32 v[44:45], v[44:45], 1.0 op_sel_hi:[1,0]
    v_pk_add_f32 v[46:47], v[46:47], 1.0 op_sel_hi:[1,0]
    s_add_u32 m0, s61, 126976
    s_add_u32 s56, s17, 2777088
    buffer_load_dwordx4 v3, s[12:15], s56 offen sc1 lds
    v_pk_add_f32 v[120:121], v[120:121], 1.0 op_sel_hi:[1,0]
    v_rcp_f32 v40, v40
    v_rcp_f32 v41, v41
    v_rcp_f32 v42, v42
    v_rcp_f32 v43, v43
    v_rcp_f32 v44, v44
    v_rcp_f32 v45, v45
    v_rcp_f32_e64 v46, v46
    s_add_u32 s29, s16, 1875968
    buffer_load_dwordx4 a[148:151], v3, s[12:15], s29 offen offset:0 sc1
    v_rcp_f32 v47, v47
    v_rcp_f32 v120, v120
    v_rcp_f32_e64 v121, v121
    v_pk_mul_f32 v[56:57], v[56:57], v[40:41]
    v_pk_mul_f32 v[58:59], v[58:59], v[42:43]
    v_pk_mul_f32 v[60:61], v[60:61], v[44:45]
    v_pk_mul_f32 v[62:63], v[62:63], v[46:47]
    v_pk_mul_f32 v[92:93], v[92:93], v[120:121]
    v_cvt_pk_bf16_f32 v56, v56, v57
    v_cvt_pk_bf16_f32 v57, v58, v59
    v_cvt_pk_bf16_f32 v58, v60, v61
    s_add_u32 s18, s16, 2695168
    buffer_load_dwordx4 a[152:155], v3, s[12:15], s18 offen offset:0 sc1
    v_cvt_pk_bf16_f32 v59, v62, v63
    v_cvt_pk_bf16_f32 v60, v92, v93
    v_pk_mul_f32 v[94:95], v[94:95], v[136:137] op_sel:[0,1] op_sel_hi:[1,1]
    v_pk_mul_f32 v[104:105], v[104:105], v[138:139] op_sel:[0,1] op_sel_hi:[1,1]
    v_pk_mul_f32 v[106:107], v[106:107], v[138:139] op_sel:[0,1] op_sel_hi:[1,1]
    v_pk_mul_f32 v[108:109], v[108:109], v[132:133] op_sel:[0,1] op_sel_hi:[1,1]
    v_pk_mul_f32 v[110:111], v[110:111], v[132:133] op_sel:[0,1] op_sel_hi:[1,1]
    v_pk_mul_f32 v[40:41], v[94:95], v[94:95]
    v_pk_mul_f32 v[42:43], v[104:105], v[104:105]
    v_pk_mul_f32 v[44:45], v[106:107], v[106:107]
    v_pk_mul_f32 v[46:47], v[108:109], v[108:109]
    v_pk_mul_f32 v[120:121], v[110:111], v[110:111]
    v_pk_fma_f32 v[40:41], v[40:41], s[40:41], v[66:67]
    v_pk_fma_f32 v[42:43], v[42:43], s[40:41], v[66:67]
    v_pk_fma_f32 v[44:45], v[44:45], s[40:41], v[66:67]
    buffer_load_dwordx4 a[156:159], v3, s[12:15], s29 offen offset:1024 sc1
    v_pk_fma_f32 v[46:47], v[46:47], s[40:41], v[66:67]
    v_pk_fma_f32 v[120:121], v[120:121], s[40:41], v[66:67]
    v_pk_mul_f32 v[40:41], v[40:41], v[94:95]
    v_pk_mul_f32 v[42:43], v[42:43], v[104:105]
    v_pk_mul_f32 v[44:45], v[44:45], v[106:107]
    v_pk_mul_f32 v[46:47], v[46:47], v[108:109]
    v_pk_mul_f32 v[120:121], v[120:121], v[110:111]
    v_exp_f32 v40, v40
    v_exp_f32 v41, v41
    v_exp_f32 v42, v42
    v_exp_f32 v43, v43
    v_exp_f32 v44, v44
    buffer_load_dwordx4 a[160:163], v3, s[12:15], s18 offen offset:1024 sc1
    v_exp_f32 v45, v45
    v_exp_f32 v46, v46
    v_exp_f32 v47, v47
    v_exp_f32 v120, v120
    v_exp_f32 v121, v121
    v_pk_add_f32 v[40:41], v[40:41], 1.0 op_sel_hi:[1,0]
    v_pk_add_f32 v[42:43], v[42:43], 1.0 op_sel_hi:[1,0]
    v_pk_add_f32 v[44:45], v[44:45], 1.0 op_sel_hi:[1,0]
    v_pk_add_f32 v[46:47], v[46:47], 1.0 op_sel_hi:[1,0]
    v_pk_add_f32 v[120:121], v[120:121], 1.0 op_sel_hi:[1,0]
    v_rcp_f32 v40, v40
    v_rcp_f32 v41, v41
    v_rcp_f32 v42, v42
    v_rcp_f32 v43, v43
    v_rcp_f32 v44, v44
    v_rcp_f32 v45, v45
    buffer_load_dwordx4 a[164:167], v3, s[12:15], s29 offen offset:2048 sc1
    v_rcp_f32 v46, v46
    v_rcp_f32 v47, v47
    v_rcp_f32 v120, v120
    v_rcp_f32 v121, v121
    v_pk_mul_f32 v[94:95], v[94:95], v[40:41]
    v_pk_mul_f32 v[104:105], v[104:105], v[42:43]
    v_pk_mul_f32 v[106:107], v[106:107], v[44:45]
    v_pk_mul_f32 v[108:109], v[108:109], v[46:47]
    v_pk_mul_f32 v[110:111], v[110:111], v[120:121]
    v_cvt_pk_bf16_f32 v61, v94, v95
    v_cvt_pk_bf16_f32 v62, v104, v105
    buffer_load_dwordx4 a[168:171], v3, s[12:15], s18 offen offset:2048 sc1
    v_cvt_pk_bf16_f32 v63, v106, v107
    v_cvt_pk_bf16_f32 v92, v108, v109
    v_cvt_pk_bf16_f32 v93, v110, v111
    v_mov_b32 v94, v92
    v_mov_b32 v95, v93
    s_add_u32 s30, s23, 9895936
    v_permlane16_swap_b32 v56, v58
    v_permlane16_swap_b32 v57, v59
    v_permlane16_swap_b32 v60, v62
    v_permlane16_swap_b32 v61, v63
    v_permlane16_swap_b32 v92, v94
    v_permlane16_swap_b32 v93, v95
    buffer_store_dwordx4 v[56:59], v64, s[12:15], s30 offen sc1
    buffer_store_dwordx4 v[60:63], v65, s[12:15], s30 offen sc1
    buffer_store_dwordx4 v[92:95], v25, s[12:15], s30 offen sc1
    s_nop 1
    s_waitcnt vmcnt(19)
    s_barrier
    s_nop 0
    ds_read_b128 a[12:15], v48 offset:0
    ds_read_b128 a[28:31], v27 offset:57344
    ds_read_b128 a[32:35], v27 offset:53248
    ds_read_b128 a[16:19], v50 offset:0
    ds_read_b128 a[20:23], v52 offset:0
    ds_read_b128 a[24:27], v54 offset:0
    ds_read_b128 a[36:39], v49 offset:0
    ds_read_b128 a[52:55], v27 offset:58368
    ds_read_b128 a[56:59], v27 offset:54272
    ds_read_b128 a[40:43], v51 offset:0
    ds_read_b128 a[44:47], v53 offset:0
    ds_read_b128 a[48:51], v55 offset:0
    s_waitcnt lgkmcnt(11)
    v_mfma_f32_16x16x32_bf16 v[40:43], a[112:115], a[12:15], 0
    ds_read_b128 a[60:63], v48 offset:9216
    v_mfma_f32_16x16x32_bf16 v[104:107], a[116:119], a[12:15], 0
    buffer_load_dwordx4 a[172:175], v3, s[12:15], s29 offen offset:3072 sc1
    s_waitcnt lgkmcnt(11)
    v_mfma_f32_16x16x32_bf16 v[92:95], a[28:31], a[12:15], 0
    ds_read_b128 a[76:79], v27 offset:59392
    s_waitcnt lgkmcnt(11)
    v_mfma_f32_16x16x32_bf16 v[120:123], a[32:35], a[12:15], 0
    ds_read_b128 a[80:83], v27 offset:55296
    s_waitcnt lgkmcnt(11)
    v_mfma_f32_16x16x32_bf16 v[44:47], a[112:115], a[16:19], 0
    ds_read_b128 a[64:67], v50 offset:9216
    v_mfma_f32_16x16x32_bf16 v[108:111], a[116:119], a[16:19], 0
    buffer_load_dwordx4 a[176:179], v3, s[12:15], s18 offen offset:3072 sc1
    s_waitcnt lgkmcnt(11)
    v_mfma_f32_16x16x32_bf16 v[56:59], a[112:115], a[20:23], 0
    ds_read_b128 a[68:71], v52 offset:9216
    v_mfma_f32_16x16x32_bf16 v[112:115], a[116:119], a[20:23], 0
    s_add_u32 m0, s61, 102400
    s_nop 0
    buffer_load_dwordx4 v16, s[24:27], 0 offen nt lds
    s_waitcnt lgkmcnt(11)
    v_mfma_f32_16x16x32_bf16 v[60:63], a[112:115], a[24:27], 0
    ds_read_b128 a[72:75], v54 offset:9216
    v_mfma_f32_16x16x32_bf16 v[116:119], a[116:119], a[24:27], 0
    s_add_u32 m0, s61, 106496
    s_nop 0
    buffer_load_dwordx4 v17, s[24:27], 0 offen nt lds
    s_waitcnt lgkmcnt(6)
    v_mfma_f32_16x16x32_bf16 v[40:43], a[120:123], a[36:39], v[40:43]
    ds_read_b128 a[12:15], v49 offset:9216
    v_mfma_f32_16x16x32_bf16 v[104:107], a[124:127], a[36:39], v[104:107]
    s_add_u32 m0, s61, 110592
    s_nop 0
    buffer_load_dwordx4 v18, s[24:27], 0 offen nt lds
    v_mfma_f32_16x16x32_bf16 v[92:95], a[52:55], a[36:39], v[92:95]
    ds_read_b128 a[28:31], v27 offset:60416
    v_mfma_f32_16x16x32_bf16 v[120:123], a[56:59], a[36:39], v[120:123]
    ds_read_b128 a[32:35], v27 offset:56320
    v_mfma_f32_16x16x32_bf16 v[44:47], a[120:123], a[40:43], v[44:47]
    ds_read_b128 a[16:19], v51 offset:9216
    v_mfma_f32_16x16x32_bf16 v[108:111], a[124:127], a[40:43], v[108:111]
    s_add_u32 m0, s61, 114688
    s_nop 0
    s_nop 0
    buffer_load_dwordx4 v72, s[8:11], 0 offen nt lds
    v_mfma_f32_16x16x32_bf16 v[56:59], a[120:123], a[44:47], v[56:59]
    ds_read_b128 a[20:23], v53 offset:9216
    v_mfma_f32_16x16x32_bf16 v[112:115], a[124:127], a[44:47], v[112:115]
    v_mfma_f32_16x16x32_bf16 v[60:63], a[120:123], a[48:51], v[60:63]
    ds_read_b128 a[24:27], v55 offset:9216
    v_mfma_f32_16x16x32_bf16 v[116:119], a[124:127], a[48:51], v[116:119]
    s_waitcnt lgkmcnt(6)
    v_mfma_f32_16x16x32_bf16 v[40:43], a[128:131], a[60:63], v[40:43]
    ds_read_b128 a[36:39], v48 offset:18432
    v_mfma_f32_16x16x32_bf16 v[104:107], a[84:87], a[60:63], v[104:107]
    s_add_u32 m0, s61, 118784
    s_nop 0
    buffer_load_dwordx4 v73, s[8:11], 0 offen nt lds
    v_mfma_f32_16x16x32_bf16 v[92:95], a[76:79], a[60:63], v[92:95]
    s_lshl_b32 s24, s44, 11
    s_nop 0
    s_add_u32 s24, s24, 8192
    buffer_load_dword v16, v3, s[12:15], s24 offen offset:0 sc1
    buffer_load_dword v17, v3, s[12:15], s24 offen offset:1024 sc1
    ds_read_b128 a[52:55], v27 offset:49152
    v_mfma_f32_16x16x32_bf16 v[120:123], a[80:83], a[60:63], v[120:123]
    ds_read_b128 a[56:59], v27 offset:45056
    v_mfma_f32_16x16x32_bf16 v[44:47], a[128:131], a[64:67], v[44:47]
    ds_read_b128 a[40:43], v50 offset:18432
    v_mfma_f32_16x16x32_bf16 v[108:111], a[84:87], a[64:67], v[108:111]
    s_add_u32 m0, s61, 122880
    s_nop 0
    s_nop 0
    buffer_load_dwordx4 v74, s[8:11], 0 offen nt lds
    v_mfma_f32_16x16x32_bf16 v[56:59], a[128:131], a[68:71], v[56:59]
    ds_read_b128 a[44:47], v52 offset:18432
    v_mfma_f32_16x16x32_bf16 v[112:115], a[84:87], a[68:71], v[112:115]
    v_mfma_f32_16x16x32_bf16 v[60:63], a[128:131], a[72:75], v[60:63]
    ds_read_b128 a[48:51], v54 offset:18432
    v_mfma_f32_16x16x32_bf16 v[116:119], a[84:87], a[72:75], v[116:119]
    s_waitcnt lgkmcnt(6)
    s_nop 0
    v_mfma_f32_16x16x32_bf16 v[40:43], a[136:139], a[12:15], v[40:43]
    ds_read_b128 a[60:63], v49 offset:18432
    v_mfma_f32_16x16x32_bf16 v[104:107], a[132:135], a[12:15], v[104:107]
    s_add_u32 m0, s61, 151552
    s_add_u32 s56, s17, 1961984
    buffer_load_dwordx4 v3, s[12:15], s56 offen sc1 lds
    v_mfma_f32_16x16x32_bf16 v[92:95], a[28:31], a[12:15], v[92:95]
    ds_read_b128 a[76:79], v27 offset:50176
    v_mfma_f32_16x16x32_bf16 v[120:123], a[32:35], a[12:15], v[120:123]
    ds_read_b128 a[80:83], v27 offset:46080
    v_mfma_f32_16x16x32_bf16 v[44:47], a[136:139], a[16:19], v[44:47]
    ds_read_b128 a[64:67], v51 offset:18432
    v_mfma_f32_16x16x32_bf16 v[108:111], a[132:135], a[16:19], v[108:111]
    v_mfma_f32_16x16x32_bf16 v[56:59], a[136:139], a[20:23], v[56:59]
    ds_read_b128 a[68:71], v53 offset:18432
    v_mfma_f32_16x16x32_bf16 v[112:115], a[132:135], a[20:23], v[112:115]
    v_mfma_f32_16x16x32_bf16 v[60:63], a[136:139], a[24:27], v[60:63]
    ds_read_b128 a[72:75], v55 offset:18432
    v_mfma_f32_16x16x32_bf16 v[116:119], a[132:135], a[24:27], v[116:119]
    s_waitcnt vmcnt(28) lgkmcnt(6)
    s_nop 0
    v_mfma_f32_16x16x32_bf16 v[40:43], a[88:91], a[36:39], v[40:43]
    ds_read_b128 a[12:15], v48 offset:27648
    v_mfma_f32_16x16x32_bf16 v[104:107], a[92:95], a[36:39], v[104:107]
    v_mfma_f32_16x16x32_bf16 v[92:95], a[52:55], a[36:39], v[92:95]
    ds_read_b128 a[28:31], v27 offset:51200
    v_mfma_f32_16x16x32_bf16 v[120:123], a[56:59], a[36:39], v[120:123]
    ds_read_b128 a[32:35], v27 offset:47104
    v_mfma_f32_16x16x32_bf16 v[44:47], a[88:91], a[40:43], v[44:47]
    ds_read_b128 a[16:19], v50 offset:27648
    v_mfma_f32_16x16x32_bf16 v[108:111], a[92:95], a[40:43], v[108:111]
    v_mfma_f32_16x16x32_bf16 v[56:59], a[88:91], a[44:47], v[56:59]
    ds_read_b128 a[20:23], v52 offset:27648
    v_mfma_f32_16x16x32_bf16 v[112:115], a[92:95], a[44:47], v[112:115]
    v_mfma_f32_16x16x32_bf16 v[60:63], a[88:91], a[48:51], v[60:63]
    ds_read_b128 a[24:27], v54 offset:27648
    v_mfma_f32_16x16x32_bf16 v[116:119], a[92:95], a[48:51], v[116:119]
    s_waitcnt vmcnt(26) lgkmcnt(6)
    s_nop 0
    v_mfma_f32_16x16x32_bf16 v[40:43], a[96:99], a[60:63], v[40:43]
    ds_read_b128 a[36:39], v49 offset:27648
    v_mfma_f32_16x16x32_bf16 v[104:107], a[100:103], a[60:63], v[104:107]
    v_mfma_f32_16x16x32_bf16 v[92:95], a[76:79], a[60:63], v[92:95]
    ds_read_b128 a[52:55], v27 offset:52224
    v_mfma_f32_16x16x32_bf16 v[120:123], a[80:83], a[60:63], v[120:123]
    ds_read_b128 a[56:59], v27 offset:48128
    v_mfma_f32_16x16x32_bf16 v[44:47], a[96:99], a[64:67], v[44:47]
    ds_read_b128 a[40:43], v51 offset:27648
    v_mfma_f32_16x16x32_bf16 v[108:111], a[100:103], a[64:67], v[108:111]
    v_mfma_f32_16x16x32_bf16 v[56:59], a[96:99], a[68:71], v[56:59]
    ds_read_b128 a[44:47], v53 offset:27648
    v_mfma_f32_16x16x32_bf16 v[112:115], a[100:103], a[68:71], v[112:115]
    v_mfma_f32_16x16x32_bf16 v[60:63], a[96:99], a[72:75], v[60:63]
    ds_read_b128 a[48:51], v55 offset:27648
    v_mfma_f32_16x16x32_bf16 v[116:119], a[100:103], a[72:75], v[116:119]
    s_waitcnt vmcnt(20)
    s_waitcnt lgkmcnt(0)
    s_barrier
    v_mfma_f32_16x16x32_bf16 v[40:43], a[140:143], a[12:15], v[40:43]
    ds_read_b128 a[60:63], v48 offset:36864
    v_mfma_f32_16x16x32_bf16 v[104:107], a[104:107], a[12:15], v[104:107]
    s_waitcnt vmcnt(11)
    v_mfma_f32_16x16x32_bf16 v[92:95], a[28:31], a[12:15], v[92:95]
    ds_read_b128 a[76:79], v27 offset:40960
    v_mfma_f32_16x16x32_bf16 v[120:123], a[32:35], a[12:15], v[120:123]
    ds_read_b128 a[80:83], v27 offset:36864
    v_mfma_f32_16x16x32_bf16 v[44:47], a[140:143], a[16:19], v[44:47]
    ds_read_b128 a[64:67], v50 offset:36864
    v_mfma_f32_16x16x32_bf16 v[108:111], a[104:107], a[16:19], v[108:111]
    v_mfma_f32_16x16x32_bf16 v[56:59], a[140:143], a[20:23], v[56:59]
    ds_read_b128 a[68:71], v52 offset:36864
    v_mfma_f32_16x16x32_bf16 v[112:115], a[104:107], a[20:23], v[112:115]
    s_add_u32 m0, s61, 147456
    s_add_u32 s56, s17, 2781184
    buffer_load_dwordx4 v3, s[12:15], s56 offen sc1 lds
    v_mfma_f32_16x16x32_bf16 v[60:63], a[140:143], a[24:27], v[60:63]
    ds_read_b128 a[72:75], v54 offset:36864
    v_mfma_f32_16x16x32_bf16 v[116:119], a[104:107], a[24:27], v[116:119]
    v_mfma_f32_16x16x32_bf16 v[40:43], a[108:111], a[36:39], v[40:43]
    ds_read_b128 a[12:15], v49 offset:36864
    v_mfma_f32_16x16x32_bf16 v[104:107], a[144:147], a[36:39], v[104:107]
    s_add_u32 s29, s16, 1880064
    buffer_load_dwordx4 a[84:87], v3, s[12:15], s29 offen offset:0 sc1
    v_mfma_f32_16x16x32_bf16 v[92:95], a[52:55], a[36:39], v[92:95]
    ds_read_b128 a[28:31], v27 offset:41984
    v_mfma_f32_16x16x32_bf16 v[120:123], a[56:59], a[36:39], v[120:123]
    ds_read_b128 a[32:35], v27 offset:37888
    v_mfma_f32_16x16x32_bf16 v[44:47], a[108:111], a[40:43], v[44:47]
    s_barrier
    s_add_u32 s69, s21, 12288
    s_mov_b64 exec, 1
    buffer_store_dword v23, v24, s[12:15], s69 offen sc1
    s_mov_b64 exec, -1
    s_nop 0
    ds_read_b128 a[16:19], v51 offset:36864
    v_mfma_f32_16x16x32_bf16 v[108:111], a[144:147], a[40:43], v[108:111]
    v_mfma_f32_16x16x32_bf16 v[56:59], a[108:111], a[44:47], v[56:59]
    ds_read_b128 a[20:23], v53 offset:36864
    v_mfma_f32_16x16x32_bf16 v[112:115], a[144:147], a[44:47], v[112:115]
    v_mfma_f32_16x16x32_bf16 v[60:63], a[108:111], a[48:51], v[60:63]
    ds_read_b128 a[24:27], v55 offset:36864
    v_mfma_f32_16x16x32_bf16 v[116:119], a[144:147], a[48:51], v[116:119]
    s_waitcnt lgkmcnt(6)
    s_nop 0
    v_mfma_f32_16x16x32_bf16 v[40:43], a[148:151], a[60:63], v[40:43]
    ds_read_b128 a[36:39], v48 offset:46080
    v_mfma_f32_16x16x32_bf16 v[104:107], a[152:155], a[60:63], v[104:107]
    v_mfma_f32_16x16x32_bf16 v[92:95], a[76:79], a[60:63], v[92:95]
    ds_read_b128 a[52:55], v27 offset:43008
    v_mfma_f32_16x16x32_bf16 v[120:123], a[80:83], a[60:63], v[120:123]
    ds_read_b128 a[56:59], v27 offset:38912
    v_mfma_f32_16x16x32_bf16 v[44:47], a[148:151], a[64:67], v[44:47]
    ds_read_b128 a[40:43], v50 offset:46080
    v_mfma_f32_16x16x32_bf16 v[108:111], a[152:155], a[64:67], v[108:111]
    v_mfma_f32_16x16x32_bf16 v[56:59], a[148:151], a[68:71], v[56:59]
    ds_read_b128 a[44:47], v52 offset:46080
    v_mfma_f32_16x16x32_bf16 v[112:115], a[152:155], a[68:71], v[112:115]
    v_mfma_f32_16x16x32_bf16 v[60:63], a[148:151], a[72:75], v[60:63]
    ds_read_b128 a[48:51], v54 offset:46080
    v_mfma_f32_16x16x32_bf16 v[116:119], a[152:155], a[72:75], v[116:119]
    s_waitcnt lgkmcnt(6)
    s_nop 0
    v_mfma_f32_16x16x32_bf16 v[40:43], a[156:159], a[12:15], v[40:43]
    ds_read_b128 a[60:63], v49 offset:46080
    v_mfma_f32_16x16x32_bf16 v[104:107], a[160:163], a[12:15], v[104:107]
    v_mfma_f32_16x16x32_bf16 v[92:95], a[28:31], a[12:15], v[92:95]
    ds_read_b128 a[76:79], v27 offset:44032
    v_mfma_f32_16x16x32_bf16 v[120:123], a[32:35], a[12:15], v[120:123]
    ds_read_b128 a[80:83], v27 offset:39936
    v_mfma_f32_16x16x32_bf16 v[44:47], a[156:159], a[16:19], v[44:47]
    ds_read_b128 a[64:67], v51 offset:46080
    v_mfma_f32_16x16x32_bf16 v[108:111], a[160:163], a[16:19], v[108:111]
    v_mfma_f32_16x16x32_bf16 v[56:59], a[156:159], a[20:23], v[56:59]
    ds_read_b128 a[68:71], v53 offset:46080
    v_mfma_f32_16x16x32_bf16 v[112:115], a[160:163], a[20:23], v[112:115]
    v_mfma_f32_16x16x32_bf16 v[60:63], a[156:159], a[24:27], v[60:63]
    ds_read_b128 a[72:75], v55 offset:46080
    v_mfma_f32_16x16x32_bf16 v[116:119], a[160:163], a[24:27], v[116:119]
    s_add_u32 s18, s16, 2699264
    buffer_load_dwordx4 a[88:91], v3, s[12:15], s18 offen offset:0 sc1
    buffer_load_dwordx4 a[92:95], v3, s[12:15], s29 offen offset:1024 sc1
    buffer_load_dwordx4 a[96:99], v3, s[12:15], s18 offen offset:1024 sc1
    buffer_load_dwordx4 a[100:103], v3, s[12:15], s29 offen offset:2048 sc1
    buffer_load_dwordx4 a[104:107], v3, s[12:15], s18 offen offset:2048 sc1
    buffer_load_dwordx4 a[108:111], v3, s[12:15], s29 offen offset:3072 sc1
    buffer_load_dwordx4 a[112:115], v3, s[12:15], s18 offen offset:3072 sc1
    s_add_u32 m0, s61, 143360
    s_add_u32 s56, s17, 1966080
    buffer_load_dwordx4 v3, s[12:15], s56 offen sc1 lds
    s_add_u32 m0, s61, 139264
    s_add_u32 s56, s17, 2785280
    buffer_load_dwordx4 v3, s[12:15], s56 offen sc1 lds
    s_waitcnt vmcnt(13)
    s_barrier
    ds_read_b64_tr_b16 a[232:233], v20
    ds_read_b64_tr_b16 a[234:235], v20 offset:3072
    ds_read_b64_tr_b16 a[236:237], v21
    ds_read_b64_tr_b16 a[238:239], v21 offset:3072
    ds_read_b64_tr_b16 a[240:241], v22
    ds_read_b64_tr_b16 a[242:243], v22 offset:3072
    ds_read_b64_tr_b16 a[244:245], v96
    ds_read_b64_tr_b16 a[246:247], v96 offset:3072
    ds_read_b64_tr_b16 a[248:249], v97
    ds_read_b64_tr_b16 a[250:251], v97 offset:3072
    ds_read_b64_tr_b16 a[252:253], v98
    ds_read_b64_tr_b16 a[254:255], v98 offset:3072
    v_cmp_ne_u32 vcc, s47, v16
    v_cmp_ne_u32 s[64:65], s47, v17
    s_nop 1
    s_or_b64 vcc, vcc, s[64:65]
    s_cbranch_vccnz Lslow4
Lback5:
    s_add_u32 s29, s16, 1884160
    buffer_load_dwordx4 a[116:119], v3, s[12:15], s29 offen offset:0 sc1
    s_waitcnt vmcnt(12)
    s_waitcnt lgkmcnt(0)
    s_barrier
    s_nop 0
    v_add_u32 v48, 55296, v48
    v_add_u32 v49, 55296, v49
    buffer_store_dwordx4 a[232:235], v80, s[12:15], 0 offen sc1
    buffer_store_dwordx4 a[236:239], v81, s[12:15], 0 offen sc1
    buffer_store_dwordx4 a[240:243], v82, s[12:15], 0 offen sc1
    buffer_store_dwordx4 a[244:247], v100, s[12:15], 0 offen sc1
    buffer_store_dwordx4 a[248:251], v101, s[12:15], 0 offen sc1
    buffer_store_dwordx4 a[252:255], v102, s[12:15], 0 offen sc1
    v_add_u32 v50, 55296, v50
    v_add_u32 v51, 55296, v51
    v_add_u32 v52, 55296, v52
    v_add_u32 v53, 55296, v53
    v_add_u32 v54, 55296, v54
    v_add_u32 v55, 55296, v55
    v_mfma_f32_16x16x32_bf16 v[40:43], a[164:167], a[36:39], v[40:43]
    ds_read_b128 a[12:15], v48 offset:0
    v_mfma_f32_16x16x32_bf16 v[104:107], a[168:171], a[36:39], v[104:107]
    v_mfma_f32_16x16x32_bf16 v[92:95], a[52:55], a[36:39], v[92:95]
    ds_read_b128 a[28:31], v27 offset:61440
    v_mfma_f32_16x16x32_bf16 v[120:123], a[56:59], a[36:39], v[120:123]
    ds_read_b128 a[32:35], v27 offset:57344
    v_mfma_f32_16x16x32_bf16 v[44:47], a[164:167], a[40:43], v[44:47]
    ds_read_b128 a[16:19], v50 offset:0
    v_mfma_f32_16x16x32_bf16 v[108:111], a[168:171], a[40:43], v[108:111]
    s_add_u32 s18, s16, 2703360
    buffer_load_dwordx4 a[120:123], v3, s[12:15], s18 offen offset:0 sc1
    v_mfma_f32_16x16x32_bf16 v[56:59], a[164:167], a[44:47], v[56:59]
    ds_read_b128 a[20:23], v52 offset:0
    v_mfma_f32_16x16x32_bf16 v[112:115], a[168:171], a[44:47], v[112:115]
    v_mfma_f32_16x16x32_bf16 v[60:63], a[164:167], a[48:51], v[60:63]
    ds_read_b128 a[24:27], v54 offset:0
    v_mfma_f32_16x16x32_bf16 v[116:119], a[168:171], a[48:51], v[116:119]
    buffer_load_dwordx4 a[124:127], v3, s[12:15], s29 offen offset:1024 sc1
    v_mfma_f32_16x16x32_bf16 v[40:43], a[172:175], a[60:63], v[40:43]
    ds_read_b128 a[36:39], v49 offset:0
    v_mfma_f32_16x16x32_bf16 v[104:107], a[176:179], a[60:63], v[104:107]
    v_mfma_f32_16x16x32_bf16 v[92:95], a[76:79], a[60:63], v[92:95]
    ds_read_b128 a[52:55], v27 offset:62464
    v_mfma_f32_16x16x32_bf16 v[120:123], a[80:83], a[60:63], v[120:123]
    ds_read_b128 a[56:59], v27 offset:58368
    v_mfma_f32_16x16x32_bf16 v[44:47], a[172:175], a[64:67], v[44:47]
    ds_read_b128 a[40:43], v51 offset:0
    v_mfma_f32_16x16x32_bf16 v[108:111], a[176:179], a[64:67], v[108:111]
    buffer_load_dwordx4 a[128:131], v3, s[12:15], s18 offen offset:1024 sc1
    v_mfma_f32_16x16x32_bf16 v[56:59], a[172:175], a[68:71], v[56:59]
    ds_read_b128 a[44:47], v53 offset:0
    v_mfma_f32_16x16x32_bf16 v[112:115], a[176:179], a[68:71], v[112:115]
    v_mfma_f32_16x16x32_bf16 v[60:63], a[172:175], a[72:75], v[60:63]
    ds_read_b128 a[48:51], v55 offset:0
    v_mfma_f32_16x16x32_bf16 v[116:119], a[176:179], a[72:75], v[116:119]
    buffer_load_dwordx4 a[132:135], v3, s[12:15], s29 offen offset:2048 sc1
    s_waitcnt vmcnt(19) lgkmcnt(6)
    s_nop 0
    v_mfma_f32_16x16x32_bf16 v[40:43], a[84:87], a[12:15], v[40:43]
    ds_read_b128 a[60:63], v48 offset:9216
    v_mfma_f32_16x16x32_bf16 v[104:107], a[88:91], a[12:15], v[104:107]
    v_mfma_f32_16x16x32_bf16 v[92:95], a[28:31], a[12:15], v[92:95]
    ds_read_b128 a[76:79], v27 offset:63488
    v_mfma_f32_16x16x32_bf16 v[120:123], a[32:35], a[12:15], v[120:123]
    ds_read_b128 a[80:83], v27 offset:59392
    v_mfma_f32_16x16x32_bf16 v[44:47], a[84:87], a[16:19], v[44:47]
    ds_read_b128 a[64:67], v50 offset:9216
    v_mfma_f32_16x16x32_bf16 v[108:111], a[88:91], a[16:19], v[108:111]
    buffer_load_dwordx4 a[136:139], v3, s[12:15], s18 offen offset:2048 sc1
    v_mfma_f32_16x16x32_bf16 v[56:59], a[84:87], a[20:23], v[56:59]
    ds_read_b128 a[68:71], v52 offset:9216
    v_mfma_f32_16x16x32_bf16 v[112:115], a[88:91], a[20:23], v[112:115]
    v_mfma_f32_16x16x32_bf16 v[60:63], a[84:87], a[24:27], v[60:63]
    ds_read_b128 a[72:75], v54 offset:9216
    v_mfma_f32_16x16x32_bf16 v[116:119], a[88:91], a[24:27], v[116:119]
    buffer_load_dwordx4 a[140:143], v3, s[12:15], s29 offen offset:3072 sc1
    s_waitcnt vmcnt(19) lgkmcnt(6)
    s_nop 0
    v_mfma_f32_16x16x32_bf16 v[40:43], a[92:95], a[36:39], v[40:43]
    ds_read_b128 a[12:15], v49 offset:9216
    v_mfma_f32_16x16x32_bf16 v[104:107], a[96:99], a[36:39], v[104:107]
    v_mfma_f32_16x16x32_bf16 v[92:95], a[52:55], a[36:39], v[92:95]
    ds_read_b128 a[28:31], v27 offset:64512
    v_mfma_f32_16x16x32_bf16 v[120:123], a[56:59], a[36:39], v[120:123]
    ds_read_b128 a[32:35], v27 offset:60416
    v_mfma_f32_16x16x32_bf16 v[44:47], a[92:95], a[40:43], v[44:47]
    ds_read_b128 a[16:19], v51 offset:9216
    v_mfma_f32_16x16x32_bf16 v[108:111], a[96:99], a[40:43], v[108:111]
    buffer_load_dwordx4 a[84:87], v3, s[12:15], s18 offen offset:3072 sc1
    v_mfma_f32_16x16x32_bf16 v[56:59], a[92:95], a[44:47], v[56:59]
    ds_read_b128 a[20:23], v53 offset:9216
    v_mfma_f32_16x16x32_bf16 v[112:115], a[96:99], a[44:47], v[112:115]
    v_mfma_f32_16x16x32_bf16 v[60:63], a[92:95], a[48:51], v[60:63]
    ds_read_b128 a[24:27], v55 offset:9216
    v_mfma_f32_16x16x32_bf16 v[116:119], a[96:99], a[48:51], v[116:119]
    s_add_u32 m0, s61, 135168
    s_add_u32 s56, s17, 3588096
    buffer_load_dwordx4 v3, s[12:15], s56 offen sc1 lds
    s_waitcnt vmcnt(15)
    s_waitcnt lgkmcnt(0)
    s_barrier
    s_nop 0
    v_mfma_f32_16x16x32_bf16 v[40:43], a[100:103], a[60:63], v[40:43]
    ds_read_b128 a[36:39], v48 offset:18432
    v_mfma_f32_16x16x32_bf16 v[104:107], a[104:107], a[60:63], v[104:107]
    s_add_u32 s29, s16, 3506176
    buffer_load_dwordx4 a[88:91], v3, s[12:15], s29 offen offset:0 sc1
    v_mfma_f32_16x16x32_bf16 v[92:95], a[76:79], a[60:63], v[92:95]
    ds_read_b128 a[52:55], v27 offset:53248
    v_mfma_f32_16x16x32_bf16 v[120:123], a[80:83], a[60:63], v[120:123]
    ds_read_b128 a[56:59], v27 offset:49152
    v_mfma_f32_16x16x32_bf16 v[44:47], a[100:103], a[64:67], v[44:47]
    ds_read_b128 a[40:43], v50 offset:18432
    v_mfma_f32_16x16x32_bf16 v[108:111], a[104:107], a[64:67], v[108:111]
    v_mfma_f32_16x16x32_bf16 v[56:59], a[100:103], a[68:71], v[56:59]
    ds_read_b128 a[44:47], v52 offset:18432
    v_mfma_f32_16x16x32_bf16 v[112:115], a[104:107], a[68:71], v[112:115]
    v_mfma_f32_16x16x32_bf16 v[60:63], a[100:103], a[72:75], v[60:63]
    ds_read_b128 a[48:51], v54 offset:18432
    v_mfma_f32_16x16x32_bf16 v[116:119], a[104:107], a[72:75], v[116:119]
    v_mfma_f32_16x16x32_bf16 v[40:43], a[108:111], a[12:15], v[40:43]
    ds_read_b128 a[60:63], v49 offset:18432
    v_mfma_f32_16x16x32_bf16 v[104:107], a[112:115], a[12:15], v[104:107]
    v_mfma_f32_16x16x32_bf16 v[92:95], a[28:31], a[12:15], v[92:95]
    ds_read_b128 a[76:79], v27 offset:54272
    v_mfma_f32_16x16x32_bf16 v[120:123], a[32:35], a[12:15], v[120:123]
    ds_read_b128 a[80:83], v27 offset:50176
    v_mfma_f32_16x16x32_bf16 v[44:47], a[108:111], a[16:19], v[44:47]
    ds_read_b128 a[64:67], v51 offset:18432
    v_mfma_f32_16x16x32_bf16 v[108:111], a[112:115], a[16:19], v[108:111]
    v_mfma_f32_16x16x32_bf16 v[56:59], a[108:111], a[20:23], v[56:59]
    s_add_u32 s8, s58, 12288
    buffer_load_dword v6, v7, s[12:15], s8 offen offset:0 sc1
    ds_read_b128 a[68:71], v53 offset:18432
    v_mfma_f32_16x16x32_bf16 v[112:115], a[112:115], a[20:23], v[112:115]
    v_mfma_f32_16x16x32_bf16 v[60:63], a[108:111], a[24:27], v[60:63]
    ds_read_b128 a[72:75], v55 offset:18432
    v_mfma_f32_16x16x32_bf16 v[116:119], a[112:115], a[24:27], v[116:119]
    buffer_load_dwordx4 a[92:95], v3, s[12:15], s29 offen offset:1024 sc1
    buffer_load_dwordx4 a[96:99], v3, s[12:15], s29 offen offset:2048 sc1
    buffer_load_dwordx4 a[100:103], v3, s[12:15], s29 offen offset:3072 sc1
    s_waitcnt vmcnt(12) lgkmcnt(6)
    s_nop 0
    v_mfma_f32_16x16x32_bf16 v[40:43], a[116:119], a[36:39], v[40:43]
    ds_read_b128 a[12:15], v48 offset:27648
    v_mfma_f32_16x16x32_bf16 v[104:107], a[120:123], a[36:39], v[104:107]
    v_mfma_f32_16x16x32_bf16 v[92:95], a[52:55], a[36:39], v[92:95]
    ds_read_b128 a[28:31], v27 offset:55296
    v_mfma_f32_16x16x32_bf16 v[120:123], a[56:59], a[36:39], v[120:123]
    ds_read_b128 a[32:35], v27 offset:51200
    v_mfma_f32_16x16x32_bf16 v[44:47], a[116:119], a[40:43], v[44:47]
    ds_read_b128 a[16:19], v50 offset:27648
    v_mfma_f32_16x16x32_bf16 v[108:111], a[120:123], a[40:43], v[108:111]
    v_mfma_f32_16x16x32_bf16 v[56:59], a[116:119], a[44:47], v[56:59]
    ds_read_b128 a[20:23], v52 offset:27648
    v_mfma_f32_16x16x32_bf16 v[112:115], a[120:123], a[44:47], v[112:115]
    v_mfma_f32_16x16x32_bf16 v[60:63], a[116:119], a[48:51], v[60:63]
    ds_read_b128 a[24:27], v54 offset:27648
    v_mfma_f32_16x16x32_bf16 v[116:119], a[120:123], a[48:51], v[116:119]
    s_waitcnt vmcnt(10) lgkmcnt(6)
    s_nop 0
    v_mfma_f32_16x16x32_bf16 v[40:43], a[124:127], a[60:63], v[40:43]
    ds_read_b128 a[36:39], v49 offset:27648
    v_mfma_f32_16x16x32_bf16 v[104:107], a[128:131], a[60:63], v[104:107]
    v_mfma_f32_16x16x32_bf16 v[92:95], a[76:79], a[60:63], v[92:95]
    ds_read_b128 a[52:55], v27 offset:56320
    v_mfma_f32_16x16x32_bf16 v[120:123], a[80:83], a[60:63], v[120:123]
    s_barrier
    s_lshl_b32 s69, s44, 7
    s_add_u32 s69, s69, s45
    s_lshl_b32 s69, s69, 4
    s_add_u32 s69, s69, 98304
    s_add_u32 s69, s69, s60
    s_mov_b64 exec, 1
    buffer_store_dword v23, v24, s[12:15], s69 offen sc1
    s_mov_b64 exec, -1
    s_nop 0
    ds_read_b128 a[56:59], v27 offset:52224
    v_mfma_f32_16x16x32_bf16 v[44:47], a[124:127], a[64:67], v[44:47]
    ds_read_b128 a[40:43], v51 offset:27648
    v_mfma_f32_16x16x32_bf16 v[108:111], a[128:131], a[64:67], v[108:111]
    s_add_u32 m0, s61, 151552
    s_add_u32 s56, s17, 3592192
    buffer_load_dwordx4 v3, s[12:15], s56 offen sc1 lds
    v_mfma_f32_16x16x32_bf16 v[56:59], a[124:127], a[68:71], v[56:59]
    ds_read_b128 a[44:47], v53 offset:27648
    v_mfma_f32_16x16x32_bf16 v[112:115], a[128:131], a[68:71], v[112:115]
    s_add_u32 s18, s16, 3510272
    buffer_load_dwordx4 a[104:107], v3, s[12:15], s18 offen offset:0 sc1
    v_mfma_f32_16x16x32_bf16 v[60:63], a[124:127], a[72:75], v[60:63]
    ds_read_b128 a[48:51], v55 offset:27648
    v_mfma_f32_16x16x32_bf16 v[116:119], a[128:131], a[72:75], v[116:119]
    buffer_load_dwordx4 a[108:111], v3, s[12:15], s18 offen offset:1024 sc1
    s_waitcnt vmcnt(12) lgkmcnt(6)
    s_nop 0
    v_mfma_f32_16x16x32_bf16 v[40:43], a[132:135], a[12:15], v[40:43]
    v_mfma_f32_16x16x32_bf16 v[104:107], a[136:139], a[12:15], v[104:107]
    v_mfma_f32_16x16x32_bf16 v[92:95], a[28:31], a[12:15], v[92:95]
    v_mfma_f32_16x16x32_bf16 v[120:123], a[32:35], a[12:15], v[120:123]
    v_mfma_f32_16x16x32_bf16 v[44:47], a[132:135], a[16:19], v[44:47]
    v_mfma_f32_16x16x32_bf16 v[108:111], a[136:139], a[16:19], v[108:111]
    buffer_load_dwordx4 a[112:115], v3, s[12:15], s18 offen offset:2048 sc1
    v_mfma_f32_16x16x32_bf16 v[56:59], a[132:135], a[20:23], v[56:59]
    v_mfma_f32_16x16x32_bf16 v[112:115], a[136:139], a[20:23], v[112:115]
    v_mfma_f32_16x16x32_bf16 v[60:63], a[132:135], a[24:27], v[60:63]
    v_mfma_f32_16x16x32_bf16 v[116:119], a[136:139], a[24:27], v[116:119]
    buffer_load_dwordx4 a[116:119], v3, s[12:15], s18 offen offset:3072 sc1
    s_waitcnt vmcnt(12) lgkmcnt(0)
    s_nop 0
    v_mfma_f32_16x16x32_bf16 v[40:43], a[140:143], a[36:39], v[40:43]
    v_mfma_f32_16x16x32_bf16 v[104:107], a[84:87], a[36:39], v[104:107]
    v_mfma_f32_16x16x32_bf16 v[92:95], a[52:55], a[36:39], v[92:95]
    v_mfma_f32_16x16x32_bf16 v[120:123], a[56:59], a[36:39], v[120:123]
    v_mfma_f32_16x16x32_bf16 v[44:47], a[140:143], a[40:43], v[44:47]
    v_mfma_f32_16x16x32_bf16 v[108:111], a[84:87], a[40:43], v[108:111]
    s_add_u32 m0, s61, 147456
    s_add_u32 s56, s17, 3596288
    buffer_load_dwordx4 v3, s[12:15], s56 offen sc1 lds
    v_mfma_f32_16x16x32_bf16 v[56:59], a[140:143], a[44:47], v[56:59]
    v_mfma_f32_16x16x32_bf16 v[112:115], a[84:87], a[44:47], v[112:115]
    v_mfma_f32_16x16x32_bf16 v[60:63], a[140:143], a[48:51], v[60:63]
    v_mfma_f32_16x16x32_bf16 v[116:119], a[84:87], a[48:51], v[116:119]
    v_subrev_u32 v48, 55296, v48
    s_waitcnt vmcnt(10)
    v_cmp_ne_u32 vcc, s47, v6
    s_nop 0
    s_cbranch_vccnz Lslow7
Lback8:
    v_subrev_u32 v49, 55296, v49
    v_subrev_u32 v50, 55296, v50
    v_subrev_u32 v51, 55296, v51
    v_subrev_u32 v52, 55296, v52
    v_subrev_u32 v53, 55296, v53
    v_subrev_u32 v54, 55296, v54
    v_subrev_u32 v55, 55296, v55
    s_add_u32 m0, s62, 92160
    s_add_u32 s57, s19, 9895936
    buffer_load_dwordx4 v3, s[12:15], s57 offen offset:0 sc1 lds
    buffer_load_dwordx4 v3, s[12:15], s57 offen offset:1024 sc1 lds
    buffer_load_dwordx4 v3, s[12:15], s57 offen offset:2048 sc1 lds
    buffer_load_dwordx4 v3, s[12:15], s57 offen offset:3072 sc1 lds
    v_cvt_pk_bf16_f32 v92, v92, v93
    v_cvt_pk_bf16_f32 v93, v94, v95
    ds_write_b64 v75, v[92:93] offset:0
    v_cvt_pk_bf16_f32 v40, v40, v41
    v_cvt_pk_bf16_f32 v41, v42, v43
    v_mov_b32 v42, 0
    v_mov_b32 v43, 0
    v_cvt_pk_bf16_f32 v44, v44, v45
    v_cvt_pk_bf16_f32 v45, v46, v47
    v_mov_b32 v46, 0
    v_mov_b32 v47, 0
    v_cvt_pk_bf16_f32 v56, v56, v57
    v_cvt_pk_bf16_f32 v57, v58, v59
    v_mov_b32 v58, 0
    v_mov_b32 v59, 0
    v_cvt_pk_bf16_f32 v60, v60, v61
    v_cvt_pk_bf16_f32 v61, v62, v63
    v_mov_b32 v62, 0
    v_mov_b32 v63, 0
    v_cvt_pk_bf16_f32 v120, v120, v121
    v_cvt_pk_bf16_f32 v121, v122, v123
    ds_write_b64 v75, v[120:121] offset:2048
    v_cvt_pk_bf16_f32 v104, v104, v105
    v_cvt_pk_bf16_f32 v105, v106, v107
    v_mov_b32 v106, 0
    v_mov_b32 v107, 0
    v_cvt_pk_bf16_f32 v108, v108, v109
    v_cvt_pk_bf16_f32 v109, v110, v111
    v_mov_b32 v110, 0
    v_mov_b32 v111, 0
    v_cvt_pk_bf16_f32 v112, v112, v113
    v_cvt_pk_bf16_f32 v113, v114, v115
    v_mov_b32 v114, 0
    v_mov_b32 v115, 0
    v_cvt_pk_bf16_f32 v116, v116, v117
    v_cvt_pk_bf16_f32 v117, v118, v119
    v_mov_b32 v118, 0
    v_mov_b32 v119, 0
    s_waitcnt lgkmcnt(0)
    s_barrier
    s_mov_b64 exec, 0xffff
    ds_read_b64 v[42:43], v68 offset:0
    ds_read_b64 v[46:47], v69 offset:0
    ds_read_b64 v[58:59], v70 offset:0
    ds_read_b64 v[62:63], v71 offset:0
    s_mov_b64 exec, -1
    s_mov_b64 exec, 0xffff
    ds_read_b64 v[106:107], v68 offset:2048
    ds_read_b64 v[110:111], v69 offset:2048
    ds_read_b64 v[114:115], v70 offset:2048
    ds_read_b64 v[118:119], v71 offset:2048
    s_mov_b64 exec, -1
    s_add_u32 m0, s62, 108544
    s_add_u32 s57, s19, 9900032
    buffer_load_dwordx4 v3, s[12:15], s57 offen offset:0 sc1 lds
    buffer_load_dwordx4 v3, s[12:15], s57 offen offset:1024 sc1 lds
    buffer_load_dwordx4 v3, s[12:15], s57 offen offset:2048 sc1 lds
    buffer_load_dwordx4 v3, s[12:15], s57 offen offset:3072 sc1 lds
    s_add_u32 s29, s16, 3514368
    buffer_load_dwordx4 a[84:87], v3, s[12:15], s29 offen offset:0 sc1
    s_waitcnt lgkmcnt(0)
    s_nop 0
    v_mfma_f32_16x16x32_bf16 v[140:143], a[4:7], v[40:43], 0
    v_mfma_f32_16x16x32_bf16 v[156:159], a[8:11], v[40:43], 0
    v_mfma_f32_16x16x32_bf16 v[144:147], a[4:7], v[44:47], 0
    v_mfma_f32_16x16x32_bf16 v[160:163], a[8:11], v[44:47], 0
    v_mfma_f32_16x16x32_bf16 v[148:151], a[4:7], v[56:59], 0
    v_mfma_f32_16x16x32_bf16 v[164:167], a[8:11], v[56:59], 0
    v_mfma_f32_16x16x32_bf16 v[152:155], a[4:7], v[60:63], 0
    v_mfma_f32_16x16x32_bf16 v[168:171], a[8:11], v[60:63], 0
    buffer_load_dwordx4 a[120:123], v3, s[12:15], s29 offen offset:1024 sc1
    buffer_load_dwordx4 a[124:127], v3, s[12:15], s29 offen offset:2048 sc1
    buffer_load_dwordx4 a[128:131], v3, s[12:15], s29 offen offset:3072 sc1
    s_mov_b32 vcc_lo, 0xffff0000
    s_mov_b32 vcc_hi, 0x0
    v_cndmask_b32 v172, v156, v157, vcc
    v_cndmask_b32 v173, v160, v161, vcc
    v_cndmask_b32 v174, v164, v165, vcc
    v_cndmask_b32 v175, v168, v169, vcc
    s_mov_b32 vcc_lo, 0x0
    s_mov_b32 vcc_hi, 0xffff
    v_cndmask_b32 v172, v172, v158, vcc
    v_cndmask_b32 v173, v173, v162, vcc
    v_cndmask_b32 v174, v174, v166, vcc
    v_cndmask_b32 v175, v175, v170, vcc
    s_mov_b32 vcc_lo, 0x0
    s_mov_b32 vcc_hi, 0xffff0000
    v_cndmask_b32 v172, v172, v159, vcc
    v_cndmask_b32 v173, v173, v163, vcc
    v_cndmask_b32 v174, v174, v167, vcc
    v_cndmask_b32_e64 v175, v175, v171, vcc
    v_cvt_pk_bf16_f32 v156, v140, v141
    v_cvt_pk_bf16_f32 v157, v142, v143
    v_cvt_pk_bf16_f32 v158, v144, v145
    v_cvt_pk_bf16_f32 v159, v146, v147
    v_cvt_pk_bf16_f32 v160, v148, v149
    v_cvt_pk_bf16_f32 v161, v150, v151
    v_cvt_pk_bf16_f32 v162, v152, v153
    v_cvt_pk_bf16_f32 v163, v154, v155
    v_cvt_pk_bf16_f32 v164, v172, v173
    v_cvt_pk_bf16_f32 v165, v174, v175
    v_lshlrev_b32 v140, 16, v156
    v_and_b32 v141, 0xffff0000, v156
    v_lshlrev_b32 v142, 16, v157
    v_and_b32 v143, 0xffff0000, v157
    v_lshlrev_b32 v144, 16, v158
    v_and_b32 v145, 0xffff0000, v158
    v_lshlrev_b32 v146, 16, v159
    v_and_b32 v147, 0xffff0000, v159
    v_lshlrev_b32 v148, 16, v160
    v_and_b32 v149, 0xffff0000, v160
    v_lshlrev_b32 v150, 16, v161
    v_and_b32 v151, 0xffff0000, v161
    v_lshlrev_b32 v152, 16, v162
    v_and_b32 v153, 0xffff0000, v162
    v_lshlrev_b32 v154, 16, v163
    v_and_b32 v155, 0xffff0000, v163
    v_lshlrev_b32 v172, 16, v164
    v_and_b32 v173, 0xffff0000, v164
    v_lshlrev_b32 v174, 16, v165
    v_and_b32 v175, 0xffff0000, v165
    v_max3_f32 v180, v140, v141, v142
    v_max3_f32 v184, -v140, -v141, -v142
    v_max3_f32 v181, v144, v145, v146
    v_max3_f32 v185, -v144, -v145, -v146
    v_max3_f32 v182, v148, v149, v150
    v_max3_f32 v186, -v148, -v149, -v150
    v_max3_f32 v183, v152, v153, v154
    v_max3_f32 v187, -v152, -v153, -v154
    v_max3_f32 v180, v180, v143, v172
    v_max3_f32 v184, v184, -v143, -v172
    v_max3_f32 v181, v181, v147, v173
    v_max3_f32 v185, v185, -v147, -v173
    v_max3_f32 v182, v182, v151, v174
    v_max3_f32 v186, v186, -v151, -v174
    v_max3_f32 v183, v183, v155, v175
    v_max3_f32 v187, v187, -v155, -v175
    v_permlane16_swap_b32 v180, v184
    v_permlane16_swap_b32 v181, v185
    v_permlane16_swap_b32 v182, v186
    v_permlane16_swap_b32 v183, v187
    v_max_f32 v180, v180, v184
    s_waitcnt vmcnt(8)
    s_barrier
    s_nop 0
    v_add_u32 v32, 92160, v28
    s_add_u32 m0, s61, 143360
    s_add_u32 s56, s17, 3600384
    buffer_load_dwordx4 v3, s[12:15], s56 offen sc1 lds
    v_add_u32 v33, 92160, v29
    v_add_u32 v34, 92160, v30
    v_add_u32 v35, 92160, v31
    ds_read_b128 a[12:15], v32 offset:0
    ds_read_b128 a[28:31], v27 offset:45056
    ds_read_b128 a[16:19], v33 offset:0
    ds_read_b128 a[20:23], v34 offset:0
    ds_read_b128 a[24:27], v35 offset:0
    ds_read_b128 a[36:39], v32 offset:1024
    ds_read_b128 a[52:55], v27 offset:46080
    ds_read_b128 a[40:43], v33 offset:1024
    ds_read_b128 a[44:47], v34 offset:1024
    ds_read_b128 a[48:51], v35 offset:1024
    s_waitcnt lgkmcnt(9)
    v_mfma_f32_16x16x32_bf16 v[80:83], a[88:91], a[12:15], 0
    ds_read_b128 a[60:63], v32 offset:2048
    ds_read_b128 a[76:79], v27 offset:47104
    s_waitcnt lgkmcnt(10)
    v_mfma_f32_16x16x32_bf16 v[128:131], a[28:31], a[12:15], 0
    s_add_u32 s18, s16, 3518464
    buffer_load_dwordx4 a[132:135], v3, s[12:15], s18 offen offset:0 sc1
    s_waitcnt lgkmcnt(9)
    v_mfma_f32_16x16x32_bf16 v[96:99], a[88:91], a[16:19], 0
    ds_read_b128 a[64:67], v33 offset:2048
    ds_read_b128 a[68:71], v34 offset:2048
    s_waitcnt lgkmcnt(10)
    v_mfma_f32_16x16x32_bf16 v[100:103], a[88:91], a[20:23], 0
    ds_read_b128 a[72:75], v35 offset:2048
    s_waitcnt lgkmcnt(10)
    v_mfma_f32_16x16x32_bf16 v[124:127], a[88:91], a[24:27], 0
    buffer_load_dwordx4 a[136:139], v3, s[12:15], s18 offen offset:1024 sc1
    s_waitcnt lgkmcnt(5)
    v_mfma_f32_16x16x32_bf16 v[80:83], a[92:95], a[36:39], v[80:83]
    ds_read_b128 a[12:15], v32 offset:3072
    ds_read_b128 a[28:31], v27 offset:48128
    v_mfma_f32_16x16x32_bf16 v[128:131], a[52:55], a[36:39], v[128:131]
    buffer_load_dwordx4 a[88:91], v3, s[12:15], s18 offen offset:2048 sc1
    v_mfma_f32_16x16x32_bf16 v[96:99], a[92:95], a[40:43], v[96:99]
    ds_read_b128 a[16:19], v33 offset:3072
    ds_read_b128 a[20:23], v34 offset:3072
    v_mfma_f32_16x16x32_bf16 v[100:103], a[92:95], a[44:47], v[100:103]
    ds_read_b128 a[24:27], v35 offset:3072
    v_mfma_f32_16x16x32_bf16 v[124:127], a[92:95], a[48:51], v[124:127]
    buffer_load_dwordx4 a[140:143], v3, s[12:15], s18 offen offset:3072 sc1
    s_waitcnt vmcnt(9)
    s_waitcnt lgkmcnt(0)
    s_barrier
    s_nop 0
    v_mfma_f32_16x16x32_bf16 v[80:83], a[96:99], a[60:63], v[80:83]
    ds_read_b128 a[36:39], v32 offset:16384
    ds_read_b128 a[52:55], v27 offset:61440
    v_mfma_f32_16x16x32_bf16 v[128:131], a[76:79], a[60:63], v[128:131]
    s_add_u32 m0, s62, 92160
    s_add_u32 s57, s19, 9904128
    buffer_load_dwordx4 v3, s[12:15], s57 offen offset:0 sc1 lds
    v_mfma_f32_16x16x32_bf16 v[96:99], a[96:99], a[64:67], v[96:99]
    ds_read_b128 a[40:43], v33 offset:16384
    ds_read_b128 a[44:47], v34 offset:16384
    v_mfma_f32_16x16x32_bf16 v[100:103], a[96:99], a[68:71], v[100:103]
    ds_read_b128 a[48:51], v35 offset:16384
    v_mfma_f32_16x16x32_bf16 v[124:127], a[96:99], a[72:75], v[124:127]
    buffer_load_dwordx4 v3, s[12:15], s57 offen offset:1024 sc1 lds
    v_mfma_f32_16x16x32_bf16 v[80:83], a[100:103], a[12:15], v[80:83]
    ds_read_b128 a[60:63], v32 offset:17408
    ds_read_b128 a[76:79], v27 offset:62464
    v_mfma_f32_16x16x32_bf16 v[128:131], a[28:31], a[12:15], v[128:131]
    buffer_load_dwordx4 v3, s[12:15], s57 offen offset:2048 sc1 lds
    v_mfma_f32_16x16x32_bf16 v[96:99], a[100:103], a[16:19], v[96:99]
    ds_read_b128 a[64:67], v33 offset:17408
    ds_read_b128 a[68:71], v34 offset:17408
    v_mfma_f32_16x16x32_bf16 v[100:103], a[100:103], a[20:23], v[100:103]
    ds_read_b128 a[72:75], v35 offset:17408
    v_mfma_f32_16x16x32_bf16 v[124:127], a[100:103], a[24:27], v[124:127]
    buffer_load_dwordx4 v3, s[12:15], s57 offen offset:3072 sc1 lds
    s_waitcnt lgkmcnt(5)
    v_mfma_f32_16x16x32_bf16 v[80:83], a[104:107], a[36:39], v[80:83]
    ds_read_b128 a[12:15], v32 offset:18432
    ds_read_b128 a[28:31], v27 offset:63488
    v_mfma_f32_16x16x32_bf16 v[128:131], a[52:55], a[36:39], v[128:131]
    v_max_f32 v181, v181, v185
    v_mfma_f32_16x16x32_bf16 v[96:99], a[104:107], a[40:43], v[96:99]
    ds_read_b128 a[16:19], v33 offset:18432
    ds_read_b128 a[20:23], v34 offset:18432
    v_mfma_f32_16x16x32_bf16 v[100:103], a[104:107], a[44:47], v[100:103]
    ds_read_b128 a[24:27], v35 offset:18432
    v_mfma_f32_16x16x32_bf16 v[124:127], a[104:107], a[48:51], v[124:127]
    s_add_u32 m0, s61, 139264
    s_add_u32 s56, s17, 3604480
    buffer_load_dwordx4 v3, s[12:15], s56 offen sc1 lds
    s_waitcnt lgkmcnt(5)
    v_mfma_f32_16x16x32_bf16 v[80:83], a[108:111], a[60:63], v[80:83]
    ds_read_b128 a[36:39], v32 offset:19456
    ds_read_b128 a[52:55], v27 offset:64512
    v_mfma_f32_16x16x32_bf16 v[128:131], a[76:79], a[60:63], v[128:131]
    v_max_f32 v182, v182, v186
    v_mfma_f32_16x16x32_bf16 v[96:99], a[108:111], a[64:67], v[96:99]
    ds_read_b128 a[40:43], v33 offset:19456
    ds_read_b128 a[44:47], v34 offset:19456
    v_mfma_f32_16x16x32_bf16 v[100:103], a[108:111], a[68:71], v[100:103]
    ds_read_b128 a[48:51], v35 offset:19456
    v_mfma_f32_16x16x32_bf16 v[124:127], a[108:111], a[72:75], v[124:127]
    v_max_f32 v183, v183, v187
    s_waitcnt lgkmcnt(0)
    s_barrier
    s_add_u32 m0, s62, 108544
    s_add_u32 s57, s19, 9908224
    buffer_load_dwordx4 v3, s[12:15], s57 offen offset:0 sc1 lds
    buffer_load_dwordx4 v3, s[12:15], s57 offen offset:1024 sc1 lds
    v_permlane32_swap_b32 v180, v181
    v_permlane32_swap_b32 v182, v183
    v_max_f32 v180, v180, v181
    v_max_f32 v182, v182, v183
    v_mov_b32 v181, v180
    v_mov_b32 v183, v182
    buffer_load_dwordx4 v3, s[12:15], s57 offen offset:2048 sc1 lds
    v_permlane32_swap_b32 v180, v181
    v_permlane32_swap_b32 v182, v183
    v_mov_b32 v184, v180
    v_mov_b32 v185, v181
    v_mov_b32 v186, v182
    v_mov_b32 v187, v183
    v_permlane16_swap_b32 v180, v184
    v_permlane16_swap_b32 v181, v185
    v_permlane16_swap_b32 v182, v186
    v_permlane16_swap_b32 v183, v187
    s_nop 0
    v_pk_mul_f32 v[180:181], v[180:181], s[66:67]
    v_pk_mul_f32 v[182:183], v[182:183], s[66:67]
    v_pk_mul_f32 v[184:185], v[184:185], s[66:67]
    v_pk_mul_f32 v[186:187], v[186:187], s[66:67]
    v_pk_fma_f32 v[156:157], v[140:141], s[66:67], v[184:185] op_sel:[0,0,0] op_sel_hi:[1,1,0] neg_lo:[1,0,1] neg_hi:[1,0,1]
    v_pk_fma_f32 v[158:159], v[142:143], s[66:67], v[184:185] op_sel:[0,0,0] op_sel_hi:[1,1,0] neg_lo:[1,0,1] neg_hi:[1,0,1]
    buffer_load_dwordx4 v3, s[12:15], s57 offen offset:3072 sc1 lds
    v_pk_fma_f32 v[160:161], v[144:145], s[66:67], v[184:185] op_sel:[0,0,1] op_sel_hi:[1,1,1] neg_lo:[1,0,1] neg_hi:[1,0,1]
    v_pk_fma_f32 v[162:163], v[146:147], s[66:67], v[184:185] op_sel:[0,0,1] op_sel_hi:[1,1,1] neg_lo:[1,0,1] neg_hi:[1,0,1]
    v_pk_fma_f32 v[164:165], v[148:149], s[66:67], v[186:187] op_sel:[0,0,0] op_sel_hi:[1,1,0] neg_lo:[1,0,1] neg_hi:[1,0,1]
    v_pk_fma_f32 v[166:167], v[150:151], s[66:67], v[186:187] op_sel:[0,0,0] op_sel_hi:[1,1,0] neg_lo:[1,0,1] neg_hi:[1,0,1]
    v_pk_fma_f32 v[168:169], v[152:153], s[66:67], v[186:187] op_sel:[0,0,1] op_sel_hi:[1,1,1] neg_lo:[1,0,1] neg_hi:[1,0,1]
    v_pk_fma_f32 v[170:171], v[154:155], s[66:67], v[186:187] op_sel:[0,0,1] op_sel_hi:[1,1,1] neg_lo:[1,0,1] neg_hi:[1,0,1]
    v_pk_fma_f32 v[176:177], v[172:173], s[66:67], v[184:185] op_sel:[0,0,0] op_sel_hi:[1,1,1] neg_lo:[1,0,1] neg_hi:[1,0,1]
    v_pk_fma_f32 v[178:179], v[174:175], s[66:67], v[186:187] op_sel:[0,0,0] op_sel_hi:[1,1,1] neg_lo:[1,0,1] neg_hi:[1,0,1]
    v_pk_fma_f32 v[140:141], v[140:141], s[66:67], v[180:181] op_sel:[0,0,0] op_sel_hi:[1,1,0] neg_lo:[0,0,1] neg_hi:[0,0,1]
    v_pk_fma_f32 v[142:143], v[142:143], s[66:67], v[180:181] op_sel:[0,0,0] op_sel_hi:[1,1,0] neg_lo:[0,0,1] neg_hi:[0,0,1]
    v_pk_fma_f32 v[144:145], v[144:145], s[66:67], v[180:181] op_sel:[0,0,1] op_sel_hi:[1,1,1] neg_lo:[0,0,1] neg_hi:[0,0,1]
    v_pk_fma_f32 v[146:147], v[146:147], s[66:67], v[180:181] op_sel:[0,0,1] op_sel_hi:[1,1,1] neg_lo:[0,0,1] neg_hi:[0,0,1]
    v_pk_fma_f32 v[148:149], v[148:149], s[66:67], v[182:183] op_sel:[0,0,0] op_sel_hi:[1,1,0] neg_lo:[0,0,1] neg_hi:[0,0,1]
    v_pk_fma_f32 v[150:151], v[150:151], s[66:67], v[182:183] op_sel:[0,0,0] op_sel_hi:[1,1,0] neg_lo:[0,0,1] neg_hi:[0,0,1]
    v_pk_fma_f32 v[152:153], v[152:153], s[66:67], v[182:183] op_sel:[0,0,1] op_sel_hi:[1,1,1] neg_lo:[0,0,1] neg_hi:[0,0,1]
    v_pk_fma_f32 v[154:155], v[154:155], s[66:67], v[182:183] op_sel:[0,0,1] op_sel_hi:[1,1,1] neg_lo:[0,0,1] neg_hi:[0,0,1]
    v_pk_fma_f32 v[172:173], v[172:173], s[66:67], v[180:181] op_sel:[0,0,0] op_sel_hi:[1,1,1] neg_lo:[0,0,1] neg_hi:[0,0,1]
    v_pk_fma_f32 v[174:175], v[174:175], s[66:67], v[182:183] op_sel:[0,0,0] op_sel_hi:[1,1,1] neg_lo:[0,0,1] neg_hi:[0,0,1]
    v_exp_f32 v156, v156
    v_exp_f32 v157, v157
    v_exp_f32_e64 v158, v158
    s_add_u32 s29, s16, 3522560
    buffer_load_dwordx4 a[92:95], v3, s[12:15], s29 offen offset:0 sc1
    v_exp_f32 v159, v159
    v_exp_f32 v160, v160
    v_exp_f32 v161, v161
    v_exp_f32 v162, v162
    v_exp_f32 v163, v163
    v_exp_f32 v164, v164
    v_exp_f32 v165, v165
    v_exp_f32 v166, v166
    buffer_load_dwordx4 a[96:99], v3, s[12:15], s29 offen offset:1024 sc1
    v_exp_f32 v167, v167
    v_exp_f32 v168, v168
    v_exp_f32 v169, v169
    v_exp_f32 v170, v170
    v_exp_f32 v171, v171
    v_exp_f32 v176, v176
    v_exp_f32 v177, v177
    v_exp_f32 v178, v178
    buffer_load_dwordx4 a[100:103], v3, s[12:15], s29 offen offset:2048 sc1
    v_exp_f32 v179, v179
    v_exp_f32 v140, v140
    v_exp_f32 v141, v141
    v_exp_f32 v142, v142
    v_exp_f32 v143, v143
    v_exp_f32 v144, v144
    v_exp_f32 v145, v145
    v_exp_f32 v146, v146
    s_waitcnt vmcnt(8)
    s_barrier
    v_mfma_f32_16x16x32_bf16 v[80:83], a[112:115], a[12:15], v[80:83]
    ds_read_b128 a[60:63], v32 offset:0
    ds_read_b128 a[76:79], v27 offset:57344
    v_mfma_f32_16x16x32_bf16 v[128:131], a[28:31], a[12:15], v[128:131]
    buffer_load_dwordx4 a[104:107], v3, s[12:15], s29 offen offset:3072 sc1
    v_mfma_f32_16x16x32_bf16 v[96:99], a[112:115], a[16:19], v[96:99]
    ds_read_b128 a[64:67], v33 offset:0
    ds_read_b128 a[68:71], v34 offset:0
    v_mfma_f32_16x16x32_bf16 v[100:103], a[112:115], a[20:23], v[100:103]
    ds_read_b128 a[72:75], v35 offset:0
    v_mfma_f32_16x16x32_bf16 v[124:127], a[112:115], a[24:27], v[124:127]
    s_add_u32 m0, s61, 151552
    s_add_u32 s56, s17, 4407296
    buffer_load_dwordx4 v3, s[12:15], s56 offen sc1 lds
    v_mfma_f32_16x16x32_bf16 v[80:83], a[116:119], a[36:39], v[80:83]
    ds_read_b128 a[12:15], v32 offset:1024
    ds_read_b128 a[28:31], v27 offset:58368
    v_mfma_f32_16x16x32_bf16 v[128:131], a[52:55], a[36:39], v[128:131]
    v_exp_f32_e64 v147, v147
    v_mfma_f32_16x16x32_bf16 v[96:99], a[116:119], a[40:43], v[96:99]
    ds_read_b128 a[16:19], v33 offset:1024
    ds_read_b128 a[20:23], v34 offset:1024
    v_mfma_f32_16x16x32_bf16 v[100:103], a[116:119], a[44:47], v[100:103]
    ds_read_b128 a[24:27], v35 offset:1024
    v_mfma_f32_16x16x32_bf16 v[124:127], a[116:119], a[48:51], v[124:127]
    v_exp_f32 v148, v148
    s_waitcnt lgkmcnt(5)
    v_mfma_f32_16x16x32_bf16 v[80:83], a[84:87], a[60:63], v[80:83]
    ds_read_b128 a[36:39], v32 offset:2048
    ds_read_b128 a[52:55], v27 offset:59392
    v_mfma_f32_16x16x32_bf16 v[128:131], a[76:79], a[60:63], v[128:131]
    s_add_u32 s18, s16, 4325376
    buffer_load_dwordx4 a[108:111], v3, s[12:15], s18 offen offset:0 sc1
    v_mfma_f32_16x16x32_bf16 v[96:99], a[84:87], a[64:67], v[96:99]
    ds_read_b128 a[40:43], v33 offset:2048
    ds_read_b128 a[44:47], v34 offset:2048
    v_mfma_f32_16x16x32_bf16 v[100:103], a[84:87], a[68:71], v[100:103]
    ds_read_b128 a[48:51], v35 offset:2048
    v_mfma_f32_16x16x32_bf16 v[124:127], a[84:87], a[72:75], v[124:127]
    buffer_load_dwordx4 a[112:115], v3, s[12:15], s18 offen offset:1024 sc1
    s_waitcnt lgkmcnt(5)
    v_mfma_f32_16x16x32_bf16 v[80:83], a[120:123], a[12:15], v[80:83]
    ds_read_b128 a[60:63], v32 offset:3072
    ds_read_b128 a[76:79], v27 offset:60416
    v_mfma_f32_16x16x32_bf16 v[128:131], a[28:31], a[12:15], v[128:131]
    v_exp_f32 v149, v149
    v_mfma_f32_16x16x32_bf16 v[96:99], a[120:123], a[16:19], v[96:99]
    ds_read_b128 a[64:67], v33 offset:3072
    ds_read_b128 a[68:71], v34 offset:3072
    v_mfma_f32_16x16x32_bf16 v[100:103], a[120:123], a[20:23], v[100:103]
    s_lshl_b32 s10, s44, 11
    s_nop 0
    s_add_u32 s10, s10, 98304
    buffer_load_dword v16, v3, s[12:15], s10 offen offset:0 sc1
    buffer_load_dword v17, v3, s[12:15], s10 offen offset:1024 sc1
    ds_read_b128 a[72:75], v35 offset:3072
    v_mfma_f32_16x16x32_bf16 v[124:127], a[120:123], a[24:27], v[124:127]
    buffer_load_dwordx4 a[84:87], v3, s[12:15], s18 offen offset:2048 sc1
    v_exp_f32 v150, v150
    v_exp_f32 v151, v151
    v_exp_f32 v152, v152
    v_exp_f32 v153, v153
    v_exp_f32 v154, v154
    s_waitcnt vmcnt(10)
    s_waitcnt lgkmcnt(0)
    s_barrier
    v_mfma_f32_16x16x32_bf16 v[80:83], a[124:127], a[36:39], v[80:83]
    ds_read_b128 a[12:15], v32 offset:16384
    ds_read_b128 a[28:31], v27 offset:53248
    v_mfma_f32_16x16x32_bf16 v[128:131], a[52:55], a[36:39], v[128:131]
    s_add_u32 m0, s62, 92160
    s_add_u32 s57, s19, 9912320
    buffer_load_dwordx4 v3, s[12:15], s57 offen offset:0 sc1 lds
    v_mfma_f32_16x16x32_bf16 v[96:99], a[124:127], a[40:43], v[96:99]
    ds_read_b128 a[16:19], v33 offset:16384
    ds_read_b128 a[20:23], v34 offset:16384
    v_mfma_f32_16x16x32_bf16 v[100:103], a[124:127], a[44:47], v[100:103]
    ds_read_b128 a[24:27], v35 offset:16384
    v_mfma_f32_16x16x32_bf16 v[124:127], a[124:127], a[48:51], v[124:127]
    buffer_load_dwordx4 v3, s[12:15], s57 offen offset:1024 sc1 lds
    v_mfma_f32_16x16x32_bf16 v[80:83], a[128:131], a[60:63], v[80:83]
    ds_read_b128 a[36:39], v32 offset:17408
    ds_read_b128 a[52:55], v27 offset:54272
    v_mfma_f32_16x16x32_bf16 v[128:131], a[76:79], a[60:63], v[128:131]
    buffer_load_dwordx4 v3, s[12:15], s57 offen offset:2048 sc1 lds
    v_mfma_f32_16x16x32_bf16 v[96:99], a[128:131], a[64:67], v[96:99]
    ds_read_b128 a[40:43], v33 offset:17408
    ds_read_b128 a[44:47], v34 offset:17408
    v_mfma_f32_16x16x32_bf16 v[100:103], a[128:131], a[68:71], v[100:103]
    ds_read_b128 a[48:51], v35 offset:17408
    v_mfma_f32_16x16x32_bf16 v[124:127], a[128:131], a[72:75], v[124:127]
    v_exp_f32 v155, v155
    s_waitcnt lgkmcnt(5)
    v_mfma_f32_16x16x32_bf16 v[80:83], a[132:135], a[12:15], v[80:83]
    ds_read_b128 a[60:63], v32 offset:18432
    ds_read_b128 a[76:79], v27 offset:55296
    v_mfma_f32_16x16x32_bf16 v[128:131], a[28:31], a[12:15], v[128:131]
    buffer_load_dwordx4 v3, s[12:15], s57 offen offset:3072 sc1 lds
    v_mfma_f32_16x16x32_bf16 v[96:99], a[132:135], a[16:19], v[96:99]
    ds_read_b128 a[64:67], v33 offset:18432
    ds_read_b128 a[68:71], v34 offset:18432
    v_mfma_f32_16x16x32_bf16 v[100:103], a[132:135], a[20:23], v[100:103]
    ds_read_b128 a[72:75], v35 offset:18432
    v_mfma_f32_16x16x32_bf16 v[124:127], a[132:135], a[24:27], v[124:127]
    buffer_load_dwordx4 a[116:119], v3, s[12:15], s18 offen offset:3072 sc1
    s_waitcnt lgkmcnt(5)
    v_mfma_f32_16x16x32_bf16 v[80:83], a[136:139], a[36:39], v[80:83]
    ds_read_b128 a[12:15], v32 offset:19456
    ds_read_b128 a[28:31], v27 offset:56320
    v_mfma_f32_16x16x32_bf16 v[128:131], a[52:55], a[36:39], v[128:131]
    v_exp_f32 v172, v172
    v_mfma_f32_16x16x32_bf16 v[96:99], a[136:139], a[40:43], v[96:99]
    ds_read_b128 a[16:19], v33 offset:19456
    ds_read_b128 a[20:23], v34 offset:19456
    v_mfma_f32_16x16x32_bf16 v[100:103], a[136:139], a[44:47], v[100:103]
    ds_read_b128 a[24:27], v35 offset:19456
    v_mfma_f32_16x16x32_bf16 v[124:127], a[136:139], a[48:51], v[124:127]
    v_exp_f32 v173, v173
    s_waitcnt lgkmcnt(0)
    s_barrier
    s_add_u32 m0, s61, 147456
    s_add_u32 s56, s17, 4411392
    buffer_load_dwordx4 v3, s[12:15], s56 offen sc1 lds
    s_add_u32 s29, s16, 4329472
    buffer_load_dwordx4 a[120:123], v3, s[12:15], s29 offen offset:0 sc1
    v_exp_f32 v174, v174
    v_exp_f32 v175, v175
    v_add_f32 v184, v156, v157
    v_add_f32 v185, v160, v161
    v_add_f32 v186, v164, v165
    v_add_f32 v187, v168, v169
    v_add_f32 v184, v184, v158
    buffer_load_dwordx4 a[124:127], v3, s[12:15], s29 offen offset:1024 sc1
    v_add_f32 v185, v185, v162
    v_add_f32 v186, v186, v166
    v_add_f32 v187, v187, v170
    v_add_f32 v184, v184, v159
    v_add_f32 v185, v185, v163
    v_add_f32 v186, v186, v167
    v_add_f32 v187, v187, v171
    v_add_f32 v184, v184, v176
    v_add_f32 v185, v185, v177
    v_add_f32 v186, v186, v178
    v_add_f32 v187, v187, v179
    v_add_f32 v180, v140, v141
    v_add_f32 v181, v144, v145
    v_add_f32 v182, v148, v149
    v_add_f32 v183, v152, v153
    v_add_f32 v180, v180, v142
    v_add_f32 v181, v181, v146
    v_add_f32 v182, v182, v150
    v_add_f32 v183, v183, v154
    v_add_f32 v180, v180, v143
    s_waitcnt vmcnt(9)
    v_cmp_ne_u32 vcc, s47, v16
    v_cmp_ne_u32 s[64:65], s47, v17
    s_nop 1
    s_or_b64 vcc, vcc, s[64:65]
    s_cbranch_vccnz Lslow10
Lback11:
    v_add_f32 v181, v181, v147
    v_add_f32 v182, v182, v151
    v_add_f32 v183, v183, v155
    v_add_f32 v180, v180, v172
    v_add_f32 v181, v181, v173
    v_add_f32 v182, v182, v174
    v_add_f32 v183, v183, v175
    v_permlane16_swap_b32 v180, v184
    v_permlane16_swap_b32 v181, v185
    v_permlane16_swap_b32 v182, v186
    buffer_load_dwordx4 a[128:131], v3, s[12:15], s29 offen offset:2048 sc1
    v_permlane16_swap_b32 v183, v187
    v_add_f32 v180, v180, v184
    v_add_f32 v181, v181, v185
    v_add_f32 v182, v182, v186
    v_add_f32 v183, v183, v187
    v_permlane32_swap_b32 v180, v181
    s_nop 0
    v_permlane32_swap_b32 v182, v183
    v_add_f32 v180, v180, v181
    v_add_f32 v182, v182, v183
    v_mov_b32 v181, v180
    v_mov_b32 v183, v182
    s_nop 0
    v_permlane32_swap_b32 v180, v181
    v_permlane32_swap_b32 v182, v183
    v_mov_b32 v184, v180
    v_mov_b32 v185, v181
    v_mov_b32 v186, v182
    buffer_load_dwordx4 a[132:135], v3, s[12:15], s29 offen offset:3072 sc1
    v_mov_b32 v187, v183
    v_permlane16_swap_b32 v180, v184
    v_permlane16_swap_b32 v181, v185
    v_permlane16_swap_b32 v182, v186
    v_permlane16_swap_b32 v183, v187
    v_rcp_f32 v180, v180
    v_rcp_f32 v181, v181
    v_rcp_f32 v182, v182
    v_rcp_f32 v183, v183
    v_rcp_f32 v184, v184
    v_rcp_f32 v185, v185
    s_add_u32 m0, s61, 143360
    s_add_u32 s56, s17, 4415488
    buffer_load_dwordx4 v3, s[12:15], s56 offen sc1 lds
    v_rcp_f32 v186, v186
    v_rcp_f32 v187, v187
    v_pk_mul_f32 v[140:141], v[140:141], v[180:181] op_sel:[0,0] op_sel_hi:[1,0]
    v_pk_mul_f32 v[142:143], v[142:143], v[180:181] op_sel:[0,0] op_sel_hi:[1,0]
    v_pk_mul_f32 v[144:145], v[144:145], v[180:181] op_sel:[0,1] op_sel_hi:[1,1]
    v_pk_mul_f32 v[146:147], v[146:147], v[180:181] op_sel:[0,1] op_sel_hi:[1,1]
    v_pk_mul_f32 v[148:149], v[148:149], v[182:183] op_sel:[0,0] op_sel_hi:[1,0]
    v_pk_mul_f32 v[150:151], v[150:151], v[182:183] op_sel:[0,0] op_sel_hi:[1,0]
    v_pk_mul_f32 v[152:153], v[152:153], v[182:183] op_sel:[0,1] op_sel_hi:[1,1]
    v_pk_mul_f32 v[154:155], v[154:155], v[182:183] op_sel:[0,1] op_sel_hi:[1,1]
    v_pk_mul_f32 v[172:173], v[172:173], v[180:181] op_sel:[0,0] op_sel_hi:[1,1]
    v_pk_mul_f32 v[174:175], v[174:175], v[182:183] op_sel:[0,0] op_sel_hi:[1,1]
    s_add_u32 s18, s16, 4333568
    buffer_load_dwordx4 a[136:139], v3, s[12:15], s18 offen offset:0 sc1
    v_pk_mul_f32 v[156:157], v[156:157], v[184:185] op_sel:[0,0] op_sel_hi:[1,0]
    v_pk_mul_f32 v[158:159], v[158:159], v[184:185] op_sel:[0,0] op_sel_hi:[1,0]
    v_pk_mul_f32 v[160:161], v[160:161], v[184:185] op_sel:[0,1] op_sel_hi:[1,1]
    v_pk_mul_f32 v[162:163], v[162:163], v[184:185] op_sel:[0,1] op_sel_hi:[1,1]
    v_pk_mul_f32 v[164:165], v[164:165], v[186:187] op_sel:[0,0] op_sel_hi:[1,0]
    v_pk_mul_f32 v[166:167], v[166:167], v[186:187] op_sel:[0,0] op_sel_hi:[1,0]
    v_pk_mul_f32 v[168:169], v[168:169], v[186:187] op_sel:[0,1] op_sel_hi:[1,1]
    v_pk_mul_f32 v[170:171], v[170:171], v[186:187] op_sel:[0,1] op_sel_hi:[1,1]
    v_pk_mul_f32 v[176:177], v[176:177], v[184:185] op_sel:[0,0] op_sel_hi:[1,1]
    v_pk_mul_f32 v[178:179], v[178:179], v[186:187] op_sel:[0,0] op_sel_hi:[1,1]
    v_cvt_pk_bf16_f32 v40, v140, v141
    v_cvt_pk_bf16_f32 v42, v156, v157
    v_cvt_pk_bf16_f32 v41, v142, v143
    s_waitcnt vmcnt(8)
    s_barrier
    v_mfma_f32_16x16x32_bf16 v[80:83], a[88:91], a[60:63], v[80:83]
    ds_read_b128 a[36:39], v32 offset:0
    ds_read_b128 a[52:55], v27 offset:49152
    v_mfma_f32_16x16x32_bf16 v[128:131], a[76:79], a[60:63], v[128:131]
    buffer_load_dwordx4 a[144:147], v3, s[12:15], s18 offen offset:1024 sc1
    v_mfma_f32_16x16x32_bf16 v[96:99], a[88:91], a[64:67], v[96:99]
    ds_read_b128 a[40:43], v33 offset:0
    ds_read_b128 a[44:47], v34 offset:0
    v_mfma_f32_16x16x32_bf16 v[100:103], a[88:91], a[68:71], v[100:103]
    ds_read_b128 a[48:51], v35 offset:0
    v_mfma_f32_16x16x32_bf16 v[124:127], a[88:91], a[72:75], v[124:127]
    buffer_load_dwordx4 a[148:151], v3, s[12:15], s18 offen offset:2048 sc1
    v_mfma_f32_16x16x32_bf16 v[80:83], a[140:143], a[12:15], v[80:83]
    ds_read_b128 a[60:63], v32 offset:1024
    ds_read_b128 a[76:79], v27 offset:50176
    v_mfma_f32_16x16x32_bf16 v[128:131], a[28:31], a[12:15], v[128:131]
    v_cvt_pk_bf16_f32 v43, v158, v159
    v_mfma_f32_16x16x32_bf16 v[96:99], a[140:143], a[16:19], v[96:99]
    ds_read_b128 a[64:67], v33 offset:1024
    ds_read_b128 a[68:71], v34 offset:1024
    v_mfma_f32_16x16x32_bf16 v[100:103], a[140:143], a[20:23], v[100:103]
    ds_read_b128 a[72:75], v35 offset:1024
    v_mfma_f32_16x16x32_bf16 v[124:127], a[140:143], a[24:27], v[124:127]
    buffer_load_dwordx4 a[88:91], v3, s[12:15], s18 offen offset:3072 sc1
    s_waitcnt lgkmcnt(5)
    s_nop 0
    v_mfma_f32_16x16x32_bf16 v[80:83], a[92:95], a[36:39], v[80:83]
    ds_read_b128 a[12:15], v32 offset:2048
    ds_read_b128 a[28:31], v27 offset:51200
    v_mfma_f32_16x16x32_bf16 v[128:131], a[52:55], a[36:39], v[128:131]
    v_cvt_pk_bf16_f32 v92, v172, v176
    v_mfma_f32_16x16x32_bf16 v[96:99], a[92:95], a[40:43], v[96:99]
    ds_read_b128 a[16:19], v33 offset:2048
    ds_read_b128 a[20:23], v34 offset:2048
    v_mfma_f32_16x16x32_bf16 v[100:103], a[92:95], a[44:47], v[100:103]
    ds_read_b128 a[24:27], v35 offset:2048
    v_mfma_f32_16x16x32_bf16 v[124:127], a[92:95], a[48:51], v[124:127]
    s_add_u32 m0, s61, 135168
    s_add_u32 s56, s17, 4419584
    buffer_load_dwordx4 v3, s[12:15], s56 offen sc1 lds
    s_waitcnt lgkmcnt(5)
    s_nop 0
    v_mfma_f32_16x16x32_bf16 v[80:83], a[96:99], a[60:63], v[80:83]
    ds_read_b128 a[36:39], v32 offset:3072
    ds_read_b128 a[52:55], v27 offset:52224
    v_mfma_f32_16x16x32_bf16 v[128:131], a[76:79], a[60:63], v[128:131]
    v_cvt_pk_bf16_f32 v44, v144, v145
    v_mfma_f32_16x16x32_bf16 v[96:99], a[96:99], a[64:67], v[96:99]
    ds_read_b128 a[40:43], v33 offset:3072
    ds_read_b128 a[44:47], v34 offset:3072
    v_mfma_f32_16x16x32_bf16 v[100:103], a[96:99], a[68:71], v[100:103]
    ds_read_b128 a[48:51], v35 offset:3072
    v_mfma_f32_16x16x32_bf16 v[124:127], a[96:99], a[72:75], v[124:127]
    s_add_u32 s29, s16, 4337664
    buffer_load_dwordx4 a[92:95], v3, s[12:15], s29 offen offset:0 sc1
    s_waitcnt lgkmcnt(5)
    s_nop 0
    v_mfma_f32_16x16x32_bf16 v[80:83], a[100:103], a[12:15], v[80:83]
    v_cvt_pk_bf16_f32 v46, v160, v161
    v_mfma_f32_16x16x32_bf16 v[128:131], a[28:31], a[12:15], v[128:131]
    v_cvt_pk_bf16_f32 v45, v146, v147
    v_mfma_f32_16x16x32_bf16 v[96:99], a[100:103], a[16:19], v[96:99]
    v_cvt_pk_bf16_f32 v47, v162, v163
    v_mfma_f32_16x16x32_bf16 v[100:103], a[100:103], a[20:23], v[100:103]
    v_cvt_pk_bf16_f32 v93, v173, v177
    v_mfma_f32_16x16x32_bf16 v[124:127], a[100:103], a[24:27], v[124:127]
    buffer_load_dwordx4 a[96:99], v3, s[12:15], s29 offen offset:1024 sc1
    s_waitcnt lgkmcnt(0)
    s_nop 0
    v_mfma_f32_16x16x32_bf16 v[80:83], a[104:107], a[36:39], v[80:83]
    v_cvt_pk_bf16_f32 v56, v148, v149
    v_mfma_f32_16x16x32_bf16 v[128:131], a[52:55], a[36:39], v[128:131]
    v_cvt_pk_bf16_f32 v58, v164, v165
    v_mfma_f32_16x16x32_bf16 v[96:99], a[104:107], a[40:43], v[96:99]
    v_cvt_pk_bf16_f32 v57, v150, v151
    v_mfma_f32_16x16x32_bf16 v[100:103], a[104:107], a[44:47], v[100:103]
    v_cvt_pk_bf16_f32 v59, v166, v167
    v_mfma_f32_16x16x32_bf16 v[124:127], a[104:107], a[48:51], v[124:127]
    buffer_load_dwordx4 a[100:103], v3, s[12:15], s29 offen offset:2048 sc1
    v_lshlrev_b32 v188, 16, v76
    v_and_b32 v189, 0xffff0000, v76
    v_lshlrev_b32 v190, 16, v77
    v_and_b32 v191, 0xffff0000, v77
    v_lshlrev_b32 v192, 16, v78
    v_and_b32 v193, 0xffff0000, v78
    v_lshlrev_b32 v194, 16, v79
    v_and_b32 v195, 0xffff0000, v79
    buffer_load_dwordx4 a[104:107], v3, s[12:15], s29 offen offset:3072 sc1
    v_lshlrev_b32 v196, 16, v84
    v_and_b32 v197, 0xffff0000, v84
    v_lshlrev_b32 v198, 16, v85
    v_and_b32 v199, 0xffff0000, v85
    v_lshlrev_b32 v200, 16, v86
    v_and_b32 v201, 0xffff0000, v86
    v_lshlrev_b32 v202, 16, v87
    v_and_b32 v203, 0xffff0000, v87
    v_lshlrev_b32 v204, 16, v88
    v_and_b32 v205, 0xffff0000, v88
    v_lshlrev_b32 v206, 16, v89
    v_and_b32 v207, 0xffff0000, v89
    v_pk_add_f32 v[80:81], v[80:81], v[188:189]
    v_pk_add_f32 v[82:83], v[82:83], v[190:191]
    v_pk_add_f32 v[96:97], v[96:97], v[192:193]
    v_pk_add_f32 v[98:99], v[98:99], v[194:195]
    s_add_u32 m0, s61, 131072
    s_add_u32 s56, s17, 4423680
    buffer_load_dwordx4 v3, s[12:15], s56 offen sc1 lds
    v_pk_add_f32 v[100:101], v[100:101], v[196:197]
    v_pk_add_f32 v[102:103], v[102:103], v[198:199]
    v_pk_add_f32 v[124:125], v[124:125], v[200:201]
    v_pk_add_f32 v[126:127], v[126:127], v[202:203]
    v_pk_add_f32 v[128:129], v[128:129], v[204:205]
    v_pk_add_f32 v[130:131], v[130:131], v[206:207]
    v_cvt_pk_bf16_f32 v76, v80, v81
    v_mov_b32 v188, v76
    v_cvt_pk_bf16_f32 v77, v82, v83
    v_mov_b32 v189, v77
    v_cvt_pk_bf16_f32 v78, v96, v97
    v_mov_b32 v190, v78
    v_cvt_pk_bf16_f32 v79, v98, v99
    v_mov_b32 v191, v79
    s_add_u32 s18, s16, 4341760
    buffer_load_dwordx4 a[140:143], v3, s[12:15], s18 offen offset:0 sc1
    v_cvt_pk_bf16_f32 v84, v100, v101
    v_mov_b32 v192, v84
    v_cvt_pk_bf16_f32 v85, v102, v103
    v_mov_b32 v193, v85
    v_cvt_pk_bf16_f32 v86, v124, v125
    v_mov_b32 v194, v86
    v_cvt_pk_bf16_f32 v87, v126, v127
    v_mov_b32 v195, v87
    v_cvt_pk_bf16_f32 v88, v128, v129
    v_mov_b32 v196, v88
    v_cvt_pk_bf16_f32 v89, v130, v131
    v_mov_b32 v197, v89
    v_mov_b32 v198, v196
    v_mov_b32 v199, v197
    s_add_u32 s48, s23, 12517376
    buffer_load_dwordx4 a[152:155], v3, s[12:15], s18 offen offset:1024 sc1
    v_permlane16_swap_b32 v188, v190
    v_permlane16_swap_b32 v189, v191
    v_permlane16_swap_b32 v192, v194
    v_permlane16_swap_b32 v193, v195
    v_permlane16_swap_b32 v196, v198
    v_permlane16_swap_b32 v197, v199
    buffer_store_dwordx4 v[188:191], v64, s[12:15], s48 offen sc1
    buffer_store_dwordx4 v[192:195], v65, s[12:15], s48 offen sc1
    buffer_store_dwordx4 v[196:199], v25, s[12:15], s48 offen sc1
    s_nop 1
    s_barrier
    v_lshlrev_b32_e64 v6, 4, v5
    buffer_load_dwordx4 a[156:159], v3, s[12:15], s18 offen offset:2048 sc1
    v_add_u32 v6, 161792, v6
    s_waitcnt vmcnt(16)
    s_barrier
    ds_read_b128 a[12:15], v48 offset:0
    ds_read_b128 a[28:31], v27 offset:61440
    ds_read_b128 a[16:19], v50 offset:0
    ds_read_b128 a[20:23], v52 offset:0
    ds_read_b128 a[24:27], v54 offset:0
    ds_read_b128 a[36:39], v49 offset:0
    ds_read_b128 a[52:55], v27 offset:62464
    ds_read_b128 a[40:43], v51 offset:0
    ds_read_b128 a[44:47], v53 offset:0
    ds_read_b128 a[48:51], v55 offset:0
    s_waitcnt lgkmcnt(9)
    s_nop 0
    v_mfma_f32_16x16x32_bf16 v[80:83], a[108:111], a[12:15], 0
    ds_read_b128 a[60:63], v48 offset:9216
    ds_read_b128 a[76:79], v27 offset:63488
    v_cvt_pk_bf16_f32 v94, v174, v178
    v_cvt_pk_bf16_f32 v60, v152, v153
    v_cvt_pk_bf16_f32 v62, v168, v169
    v_cvt_pk_bf16_f32 v61, v154, v155
    ds_read_b128 v[188:191], v6 offset:0
    buffer_load_dwordx4 a[160:163], v3, s[12:15], s18 offen offset:3072 sc1
    v_cvt_pk_bf16_f32 v63, v170, v171
    v_cvt_pk_bf16_f32 v95, v175, v179
    s_lshl_b32 s8, s3, 13
    s_add_u32 s8, s8, 92160
    s_waitcnt lgkmcnt(11)
    v_mfma_f32_16x16x32_bf16 v[128:131], a[28:31], a[12:15], 0
    s_add_u32 s29, s90, 7929856
    buffer_load_dwordx4 a[164:167], v3, s[12:15], s29 offen offset:0 sc1
    v_lshl_add_u32 v136, v5, 4, s8
    v_lshl_add_u32 v137, v5, 2, s8
    v_lshl_add_u32 v138, v5, 3, s8
    v_mov_b32 v139, 0x3f80
    s_waitcnt lgkmcnt(10)
    v_mfma_f32_16x16x32_bf16 v[96:99], a[108:111], a[16:19], 0
    ds_read_b128 a[64:67], v50 offset:9216
    ds_read_b128 a[68:71], v52 offset:9216
    s_mov_b32 vcc_lo, 0xffff0000
    s_mov_b32 vcc_hi, 0x0
    v_cndmask_b32 v139, 0, v139, vcc
    v_mul_u32_u24 v132, 80, v36
    v_add_u32 v133, v132, v137
    v_add_u32 v132, v132, v136
    s_waitcnt lgkmcnt(11)
    v_mfma_f32_16x16x32_bf16 v[100:103], a[108:111], a[20:23], 0
    ds_read_b128 a[72:75], v54 offset:9216
    v_mad_u32_u24 v134, v36, 48, v138
    v_or_b32_e64 v106, v106, v139
    ds_write_b128 v132, v[40:43]
    ds_write_b32 v133, v92 offset:64
    s_waitcnt lgkmcnt(13)
    v_mfma_f32_16x16x32_bf16 v[124:127], a[108:111], a[24:27], 0
    buffer_load_dwordx4 a[168:171], v3, s[12:15], s29 offen offset:1024 sc1
    ds_write_b64 v134, v[104:105] offset:5120
    s_mov_b32 exec_lo, 0xffffffff
    s_mov_b32 exec_hi, 0x0
    ds_write_b64 v134, v[106:107] offset:5152
    s_mov_b64 exec, -1
    v_mul_u32_u24 v132, 80, v37
    v_add_u32 v133, v132, v137
    s_waitcnt lgkmcnt(7)
    v_mfma_f32_16x16x32_bf16 v[196:199], v[188:191], a[12:15], 0
    buffer_load_dwordx4 a[172:175], v3, s[12:15], s29 offen offset:2048 sc1
    v_add_u32 v132, v132, v136
    v_mad_u32_u24 v134, v37, 48, v138
    v_or_b32 v110, v110, v139
    ds_write_b128 v132, v[44:47]
    v_mfma_f32_16x16x32_bf16 v[80:83], a[112:115], a[36:39], v[80:83]
    ds_read_b128 a[12:15], v49 offset:9216
    ds_read_b128 a[28:31], v27 offset:64512
    ds_write_b32 v133, v93 offset:64
    ds_write_b64 v134, v[108:109] offset:5120
    s_mov_b32 exec_lo, 0xffffffff
    s_mov_b32 exec_hi, 0x0
    ds_write_b64 v134, v[110:111] offset:5152
    s_mov_b64 exec, -1
    v_mul_u32_u24 v132, 80, v38
    ds_read_b128 v[192:195], v6 offset:64
    buffer_load_dwordx4 a[108:111], v3, s[12:15], s29 offen offset:3072 sc1
    v_add_u32 v133, v132, v137
    v_add_u32 v132, v132, v136
    v_mad_u32_u24 v134, v38, 48, v138
    v_or_b32 v114, v114, v139
    v_mfma_f32_16x16x32_bf16 v[128:131], a[52:55], a[36:39], v[128:131]
    s_add_u32 s18, s90, 7933952
    buffer_load_dwordx4 a[176:179], v3, s[12:15], s18 offen offset:0 sc1
    ds_write_b128 v132, v[56:59]
    ds_write_b32 v133, v94 offset:64
    ds_write_b64 v134, v[112:113] offset:5120
    s_mov_b32 exec_lo, 0xffffffff
    s_mov_b32 exec_hi, 0x0
    ds_write_b64 v134, v[114:115] offset:5152
    s_mov_b64 exec, -1
    v_mfma_f32_16x16x32_bf16 v[96:99], a[112:115], a[40:43], v[96:99]
    ds_read_b128 a[16:19], v51 offset:9216
    ds_read_b128 a[20:23], v53 offset:9216
    v_mul_u32_u24 v132, 80, v39
    v_add_u32 v133, v132, v137
    v_add_u32_e64 v132, v132, v136
    v_mad_u32_u24 v134, v39, 48, v138
    v_mfma_f32_16x16x32_bf16 v[100:103], a[112:115], a[44:47], v[100:103]
    ds_read_b128 a[24:27], v55 offset:9216
    v_or_b32_e64 v118, v118, v139
    ds_write_b128 v132, v[60:63]
    ds_write_b32 v133, v95 offset:64
    ds_write_b64 v134, v[116:117] offset:5120
    v_mfma_f32_16x16x32_bf16 v[124:127], a[112:115], a[48:51], v[124:127]
    buffer_load_dwordx4 a[180:183], v3, s[12:15], s18 offen offset:1024 sc1
    s_mov_b32 exec_lo, 0xffffffff
    s_mov_b32 exec_hi, 0x0
    ds_write_b64 v134, v[118:119] offset:5152
    s_mov_b64 exec, -1
    v_bfe_u32 v135, v2, 2, 2
    v_lshl_add_u32 v135, v5, 3, v135
    v_and_b32 v136, 3, v2
    s_waitcnt lgkmcnt(11)
    v_mfma_f32_16x16x32_bf16 v[196:199], v[192:195], a[36:39], v[196:199]
    buffer_load_dwordx4 a[184:187], v3, s[12:15], s18 offen offset:2048 sc1
    v_lshl_add_u32 v136, v136, 3, s8
    v_mul_u32_u24 v137, 80, v135
    v_add_u32 v137, v137, v136
    v_mad_u32_u24 v138, v135, 48, v136
    s_waitcnt lgkmcnt(0)
    s_barrier
    v_mfma_f32_16x16x32_bf16 v[80:83], a[84:87], a[60:63], v[80:83]
    ds_read_b128 a[36:39], v48 offset:18432
    ds_read_b128 a[52:55], v27 offset:57344
    ds_read_b64_tr_b16 v[140:141], v137 offset:0
    ds_read_b64_tr_b16 v[142:143], v137 offset:320
    ds_read_b64_tr_b16 v[144:145], v137 offset:32
    ds_read_b128 v[188:191], v6 offset:128
    ds_read_b64_tr_b16 v[146:147], v137 offset:352
    ds_read_b64_tr_b16 v[148:149], v137 offset:64
    ds_read_b64_tr_b16 v[150:151], v137 offset:384
    ds_read_b64_tr_b16 v[104:105], v138 offset:5120
    v_mfma_f32_16x16x32_bf16 v[128:131], a[76:79], a[60:63], v[128:131]
    ds_read_b64_tr_b16 v[106:107], v138 offset:5312
    ds_read_b64_tr_b16 v[108:109], v138 offset:5152
    ds_read_b64_tr_b16 v[110:111], v138 offset:5344
    ds_read_b64_tr_b16 v[152:153], v137 offset:2560
    v_mfma_f32_16x16x32_bf16 v[96:99], a[84:87], a[64:67], v[96:99]
    ds_read_b128 a[40:43], v50 offset:18432
    ds_read_b128 a[44:47], v52 offset:18432
    ds_read_b64_tr_b16 v[154:155], v137 offset:2880
    ds_read_b64_tr_b16 v[156:157], v137 offset:2592
    ds_read_b64_tr_b16 v[158:159], v137 offset:2912
    ds_read_b64_tr_b16 v[160:161], v137 offset:2624
    v_mfma_f32_16x16x32_bf16 v[100:103], a[84:87], a[68:71], v[100:103]
    ds_read_b128 a[48:51], v54 offset:18432
    ds_read_b64_tr_b16 v[162:163], v137 offset:2944
    ds_read_b64_tr_b16 v[112:113], v138 offset:6656
    ds_read_b64_tr_b16 v[114:115], v138 offset:6848
    ds_read_b64_tr_b16 v[116:117], v138 offset:6688
    v_mfma_f32_16x16x32_bf16 v[124:127], a[84:87], a[72:75], v[124:127]
    ds_read_b64_tr_b16 v[118:119], v138 offset:6880
    s_waitcnt lgkmcnt(15)
    s_nop 0
    v_mfma_f32_16x16x32_bf16 v[196:199], v[188:191], a[60:63], v[196:199]
    v_mfma_f32_16x16x32_bf16 v[80:83], a[116:119], a[12:15], v[80:83]
    ds_read_b128 a[60:63], v49 offset:18432
    ds_read_b128 a[76:79], v27 offset:58368
    ds_read_b128 v[192:195], v6 offset:192
    v_mfma_f32_16x16x32_bf16 v[128:131], a[28:31], a[12:15], v[128:131]
    v_mfma_f32_16x16x32_bf16 v[96:99], a[116:119], a[16:19], v[96:99]
    ds_read_b128 a[64:67], v51 offset:18432
    ds_read_b128 a[68:71], v53 offset:18432
    s_waitcnt lgkmcnt(15)
    v_mfma_f32_16x16x32_bf16 v[164:167], v[140:143], v[104:107], 0
    v_mfma_f32_16x16x32_bf16 v[168:171], v[140:143], v[108:111], 0
    s_waitcnt vmcnt(9)
    v_mfma_f32_16x16x32_bf16 v[172:175], v[144:147], v[104:107], 0
    v_mfma_f32_16x16x32_bf16 v[176:179], v[144:147], v[108:111], 0
    v_mfma_f32_16x16x32_bf16 v[180:183], v[148:151], v[104:107], 0
    v_mfma_f32_16x16x32_bf16 v[100:103], a[116:119], a[20:23], v[100:103]
    ds_read_b128 a[72:75], v55 offset:18432
    v_mfma_f32_16x16x32_bf16 v[184:187], v[148:151], v[108:111], 0
    v_mfma_f32_16x16x32_bf16 v[124:127], a[116:119], a[24:27], v[124:127]
    buffer_load_dwordx4 a[84:87], v3, s[12:15], s18 offen offset:3072 sc1
    s_waitcnt lgkmcnt(3)
    v_mfma_f32_16x16x32_bf16 v[196:199], v[192:195], a[12:15], v[196:199]
    s_add_u32 s29, s90, 7938048
    buffer_load_dwordx4 a[112:115], v3, s[12:15], s29 offen offset:0 sc1
    v_mfma_f32_16x16x32_bf16 v[164:167], v[152:155], v[112:115], v[164:167]
    s_barrier
    s_add_u32 s69, s21, 16384
    s_mov_b64 exec, 1
    buffer_store_dword v23, v24, s[12:15], s69 offen sc1
    s_mov_b64 exec, -1
    v_mfma_f32_16x16x32_bf16 v[168:171], v[152:155], v[116:119], v[168:171]
    v_mfma_f32_16x16x32_bf16 v[172:175], v[156:159], v[112:115], v[172:175]
    v_mfma_f32_16x16x32_bf16 v[176:179], v[156:159], v[116:119], v[176:179]
    v_mfma_f32_16x16x32_bf16 v[180:183], v[160:163], v[112:115], v[180:183]
    v_mfma_f32_16x16x32_bf16 v[80:83], a[120:123], a[36:39], v[80:83]
    ds_read_b128 a[12:15], v48 offset:27648
    ds_read_b128 a[28:31], v27 offset:59392
    v_mfma_f32_16x16x32_bf16 v[184:187], v[160:163], v[116:119], v[184:187]
    v_mul_u32_u24 v132, 160, v4
    v_lshl_add_u32 v132, v5, 4, v132
    v_add_u32_e64 v132, s8, v132
    ds_read_b128 v[188:191], v6 offset:256
    buffer_load_dwordx4 a[116:119], v3, s[12:15], s29 offen offset:1024 sc1
    v_add_u32_e64 v134, s8, v3
    v_mfma_f32_16x16x32_bf16 v[128:131], a[52:55], a[36:39], v[128:131]
    v_mfma_f32_16x16x32_bf16 v[96:99], a[120:123], a[40:43], v[96:99]
    ds_read_b128 a[16:19], v50 offset:27648
    ds_read_b128 a[20:23], v52 offset:27648
    v_mfma_f32_16x16x32_bf16 v[100:103], a[120:123], a[44:47], v[100:103]
    ds_read_b128 a[24:27], v54 offset:27648
    ds_write_b128 v132, v[164:167] offset:0
    ds_write_b128 v132, v[172:175] offset:64
    s_mov_b32 exec_lo, 0xffffffff
    s_mov_b32 exec_hi, 0x0
    ds_write_b128 v132, v[180:183] offset:128
    s_mov_b32 exec_lo, 0x1f001f
    s_mov_b32 exec_hi, 0x1f001f
    ds_write_b128 v132, v[168:171] offset:2560
    ds_write_b128 v132, v[176:179] offset:2624
    s_mov_b64 exec, 0x1f001f
    ds_write_b128 v132, v[184:187] offset:2688
    s_mov_b64 exec, -1
    v_mfma_f32_16x16x32_bf16 v[124:127], a[120:123], a[48:51], v[124:127]
    buffer_load_dwordx4 a[188:191], v3, s[12:15], s29 offen offset:2048 sc1
    buffer_load_dwordx4 a[192:195], v3, s[12:15], s29 offen offset:3072 sc1
    s_waitcnt lgkmcnt(9)
    v_mfma_f32_16x16x32_bf16 v[196:199], v[188:191], a[36:39], v[196:199]
    v_mfma_f32_16x16x32_bf16 v[80:83], a[124:127], a[60:63], v[80:83]
    ds_read_b128 a[36:39], v49 offset:27648
    ds_read_b128 a[52:55], v27 offset:60416
    ds_read_b128 v[192:195], v6 offset:320
    s_add_u32 s18, s90, 7942144
    buffer_load_dwordx4 a[120:123], v3, s[12:15], s18 offen offset:0 sc1
    v_mfma_f32_16x16x32_bf16 v[128:131], a[76:79], a[60:63], v[128:131]
    v_mfma_f32_16x16x32_bf16 v[96:99], a[124:127], a[64:67], v[96:99]
    ds_read_b128 a[40:43], v51 offset:27648
    ds_read_b128 a[44:47], v53 offset:27648
    v_mfma_f32_16x16x32_bf16 v[100:103], a[124:127], a[68:71], v[100:103]
    ds_read_b128 a[48:51], v55 offset:27648
    v_mfma_f32_16x16x32_bf16 v[124:127], a[124:127], a[72:75], v[124:127]
    buffer_load_dwordx4 a[196:199], v3, s[12:15], s18 offen offset:1024 sc1
    s_waitcnt lgkmcnt(3)
    v_mfma_f32_16x16x32_bf16 v[196:199], v[192:195], a[60:63], v[196:199]
    buffer_load_dwordx4 a[200:203], v3, s[12:15], s18 offen offset:2048 sc1
    ds_read_b128 v[140:143], v134 offset:0
    ds_read_b128 v[144:147], v134 offset:1024
    ds_read_b128 v[148:151], v134 offset:2048
    s_waitcnt lgkmcnt(0)
    s_barrier
    v_mfma_f32_16x16x32_bf16 v[80:83], a[128:131], a[12:15], v[80:83]
    ds_read_b128 a[60:63], v48 offset:36864
    ds_read_b128 a[76:79], v27 offset:53248
    ds_read_b128 v[152:155], v134 offset:3072
    s_lshl_b32 s8, s43, 5
    s_add_u32 s8, s8, s42
    s_lshl_b32 s8, s8, 2
    ds_read_b128 v[188:191], v6 offset:384
    buffer_load_dwordx4 a[124:127], v3, s[12:15], s18 offen offset:3072 sc1
    s_add_u32 s8, s8, s3
    s_nop 0
    s_mul_i32 s8, s8, 3584
    s_add_u32 s8, s8, 24051712
    v_mfma_f32_16x16x32_bf16 v[128:131], a[28:31], a[12:15], v[128:131]
    v_mfma_f32_16x16x32_bf16 v[96:99], a[128:131], a[16:19], v[96:99]
    ds_read_b128 a[64:67], v50 offset:36864
    ds_read_b128 a[68:71], v52 offset:36864
    v_mfma_f32_16x16x32_bf16 v[100:103], a[128:131], a[20:23], v[100:103]
    ds_read_b128 a[72:75], v54 offset:36864
    v_mfma_f32_16x16x32_bf16 v[124:127], a[128:131], a[24:27], v[124:127]
    s_add_u32 s29, s90, 7946240
    buffer_load_dwordx4 a[204:207], v3, s[12:15], s29 offen offset:0 sc1
    s_waitcnt lgkmcnt(4)
    buffer_store_dwordx4 v[140:143], v3, s[12:15], s8 offen offset:0 sc1
    buffer_store_dwordx4 v[144:147], v3, s[12:15], s8 offen offset:1024 sc1
    buffer_store_dwordx4 v[148:151], v3, s[12:15], s8 offen offset:2048 sc1
    s_mov_b32 exec_lo, 0xffffffff
    s_mov_b32 exec_hi, 0x0
    buffer_store_dwordx4 v[152:155], v3, s[12:15], s8 offen offset:3072 sc1
    s_mov_b64 exec, -1
    s_nop 1
    s_waitcnt lgkmcnt(0)
    s_barrier
    s_nop 0
    v_mfma_f32_16x16x32_bf16 v[196:199], v[188:191], a[12:15], v[196:199]
    buffer_load_dwordx4 a[208:211], v3, s[12:15], s29 offen offset:1024 sc1
    v_mfma_f32_16x16x32_bf16 v[80:83], a[132:135], a[36:39], v[80:83]
    ds_read_b128 a[12:15], v49 offset:36864
    ds_read_b128 a[28:31], v27 offset:54272
    ds_read_b128 v[192:195], v6 offset:448
    v_mfma_f32_16x16x32_bf16 v[128:131], a[52:55], a[36:39], v[128:131]
    buffer_load_dwordx4 a[128:131], v3, s[12:15], s29 offen offset:2048 sc1
    v_mfma_f32_16x16x32_bf16 v[96:99], a[132:135], a[40:43], v[96:99]
    ds_read_b128 a[16:19], v51 offset:36864
    ds_read_b128 a[20:23], v53 offset:36864
    v_mfma_f32_16x16x32_bf16 v[100:103], a[132:135], a[44:47], v[100:103]
    ds_read_b128 a[24:27], v55 offset:36864
    v_mfma_f32_16x16x32_bf16 v[124:127], a[132:135], a[48:51], v[124:127]
    buffer_load_dwordx4 a[212:215], v3, s[12:15], s29 offen offset:3072 sc1
    s_waitcnt lgkmcnt(3)
    s_nop 0
    v_mfma_f32_16x16x32_bf16 v[196:199], v[192:195], a[36:39], v[196:199]
    s_add_u32 s18, s90, 8011776
    buffer_load_dwordx4 a[216:219], v3, s[12:15], s18 offen offset:0 sc1
    v_mfma_f32_16x16x32_bf16 v[80:83], a[136:139], a[60:63], v[80:83]
    ds_read_b128 a[36:39], v48 offset:46080
    ds_read_b128 a[52:55], v27 offset:55296
    ds_read_b128 v[188:191], v6 offset:512
    v_mfma_f32_16x16x32_bf16 v[128:131], a[76:79], a[60:63], v[128:131]
    v_mfma_f32_16x16x32_bf16 v[96:99], a[136:139], a[64:67], v[96:99]
    ds_read_b128 a[40:43], v50 offset:46080
    ds_read_b128 a[44:47], v52 offset:46080
    v_mfma_f32_16x16x32_bf16 v[100:103], a[136:139], a[68:71], v[100:103]
    ds_read_b128 a[48:51], v54 offset:46080
    v_mfma_f32_16x16x32_bf16 v[124:127], a[136:139], a[72:75], v[124:127]
    buffer_load_dwordx4 a[132:135], v3, s[12:15], s18 offen offset:1024 sc1
    s_waitcnt lgkmcnt(3)
    s_nop 0
    v_mfma_f32_16x16x32_bf16 v[196:199], v[188:191], a[60:63], v[196:199]
    buffer_load_dwordx4 a[220:223], v3, s[12:15], s18 offen offset:2048 sc1
    v_mfma_f32_16x16x32_bf16 v[80:83], a[144:147], a[12:15], v[80:83]
    ds_read_b128 a[60:63], v49 offset:46080
    ds_read_b128 a[76:79], v27 offset:56320
    ds_read_b128 v[192:195], v6 offset:576
    v_mfma_f32_16x16x32_bf16 v[128:131], a[28:31], a[12:15], v[128:131]
    v_mfma_f32_16x16x32_bf16 v[96:99], a[144:147], a[16:19], v[96:99]
    ds_read_b128 a[64:67], v51 offset:46080
    ds_read_b128 a[68:71], v53 offset:46080
    v_mfma_f32_16x16x32_bf16 v[100:103], a[144:147], a[20:23], v[100:103]
    ds_read_b128 a[72:75], v55 offset:46080
    v_mfma_f32_16x16x32_bf16 v[124:127], a[144:147], a[24:27], v[124:127]
    buffer_load_dwordx4 a[136:139], v3, s[12:15], s18 offen offset:3072 sc1
    s_waitcnt lgkmcnt(3)
    v_mfma_f32_16x16x32_bf16 v[196:199], v[192:195], a[12:15], v[196:199]
    s_waitcnt lgkmcnt(0)
    s_barrier
    s_nop 0
    v_add_u32 v48, 55296, v48
    v_add_u32 v49, 55296, v49
    v_add_u32 v50, 55296, v50
    v_add_u32 v51, 55296, v51
    v_add_u32 v52, 55296, v52
    v_add_u32 v53, 55296, v53
    v_add_u32 v54, 55296, v54
    v_add_u32 v55, 55296, v55
    v_mfma_f32_16x16x32_bf16 v[80:83], a[148:151], a[36:39], v[80:83]
    ds_read_b128 a[12:15], v48 offset:0
    ds_read_b128 a[28:31], v27 offset:45056
    ds_read_b128 v[188:191], v6 offset:640
    s_add_u32 s29, s90, 8015872
    buffer_load_dwordx4 a[144:147], v3, s[12:15], s29 offen offset:0 sc1
    v_mfma_f32_16x16x32_bf16 v[128:131], a[52:55], a[36:39], v[128:131]
    v_mfma_f32_16x16x32_bf16 v[96:99], a[148:151], a[40:43], v[96:99]
    ds_read_b128 a[16:19], v50 offset:0
    ds_read_b128 a[20:23], v52 offset:0
    v_mfma_f32_16x16x32_bf16 v[100:103], a[148:151], a[44:47], v[100:103]
    ds_read_b128 a[24:27], v54 offset:0
    v_mfma_f32_16x16x32_bf16 v[124:127], a[148:151], a[48:51], v[124:127]
    buffer_load_dwordx4 a[224:227], v3, s[12:15], s29 offen offset:1024 sc1
    s_waitcnt lgkmcnt(3)
    s_nop 0
    v_mfma_f32_16x16x32_bf16 v[196:199], v[188:191], a[36:39], v[196:199]
    v_mfma_f32_16x16x32_bf16 v[80:83], a[88:91], a[60:63], v[80:83]
    ds_read_b128 a[36:39], v49 offset:0
    ds_read_b128 a[52:55], v27 offset:46080
    ds_read_b128 v[192:195], v6 offset:704
    v_mfma_f32_16x16x32_bf16 v[128:131], a[76:79], a[60:63], v[128:131]
    v_mfma_f32_16x16x32_bf16 v[96:99], a[88:91], a[64:67], v[96:99]
    ds_read_b128 a[40:43], v51 offset:0
    ds_read_b128 a[44:47], v53 offset:0
    v_mfma_f32_16x16x32_bf16 v[100:103], a[88:91], a[68:71], v[100:103]
    ds_read_b128 a[48:51], v55 offset:0
    v_mfma_f32_16x16x32_bf16 v[124:127], a[88:91], a[72:75], v[124:127]
    s_waitcnt lgkmcnt(3)
    s_nop 0
    v_mfma_f32_16x16x32_bf16 v[196:199], v[192:195], a[60:63], v[196:199]
    v_mfma_f32_16x16x32_bf16 v[80:83], a[92:95], a[12:15], v[80:83]
    ds_read_b128 a[60:63], v48 offset:9216
    ds_read_b128 a[76:79], v27 offset:47104
    ds_read_b128 v[188:191], v6 offset:768
    v_mfma_f32_16x16x32_bf16 v[128:131], a[28:31], a[12:15], v[128:131]
    v_mfma_f32_16x16x32_bf16 v[96:99], a[92:95], a[16:19], v[96:99]
    ds_read_b128 a[64:67], v50 offset:9216
    ds_read_b128 a[68:71], v52 offset:9216
    v_mfma_f32_16x16x32_bf16 v[100:103], a[92:95], a[20:23], v[100:103]
    ds_read_b128 a[72:75], v54 offset:9216
    v_mfma_f32_16x16x32_bf16 v[124:127], a[92:95], a[24:27], v[124:127]
    s_waitcnt lgkmcnt(3)
    s_nop 0
    v_mfma_f32_16x16x32_bf16 v[196:199], v[188:191], a[12:15], v[196:199]
    v_mfma_f32_16x16x32_bf16 v[80:83], a[96:99], a[36:39], v[80:83]
    ds_read_b128 a[12:15], v49 offset:9216
    ds_read_b128 a[28:31], v27 offset:48128
    ds_read_b128 v[192:195], v6 offset:832
    v_mfma_f32_16x16x32_bf16 v[128:131], a[52:55], a[36:39], v[128:131]
    v_mfma_f32_16x16x32_bf16 v[96:99], a[96:99], a[40:43], v[96:99]
    ds_read_b128 a[16:19], v51 offset:9216
    ds_read_b128 a[20:23], v53 offset:9216
    v_mfma_f32_16x16x32_bf16 v[100:103], a[96:99], a[44:47], v[100:103]
    ds_read_b128 a[24:27], v55 offset:9216
    v_mfma_f32_16x16x32_bf16 v[124:127], a[96:99], a[48:51], v[124:127]
    s_waitcnt lgkmcnt(3)
    v_mfma_f32_16x16x32_bf16 v[196:199], v[192:195], a[36:39], v[196:199]
    s_waitcnt lgkmcnt(0)
    s_barrier
    s_nop 0
    v_mfma_f32_16x16x32_bf16 v[80:83], a[100:103], a[60:63], v[80:83]
    ds_read_b128 a[36:39], v48 offset:18432
    ds_read_b128 a[52:55], v27 offset:40960
    ds_read_b128 v[188:191], v6 offset:896
    v_mfma_f32_16x16x32_bf16 v[128:131], a[76:79], a[60:63], v[128:131]
    v_mfma_f32_16x16x32_bf16 v[96:99], a[100:103], a[64:67], v[96:99]
    ds_read_b128 a[40:43], v50 offset:18432
    ds_read_b128 a[44:47], v52 offset:18432
    v_mfma_f32_16x16x32_bf16 v[100:103], a[100:103], a[68:71], v[100:103]
    ds_read_b128 a[48:51], v54 offset:18432
    v_mfma_f32_16x16x32_bf16 v[124:127], a[100:103], a[72:75], v[124:127]
    s_waitcnt lgkmcnt(3)
    v_mfma_f32_16x16x32_bf16 v[196:199], v[188:191], a[60:63], v[196:199]
    s_add_u32 s8, s58, 16384
    buffer_load_dword v16, v7, s[12:15], s8 offen offset:0 sc1
    s_waitcnt vmcnt(10)
    v_mfma_f32_16x16x32_bf16 v[80:83], a[104:107], a[12:15], v[80:83]
    ds_read_b128 a[60:63], v49 offset:18432
    ds_read_b128 a[76:79], v27 offset:41984
    ds_read_b128 v[192:195], v6 offset:960
    v_mfma_f32_16x16x32_bf16 v[128:131], a[28:31], a[12:15], v[128:131]
    v_mfma_f32_16x16x32_bf16 v[96:99], a[104:107], a[16:19], v[96:99]
    ds_read_b128 a[64:67], v51 offset:18432
    ds_read_b128 a[68:71], v53 offset:18432
    v_mfma_f32_16x16x32_bf16 v[100:103], a[104:107], a[20:23], v[100:103]
    ds_read_b128 a[72:75], v55 offset:18432
    v_mfma_f32_16x16x32_bf16 v[124:127], a[104:107], a[24:27], v[124:127]
    buffer_load_dwordx4 a[88:91], v3, s[12:15], s29 offen offset:2048 sc1
    s_waitcnt lgkmcnt(3)
    s_nop 0
    v_mfma_f32_16x16x32_bf16 v[196:199], v[192:195], a[12:15], v[196:199]
    v_mfma_f32_16x16x32_bf16 v[80:83], a[140:143], a[36:39], v[80:83]
    ds_read_b128 a[12:15], v48 offset:27648
    ds_read_b128 a[28:31], v27 offset:43008
    ds_read_b128 v[188:191], v6 offset:1024
    buffer_load_dwordx4 a[92:95], v3, s[12:15], s29 offen offset:3072 sc1
    v_mfma_f32_16x16x32_bf16 v[128:131], a[52:55], a[36:39], v[128:131]
    v_mfma_f32_16x16x32_bf16 v[96:99], a[140:143], a[40:43], v[96:99]
    ds_read_b128 a[16:19], v50 offset:27648
    ds_read_b128 a[20:23], v52 offset:27648
    v_mfma_f32_16x16x32_bf16 v[100:103], a[140:143], a[44:47], v[100:103]
    s_barrier
    s_add_u32 s69, s22, 32768
    s_mov_b64 exec, 1
    buffer_store_dword v23, v24, s[12:15], s69 offen sc1
    s_mov_b64 exec, -1
    ds_read_b128 a[24:27], v54 offset:27648
    v_mfma_f32_16x16x32_bf16 v[124:127], a[140:143], a[48:51], v[124:127]
    s_add_u32 s18, s90, 8019968
    buffer_load_dwordx4 a[96:99], v3, s[12:15], s18 offen offset:0 sc1
    s_waitcnt lgkmcnt(3)
    v_mfma_f32_16x16x32_bf16 v[196:199], v[188:191], a[36:39], v[196:199]
    v_mfma_f32_16x16x32_bf16 v[80:83], a[152:155], a[60:63], v[80:83]
    ds_read_b128 a[36:39], v49 offset:27648
    ds_read_b128 a[52:55], v27 offset:44032
    ds_read_b128 v[192:195], v6 offset:1088
    buffer_load_dwordx4 a[100:103], v3, s[12:15], s18 offen offset:1024 sc1
    v_mfma_f32_16x16x32_bf16 v[128:131], a[76:79], a[60:63], v[128:131]
    v_mfma_f32_16x16x32_bf16 v[96:99], a[152:155], a[64:67], v[96:99]
    ds_read_b128 a[40:43], v51 offset:27648
    ds_read_b128 a[44:47], v53 offset:27648
    v_mfma_f32_16x16x32_bf16 v[100:103], a[152:155], a[68:71], v[100:103]
    ds_read_b128 a[48:51], v55 offset:27648
    v_mfma_f32_16x16x32_bf16 v[124:127], a[152:155], a[72:75], v[124:127]
    buffer_load_dwordx4 a[104:107], v3, s[12:15], s18 offen offset:2048 sc1
    s_waitcnt lgkmcnt(3)
    s_nop 0
    v_mfma_f32_16x16x32_bf16 v[196:199], v[192:195], a[60:63], v[196:199]
    v_mfma_f32_16x16x32_bf16 v[80:83], a[156:159], a[12:15], v[80:83]
    ds_read_b128 v[188:191], v6 offset:1152
    buffer_load_dwordx4 a[140:143], v3, s[12:15], s18 offen offset:3072 sc1
    v_mfma_f32_16x16x32_bf16 v[128:131], a[28:31], a[12:15], v[128:131]
    v_mfma_f32_16x16x32_bf16 v[96:99], a[156:159], a[16:19], v[96:99]
    v_mfma_f32_16x16x32_bf16 v[100:103], a[156:159], a[20:23], v[100:103]
    v_mfma_f32_16x16x32_bf16 v[124:127], a[156:159], a[24:27], v[124:127]
    s_add_u32 s29, s90, 8024064
    buffer_load_dwordx4 a[148:151], v3, s[12:15], s29 offen offset:0 sc1
    s_waitcnt lgkmcnt(0)
    s_nop 0
    v_mfma_f32_16x16x32_bf16 v[196:199], v[188:191], a[12:15], v[196:199]
    v_mfma_f32_16x16x32_bf16 v[80:83], a[160:163], a[36:39], v[80:83]
    ds_read_b128 v[192:195], v6 offset:1216
    v_mfma_f32_16x16x32_bf16 v[128:131], a[52:55], a[36:39], v[128:131]
    v_mfma_f32_16x16x32_bf16 v[96:99], a[160:163], a[40:43], v[96:99]
    v_mfma_f32_16x16x32_bf16 v[100:103], a[160:163], a[44:47], v[100:103]
    v_mfma_f32_16x16x32_bf16 v[124:127], a[160:163], a[48:51], v[124:127]
    buffer_load_dwordx4 a[152:155], v3, s[12:15], s29 offen offset:1024 sc1
    s_waitcnt lgkmcnt(0)
    v_mfma_f32_16x16x32_bf16 v[196:199], v[192:195], a[36:39], v[196:199]
    s_barrier
    s_barrier
    s_nop 0
    v_cvt_pk_bf16_f32 v128, v128, v129
    buffer_load_dwordx4 a[156:159], v3, s[12:15], s29 offen offset:2048 sc1
    v_cvt_pk_bf16_f32 v129, v130, v131
    ds_write_b64 v75, v[128:129] offset:0
    v_cvt_pk_bf16_f32 v80, v80, v81
    v_cvt_pk_bf16_f32 v81, v82, v83
    v_mov_b32 v82, 0
    v_mov_b32 v83, 0
    v_cvt_pk_bf16_f32 v96, v96, v97
    v_cvt_pk_bf16_f32 v97, v98, v99
    v_mov_b32 v98, 0
    v_mov_b32 v99, 0
    v_cvt_pk_bf16_f32 v100, v100, v101
    v_cvt_pk_bf16_f32 v101, v102, v103
    s_waitcnt vmcnt(10)
    v_cmp_ne_u32 vcc, s47, v16
    s_nop 0
    s_cbranch_vccnz Lslow13
Lback14:
    s_add_u32 m0, s62, 0
    s_add_u32 s57, s19, 12517376
    buffer_load_dwordx4 v3, s[12:15], s57 offen offset:0 sc1 lds
    buffer_load_dwordx4 v3, s[12:15], s57 offen offset:1024 sc1 lds
    buffer_load_dwordx4 v3, s[12:15], s57 offen offset:2048 sc1 lds
    buffer_load_dwordx4 v3, s[12:15], s57 offen offset:3072 sc1 lds
    v_mov_b32 v102, 0
    v_mov_b32_e64 v103, 0
    v_cvt_pk_bf16_f32 v124, v124, v125
    v_cvt_pk_bf16_f32 v125, v126, v127
    v_mov_b32 v126, 0
    v_mov_b32 v127, 0
    v_mul_f32 v196, s66, v196
    v_exp_f32 v196, -v196
    s_nop 0
    v_add_f32 v196, 1.0, v196
    v_rcp_f32 v196, v196
    v_lshlrev_b32 v52, 3, v36
    v_add_u32 v52, 161280, v52
    v_sub_f32 v197, 1.0, v196
    ds_write_b64 v52, v[196:197]
    s_waitcnt lgkmcnt(0)
    s_barrier
    s_mov_b64 exec, 0xffff
    ds_read_b64 v[82:83], v68 offset:0
    ds_read_b64 v[98:99], v69 offset:0
    ds_read_b64 v[102:103], v70 offset:0
    ds_read_b64 v[126:127], v71 offset:0
    s_mov_b64 exec, -1
    v_lshlrev_b32 v52, 3, v36
    v_add_u32 v52, 161280, v52
    v_mov_b32 v93, 0
    ds_read_b64 v[56:57], v52
    v_lshlrev_b32 v53, 3, v37
    v_add_u32 v53, 161280, v53
    v_mov_b32 v95, 0
    ds_read_b64 v[58:59], v53
    v_lshlrev_b32 v54, 3, v38
    v_add_u32 v54, 161280, v54
    v_mov_b32 v105, 0
    ds_read_b64 v[60:61], v54
    v_lshlrev_b32 v55, 3, v39
    v_add_u32 v55, 161280, v55
    v_mov_b32_e64 v107, 0
    ds_read_b64 v[62:63], v55
    s_add_u32 m0, s62, 16384
    s_add_u32 s57, s19, 12521472
    buffer_load_dwordx4 v3, s[12:15], s57 offen offset:0 sc1 lds
    buffer_load_dwordx4 v3, s[12:15], s57 offen offset:1024 sc1 lds
    buffer_load_dwordx4 v3, s[12:15], s57 offen offset:2048 sc1 lds
    buffer_load_dwordx4 v3, s[12:15], s57 offen offset:3072 sc1 lds
    s_add_u32 m0, s62, 32768
    s_add_u32 s57, s19, 12525568
    buffer_load_dwordx4 v3, s[12:15], s57 offen offset:0 sc1 lds
    s_waitcnt lgkmcnt(0)
    s_nop 0
    v_mfma_f32_16x16x32_bf16 v[108:111], a[4:7], v[80:83], 0
    v_mfma_f32_16x16x32_bf16 v[132:135], a[8:11], v[80:83], 0
    v_mfma_f32_16x16x32_bf16 v[112:115], a[4:7], v[96:99], 0
    v_mfma_f32_16x16x32_bf16 v[136:139], a[8:11], v[96:99], 0
    v_mfma_f32_16x16x32_bf16 v[116:119], a[4:7], v[100:103], 0
    v_mfma_f32_16x16x32_bf16 v[140:143], a[8:11], v[100:103], 0
    v_mfma_f32_16x16x32_bf16 v[120:123], a[4:7], v[124:127], 0
    v_mfma_f32_16x16x32_bf16 v[144:147], a[8:11], v[124:127], 0
    buffer_load_dwordx4 v3, s[12:15], s57 offen offset:1024 sc1 lds
    buffer_load_dwordx4 v3, s[12:15], s57 offen offset:2048 sc1 lds
    s_mov_b32 vcc_lo, 0xffff0000
    s_mov_b32 vcc_hi, 0x0
    v_cndmask_b32 v148, v132, v133, vcc
    v_cndmask_b32 v149, v136, v137, vcc
    v_cndmask_b32 v150, v140, v141, vcc
    s_nop 0
    v_cndmask_b32 v151, v144, v145, vcc
    s_mov_b32 vcc_lo, 0x0
    s_mov_b32 vcc_hi, 0xffff
    v_cndmask_b32 v148, v148, v134, vcc
    v_cndmask_b32 v149, v149, v138, vcc
    v_cndmask_b32 v150, v150, v142, vcc
    v_cndmask_b32 v151, v151, v146, vcc
    s_mov_b32 vcc_lo, 0x0
    s_mov_b32 vcc_hi, 0xffff0000
    v_cndmask_b32 v148, v148, v135, vcc
    v_cndmask_b32 v149, v149, v139, vcc
    v_cndmask_b32 v150, v150, v143, vcc
    v_cndmask_b32 v151, v151, v147, vcc
    s_waitcnt vmcnt(11)
    s_nop 0
    v_mfma_f32_16x16x32_bf16 v[44:47], a[156:159], a[0:3], 0
    v_mfma_f32_16x16x32_bf16 v[44:47], a[152:155], a[0:3], v[44:47]
    v_mfma_f32_16x16x32_bf16 v[44:47], a[148:151], a[0:3], v[44:47]
    v_mfma_f32_16x16x32_bf16 v[44:47], a[140:143], a[0:3], v[44:47]
    v_mfma_f32_16x16x32_bf16 v[44:47], a[104:107], a[0:3], v[44:47]
    v_mfma_f32_16x16x32_bf16 v[44:47], a[100:103], a[0:3], v[44:47]
    v_mfma_f32_16x16x32_bf16 v[44:47], a[96:99], a[0:3], v[44:47]
    v_mfma_f32_16x16x32_bf16 v[44:47], a[92:95], a[0:3], v[44:47]
    v_mfma_f32_16x16x32_bf16 v[44:47], a[88:91], a[0:3], v[44:47]
    v_mfma_f32_16x16x32_bf16 v[44:47], a[224:227], a[0:3], v[44:47]
    v_mfma_f32_16x16x32_bf16 v[44:47], a[144:147], a[0:3], v[44:47]
    v_mfma_f32_16x16x32_bf16 v[44:47], a[136:139], a[0:3], v[44:47]
    v_mfma_f32_16x16x32_bf16 v[44:47], a[220:223], a[0:3], v[44:47]
    v_mfma_f32_16x16x32_bf16 v[44:47], a[132:135], a[0:3], v[44:47]
    v_mfma_f32_16x16x32_bf16 v[44:47], a[216:219], a[0:3], v[44:47]
    buffer_load_dwordx4 v3, s[12:15], s57 offen offset:3072 sc1 lds
    v_mfma_f32_16x16x32_bf16 v[40:43], a[212:215], a[0:3], 0
    v_mfma_f32_16x16x32_bf16 v[40:43], a[128:131], a[0:3], v[40:43]
    v_mfma_f32_16x16x32_bf16 v[40:43], a[208:211], a[0:3], v[40:43]
    v_mfma_f32_16x16x32_bf16 v[40:43], a[204:207], a[0:3], v[40:43]
    v_cvt_pk_bf16_f32 v132, v108, v109
    s_waitcnt vmcnt(8)
    s_barrier
    v_add_u32_e64 v32, 0, v28
    s_add_u32 m0, s62, 49152
    s_add_u32 s57, s19, 12529664
    buffer_load_dwordx4 v3, s[12:15], s57 offen offset:0 sc1 lds
    v_add_u32 v33, 0, v29
    v_add_u32 v34, 0, v30
    v_add_u32_e64 v35, 0, v31
    ds_read_b128 a[12:15], v32 offset:0
    ds_read_b128 a[16:19], v33 offset:0
    ds_read_b128 a[20:23], v34 offset:0
    ds_read_b128 a[24:27], v35 offset:0
    ds_read_b128 a[36:39], v32 offset:1024
    ds_read_b128 a[40:43], v33 offset:1024
    ds_read_b128 a[44:47], v34 offset:1024
    ds_read_b128 a[48:51], v35 offset:1024
    s_waitcnt lgkmcnt(7)
    s_nop 0
    v_mfma_f32_16x16x32_bf16 v[164:167], a[164:167], a[12:15], 0
    ds_read_b128 a[60:63], v32 offset:2048
    ds_read_b128 a[64:67], v33 offset:2048
    v_cvt_pk_bf16_f32 v133, v110, v111
    v_cvt_pk_bf16_f32 v134, v112, v113
    v_mfma_f32_16x16x32_bf16 v[40:43], a[164:167], a[0:3], v[40:43]
    buffer_load_dwordx4 v3, s[12:15], s57 offen offset:1024 sc1 lds
    v_cvt_pk_bf16_f32 v135, v114, v115
    v_cvt_pk_bf16_f32 v136, v116, v117
    s_waitcnt lgkmcnt(8)
    v_mfma_f32_16x16x32_bf16 v[168:171], a[164:167], a[16:19], 0
    v_cvt_pk_bf16_f32 v137, v118, v119
    v_cvt_pk_bf16_f32 v138, v120, v121
    s_waitcnt lgkmcnt(7)
    v_mfma_f32_16x16x32_bf16 v[172:175], a[164:167], a[20:23], 0
    ds_read_b128 a[68:71], v34 offset:2048
    ds_read_b128 a[72:75], v35 offset:2048
    v_cvt_pk_bf16_f32 v139, v122, v123
    v_cvt_pk_bf16_f32 v140, v148, v149
    v_mfma_f32_16x16x32_bf16 v[180:183], a[0:3], a[12:15], 0
    buffer_load_dwordx4 v3, s[12:15], s57 offen offset:2048 sc1 lds
    v_cvt_pk_bf16_f32 v141, v150, v151
    v_lshlrev_b32 v108, 16, v132
    s_waitcnt lgkmcnt(8)
    v_mfma_f32_16x16x32_bf16 v[176:179], a[164:167], a[24:27], 0
    v_and_b32 v109, 0xffff0000, v132
    v_lshlrev_b32_e64 v110, 16, v133
    v_mfma_f32_16x16x32_bf16 v[184:187], a[12:15], a[12:15], 0
    buffer_load_dwordx4 v3, s[12:15], s57 offen offset:3072 sc1 lds
    v_and_b32 v111, 0xffff0000, v133
    v_lshlrev_b32 v112, 16, v134
    s_waitcnt lgkmcnt(4)
    v_mfma_f32_16x16x32_bf16 v[164:167], a[168:171], a[36:39], v[164:167]
    ds_read_b128 a[12:15], v32 offset:3072
    ds_read_b128 a[16:19], v33 offset:3072
    v_and_b32 v113, 0xffff0000, v134
    v_lshlrev_b32_e64 v114, 16, v135
    v_mfma_f32_16x16x32_bf16 v[40:43], a[168:171], a[0:3], v[40:43]
    s_add_u32 m0, s62, 65536
    s_add_u32 s57, s19, 12533760
    buffer_load_dwordx4 v3, s[12:15], s57 offen offset:0 sc1 lds
    v_and_b32 v115, 0xffff0000, v135
    v_lshlrev_b32_e64 v116, 16, v136
    v_mfma_f32_16x16x32_bf16 v[168:171], a[168:171], a[40:43], v[168:171]
    v_and_b32 v117, 0xffff0000, v136
    v_lshlrev_b32_e64 v118, 16, v137
    v_mfma_f32_16x16x32_bf16 v[172:175], a[168:171], a[44:47], v[172:175]
    ds_read_b128 a[20:23], v34 offset:3072
    ds_read_b128 a[24:27], v35 offset:3072
    v_and_b32 v119, 0xffff0000, v137
    v_lshlrev_b32_e64 v120, 16, v138
    v_mfma_f32_16x16x32_bf16 v[180:183], a[0:3], a[36:39], v[180:183]
    buffer_load_dwordx4 v3, s[12:15], s57 offen offset:1024 sc1 lds
    v_and_b32 v121, 0xffff0000, v138
    v_lshlrev_b32_e64 v122, 16, v139
    v_mfma_f32_16x16x32_bf16 v[176:179], a[168:171], a[48:51], v[176:179]
    v_and_b32 v123, 0xffff0000, v139
    v_lshlrev_b32_e64 v148, 16, v140
    v_mfma_f32_16x16x32_bf16 v[184:187], a[36:39], a[36:39], v[184:187]
    v_and_b32 v149, 0xffff0000, v140
    v_lshlrev_b32 v150, 16, v141
    s_waitcnt vmcnt(10)
    s_waitcnt lgkmcnt(0)
    s_barrier
    v_mfma_f32_16x16x32_bf16 v[164:167], a[172:175], a[60:63], v[164:167]
    ds_read_b128 a[36:39], v32 offset:16384
    ds_read_b128 a[40:43], v33 offset:16384
    v_and_b32 v151, 0xffff0000, v141
    v_max3_f32 v156, v108, v109, v110
    v_mfma_f32_16x16x32_bf16 v[40:43], a[172:175], a[0:3], v[40:43]
    buffer_load_dwordx4 v3, s[12:15], s57 offen offset:2048 sc1 lds
    v_max3_f32 v160, -v108, -v109, -v110
    v_max3_f32 v157, v112, v113, v114
    v_mfma_f32_16x16x32_bf16 v[168:171], a[172:175], a[64:67], v[168:171]
    v_max3_f32 v161, -v112, -v113, -v114
    v_max3_f32 v158, v116, v117, v118
    v_mfma_f32_16x16x32_bf16 v[172:175], a[172:175], a[68:71], v[172:175]
    ds_read_b128 a[44:47], v34 offset:16384
    ds_read_b128 a[48:51], v35 offset:16384
    v_max3_f32 v162, -v116, -v117, -v118
    v_max3_f32 v159, v120, v121, v122
    v_mfma_f32_16x16x32_bf16 v[180:183], a[0:3], a[60:63], v[180:183]
    buffer_load_dwordx4 v3, s[12:15], s57 offen offset:3072 sc1 lds
    v_max3_f32 v163, -v120, -v121, -v122
    v_max3_f32 v156, v156, v111, v148
    v_mfma_f32_16x16x32_bf16 v[176:179], a[172:175], a[72:75], v[176:179]
    v_max3_f32 v160, v160, -v111, -v148
    v_max3_f32 v157, v157, v115, v149
    v_mfma_f32_16x16x32_bf16 v[184:187], a[60:63], a[60:63], v[184:187]
    buffer_load_dwordx4 a[160:163], v3, s[12:15], s29 offen offset:3072 sc1
    v_max3_f32 v161, v161, -v115, -v149
    v_max3_f32 v158, v158, v119, v150
    v_mfma_f32_16x16x32_bf16 v[164:167], a[108:111], a[12:15], v[164:167]
    ds_read_b128 a[60:63], v32 offset:17408
    ds_read_b128 a[64:67], v33 offset:17408
    v_max3_f32 v162, v162, -v119, -v150
    v_max3_f32 v159, v159, v123, v151
    v_mfma_f32_16x16x32_bf16 v[40:43], a[108:111], a[0:3], v[40:43]
    s_add_u32 s18, s90, 8028160
    buffer_load_dwordx4 a[164:167], v3, s[12:15], s18 offen offset:0 sc1
    v_max3_f32 v163, v163, -v123, -v151
    v_permlane16_swap_b32 v156, v160
    v_mfma_f32_16x16x32_bf16 v[168:171], a[108:111], a[16:19], v[168:171]
    v_permlane16_swap_b32 v157, v161
    v_permlane16_swap_b32 v158, v162
    v_mfma_f32_16x16x32_bf16 v[172:175], a[108:111], a[20:23], v[172:175]
    ds_read_b128 a[68:71], v34 offset:17408
    ds_read_b128 a[72:75], v35 offset:17408
    v_permlane16_swap_b32 v159, v163
    v_max_f32 v156, v156, v160
    v_mfma_f32_16x16x32_bf16 v[180:183], a[0:3], a[12:15], v[180:183]
    v_max_f32 v157, v157, v161
    v_max_f32 v158, v158, v162
    v_mfma_f32_16x16x32_bf16 v[176:179], a[108:111], a[24:27], v[176:179]
    v_max_f32 v159, v159, v163
    v_permlane32_swap_b32 v156, v157
    v_mfma_f32_16x16x32_bf16 v[184:187], a[12:15], a[12:15], v[184:187]
    v_permlane32_swap_b32 v158, v159
    v_max_f32 v156, v156, v157
    s_waitcnt lgkmcnt(4)
    v_mfma_f32_16x16x32_bf16 v[164:167], a[176:179], a[36:39], v[164:167]
    ds_read_b128 a[12:15], v32 offset:18432
    ds_read_b128 a[16:19], v33 offset:18432
    v_max_f32 v158, v158, v159
    v_mov_b32 v157, v156
    v_mfma_f32_16x16x32_bf16 v[40:43], a[176:179], a[0:3], v[40:43]
    buffer_load_dwordx4 a[108:111], v3, s[12:15], s18 offen offset:1024 sc1
    v_mov_b32 v159, v158
    v_permlane32_swap_b32 v156, v157
    v_mfma_f32_16x16x32_bf16 v[168:171], a[176:179], a[40:43], v[168:171]
    v_permlane32_swap_b32 v158, v159
    v_mov_b32 v160, v156
    v_mfma_f32_16x16x32_bf16 v[172:175], a[176:179], a[44:47], v[172:175]
    ds_read_b128 a[20:23], v34 offset:18432
    ds_read_b128 a[24:27], v35 offset:18432
    v_mov_b32 v161, v157
    v_mov_b32 v162, v158
    v_mfma_f32_16x16x32_bf16 v[180:183], a[0:3], a[36:39], v[180:183]
    buffer_load_dwordx4 a[168:171], v3, s[12:15], s18 offen offset:2048 sc1
    v_mov_b32 v163, v159
    v_permlane16_swap_b32 v156, v160
    v_mfma_f32_16x16x32_bf16 v[176:179], a[176:179], a[48:51], v[176:179]
    v_permlane16_swap_b32 v157, v161
    v_permlane16_swap_b32 v158, v162
    v_mfma_f32_16x16x32_bf16 v[184:187], a[36:39], a[36:39], v[184:187]
    v_permlane16_swap_b32 v159, v163
    v_mul_f32_e64 v156, v156, s66
    v_mul_f32_e64 v157, v157, s67
    s_waitcnt lgkmcnt(4)
    v_mfma_f32_16x16x32_bf16 v[164:167], a[180:183], a[60:63], v[164:167]
    ds_read_b128 a[36:39], v32 offset:19456
    ds_read_b128 a[40:43], v33 offset:19456
    v_mul_f32_e64 v158, v158, s66
    v_mul_f32_e64 v159, v159, s67
    v_mul_f32_e64 v160, v160, s66
    v_mul_f32_e64 v161, v161, s67
    v_mfma_f32_16x16x32_bf16 v[40:43], a[180:183], a[0:3], v[40:43]
    buffer_load_dwordx4 a[172:175], v3, s[12:15], s18 offen offset:3072 sc1
    v_mul_f32_e64 v162, v162, s66
    v_mul_f32_e64 v163, v163, s67
    v_fma_f32 v132, -v108, s66, -v160
    v_fma_f32 v133, -v109, s67, -v160
    v_mfma_f32_16x16x32_bf16 v[168:171], a[180:183], a[64:67], v[168:171]
    s_add_u32 s29, s90, 8093696
    buffer_load_dwordx4 a[176:179], v3, s[12:15], s29 offen offset:0 sc1
    v_fma_f32 v134, -v110, s66, -v160
    v_fma_f32 v135, -v111, s67, -v160
    v_fma_f32 v136, -v112, s66, -v161
    v_fma_f32 v137, -v113, s67, -v161
    v_mfma_f32_16x16x32_bf16 v[172:175], a[180:183], a[68:71], v[172:175]
    ds_read_b128 a[44:47], v34 offset:19456
    ds_read_b128 a[48:51], v35 offset:19456
    v_fma_f32 v138, -v114, s66, -v161
    v_fma_f32 v139, -v115, s67, -v161
    v_fma_f32 v140, -v116, s66, -v162
    v_fma_f32 v141, -v117, s67, -v162
    v_mfma_f32_16x16x32_bf16 v[180:183], a[0:3], a[60:63], v[180:183]
    v_fma_f32 v142, -v118, s66, -v162
    v_fma_f32 v143, -v119, s67, -v162
    v_fma_f32 v144, -v120, s66, -v163
    v_fma_f32 v145, -v121, s67, -v163
    v_mfma_f32_16x16x32_bf16 v[176:179], a[180:183], a[72:75], v[176:179]
    buffer_load_dwordx4 a[228:231], v3, s[12:15], s29 offen offset:1024 sc1
    v_fma_f32 v146, -v122, s66, -v163
    v_fma_f32 v147, -v123, s67, -v163
    v_fma_f32 v152, -v148, s66, -v160
    v_fma_f32 v153, -v149, s67, -v161
    v_mfma_f32_16x16x32_bf16 v[184:187], a[60:63], a[60:63], v[184:187]
    v_fma_f32 v154, -v150, s66, -v162
    v_fma_f32 v155, -v151, s67, -v163
    v_fma_f32 v108, v108, s66, -v156
    v_fma_f32 v109, v109, s67, -v156
    s_waitcnt vmcnt(11)
    s_waitcnt lgkmcnt(0)
    s_barrier
    s_nop 0
    v_mfma_f32_16x16x32_bf16 v[164:167], a[184:187], a[12:15], v[164:167]
    ds_read_b128 a[60:63], v32 offset:32768
    ds_read_b128 a[64:67], v33 offset:32768
    v_fma_f32 v110, v110, s66, -v156
    v_fma_f32 v111, v111, s67, -v156
    v_fma_f32 v112, v112, s66, -v157
    v_fma_f32 v113, v113, s67, -v157
    v_mfma_f32_16x16x32_bf16 v[40:43], a[184:187], a[0:3], v[40:43]
    buffer_load_dwordx4 a[180:183], v3, s[12:15], s29 offen offset:2048 sc1
    v_fma_f32 v114, v114, s66, -v157
    v_fma_f32 v115, v115, s67, -v157
    v_fma_f32 v116, v116, s66, -v158
    v_fma_f32 v117, v117, s67, -v158
    v_mfma_f32_16x16x32_bf16 v[168:171], a[184:187], a[16:19], v[168:171]
    buffer_load_dwordx4 a[232:235], v3, s[12:15], s29 offen offset:3072 sc1
    v_fma_f32 v118, v118, s66, -v158
    v_fma_f32 v119, v119, s67, -v158
    v_fma_f32 v120, v120, s66, -v159
    v_fma_f32 v121, v121, s67, -v159
    v_mfma_f32_16x16x32_bf16 v[172:175], a[184:187], a[20:23], v[172:175]
    ds_read_b128 a[68:71], v34 offset:32768
    ds_read_b128 a[72:75], v35 offset:32768
    v_fma_f32 v122, v122, s66, -v159
    v_fma_f32 v123, v123, s67, -v159
    v_fma_f32 v148, v148, s66, -v156
    v_fma_f32 v149, v149, s67, -v157
    v_mfma_f32_16x16x32_bf16 v[180:183], a[0:3], a[12:15], v[180:183]
    s_add_u32 s18, s90, 8097792
    buffer_load_dwordx4 a[236:239], v3, s[12:15], s18 offen offset:0 sc1
    v_fma_f32 v150, v150, s66, -v158
    v_fma_f32 v151, v151, s67, -v159
    v_exp_f32 v132, v132
    v_mfma_f32_16x16x32_bf16 v[176:179], a[184:187], a[24:27], v[176:179]
    v_exp_f32 v133, v133
    v_exp_f32 v134, v134
    v_mfma_f32_16x16x32_bf16 v[184:187], a[12:15], a[12:15], v[184:187]
    v_exp_f32 v135, v135
    v_exp_f32_e64 v136, v136
    v_mfma_f32_16x16x32_bf16 v[164:167], a[84:87], a[36:39], v[164:167]
    ds_read_b128 a[12:15], v32 offset:33792
    ds_read_b128 a[16:19], v33 offset:33792
    v_exp_f32 v137, v137
    v_exp_f32 v138, v138
    v_mfma_f32_16x16x32_bf16 v[40:43], a[84:87], a[0:3], v[40:43]
    buffer_load_dwordx4 a[184:187], v3, s[12:15], s18 offen offset:1024 sc1
    v_exp_f32 v139, v139
    v_exp_f32 v140, v140
    v_mfma_f32_16x16x32_bf16 v[168:171], a[84:87], a[40:43], v[168:171]
    v_exp_f32 v141, v141
    v_exp_f32 v142, v142
    v_mfma_f32_16x16x32_bf16 v[172:175], a[84:87], a[44:47], v[172:175]
    ds_read_b128 a[20:23], v34 offset:33792
    ds_read_b128 a[24:27], v35 offset:33792
    v_exp_f32 v143, v143
    v_exp_f32 v144, v144
    v_mfma_f32_16x16x32_bf16 v[180:183], a[0:3], a[36:39], v[180:183]
    buffer_load_dwordx4 a[240:243], v3, s[12:15], s18 offen offset:2048 sc1
    v_exp_f32 v145, v145
    v_exp_f32 v146, v146
    v_mfma_f32_16x16x32_bf16 v[176:179], a[84:87], a[48:51], v[176:179]
    v_exp_f32 v147, v147
    v_exp_f32 v152, v152
    v_mfma_f32_16x16x32_bf16 v[184:187], a[36:39], a[36:39], v[184:187]
    buffer_load_dwordx4 a[244:247], v3, s[12:15], s18 offen offset:3072 sc1
    v_exp_f32_e64 v153, v153
    s_add_u32 s8, s28, 32768
    buffer_load_dword v6, v19, s[12:15], s8 offen offset:0 sc1
    v_exp_f32 v154, v154
    s_waitcnt lgkmcnt(4)
    v_mfma_f32_16x16x32_bf16 v[164:167], a[112:115], a[60:63], v[164:167]
    ds_read_b128 a[36:39], v32 offset:34816
    ds_read_b128 a[40:43], v33 offset:34816
    v_exp_f32 v155, v155
    v_exp_f32 v108, v108
    v_mfma_f32_16x16x32_bf16 v[40:43], a[112:115], a[0:3], v[40:43]
    s_add_u32 s29, s90, 8101888
    buffer_load_dwordx4 a[84:87], v3, s[12:15], s29 offen offset:0 sc1
    v_exp_f32 v109, v109
    v_exp_f32 v110, v110
    v_mfma_f32_16x16x32_bf16 v[168:171], a[112:115], a[64:67], v[168:171]
    v_exp_f32 v111, v111
    v_exp_f32 v112, v112
    v_mfma_f32_16x16x32_bf16 v[172:175], a[112:115], a[68:71], v[172:175]
    ds_read_b128 a[44:47], v34 offset:34816
    ds_read_b128 a[48:51], v35 offset:34816
    v_exp_f32 v113, v113
    v_exp_f32 v114, v114
    v_mfma_f32_16x16x32_bf16 v[180:183], a[0:3], a[60:63], v[180:183]
    buffer_load_dwordx4 a[248:251], v3, s[12:15], s29 offen offset:1024 sc1
    v_exp_f32 v115, v115
    v_exp_f32 v116, v116
    v_mfma_f32_16x16x32_bf16 v[176:179], a[112:115], a[72:75], v[176:179]
    v_exp_f32 v117, v117
    v_exp_f32 v118, v118
    v_mfma_f32_16x16x32_bf16 v[184:187], a[60:63], a[60:63], v[184:187]
    buffer_load_dwordx4 a[252:255], v3, s[12:15], s29 offen offset:2048 sc1
    v_exp_f32 v119, v119
    v_exp_f32 v120, v120
    s_waitcnt lgkmcnt(4)
    v_mfma_f32_16x16x32_bf16 v[164:167], a[116:119], a[12:15], v[164:167]
    ds_read_b128 a[60:63], v32 offset:35840
    ds_read_b128 a[64:67], v33 offset:35840
    v_exp_f32 v121, v121
    v_exp_f32 v122, v122
    v_mfma_f32_16x16x32_bf16 v[40:43], a[116:119], a[0:3], v[40:43]
    v_exp_f32 v123, v123
    v_exp_f32_e64 v148, v148
    v_mfma_f32_16x16x32_bf16 v[168:171], a[116:119], a[16:19], v[168:171]
    buffer_load_dwordx4 a[112:115], v3, s[12:15], s29 offen offset:3072 sc1
    v_exp_f32 v149, v149
    v_exp_f32 v150, v150
    v_mfma_f32_16x16x32_bf16 v[172:175], a[116:119], a[20:23], v[172:175]
    ds_read_b128 a[68:71], v34 offset:35840
    ds_read_b128 a[72:75], v35 offset:35840
    v_exp_f32 v151, v151
    v_add_f32 v160, v132, v133
    v_mfma_f32_16x16x32_bf16 v[180:183], a[0:3], a[12:15], v[180:183]
    v_add_f32 v161, v136, v137
    v_add_f32 v162, v140, v141
    v_mfma_f32_16x16x32_bf16 v[176:179], a[116:119], a[24:27], v[176:179]
    v_add_f32 v163, v144, v145
    v_add_f32 v160, v160, v134
    v_mfma_f32_16x16x32_bf16 v[184:187], a[12:15], a[12:15], v[184:187]
    v_add_f32 v161, v161, v138
    v_add_f32 v162, v162, v142
    s_waitcnt lgkmcnt(4)
    v_mfma_f32_16x16x32_bf16 v[164:167], a[188:191], a[36:39], v[164:167]
    ds_read_b128 a[12:15], v32 offset:49152
    ds_read_b128 a[16:19], v33 offset:49152
    v_add_f32 v163, v163, v146
    v_add_f32_e64 v160, v160, v135
    v_mfma_f32_16x16x32_bf16 v[40:43], a[188:191], a[0:3], v[40:43]
    s_add_u32 s18, s90, 8105984
    buffer_load_dwordx4 a[116:119], v3, s[12:15], s18 offen offset:0 sc1
    v_add_f32 v161, v161, v139
    v_add_f32 v162, v162, v143
    v_mfma_f32_16x16x32_bf16 v[168:171], a[188:191], a[40:43], v[168:171]
    v_add_f32 v163, v163, v147
    v_add_f32 v160, v160, v152
    v_mfma_f32_16x16x32_bf16 v[172:175], a[188:191], a[44:47], v[172:175]
    ds_read_b128 a[20:23], v34 offset:49152
    ds_read_b128 a[24:27], v35 offset:49152
    v_add_f32 v161, v161, v153
    v_add_f32 v162, v162, v154
    v_mfma_f32_16x16x32_bf16 v[180:183], a[0:3], a[36:39], v[180:183]
    v_add_f32 v163, v163, v155
    v_add_f32 v156, v108, v109
    v_mfma_f32_16x16x32_bf16 v[176:179], a[188:191], a[48:51], v[176:179]
    v_add_f32 v157, v112, v113
    v_add_f32 v158, v116, v117
    v_mfma_f32_16x16x32_bf16 v[184:187], a[36:39], a[36:39], v[184:187]
    v_add_f32 v159, v120, v121
    v_add_f32 v156, v156, v110
    s_waitcnt lgkmcnt(4)
    v_mfma_f32_16x16x32_bf16 v[164:167], a[192:195], a[60:63], v[164:167]
    ds_read_b128 a[36:39], v32 offset:50176
    ds_read_b128 a[40:43], v33 offset:50176
    v_add_f32 v157, v157, v114
    v_add_f32_e64 v158, v158, v118
    v_mfma_f32_16x16x32_bf16 v[40:43], a[192:195], a[0:3], v[40:43]
    buffer_load_dwordx4 a[188:191], v3, s[12:15], s18 offen offset:1024 sc1
    v_add_f32 v159, v159, v122
    v_add_f32 v156, v156, v111
    v_mfma_f32_16x16x32_bf16 v[168:171], a[192:195], a[64:67], v[168:171]
    v_add_f32 v157, v157, v115
    v_add_f32 v158, v158, v119
    v_mfma_f32_16x16x32_bf16 v[172:175], a[192:195], a[68:71], v[172:175]
    ds_read_b128 a[44:47], v34 offset:50176
    ds_read_b128 a[48:51], v35 offset:50176
    v_add_f32 v159, v159, v123
    v_add_f32 v156, v156, v148
    v_mfma_f32_16x16x32_bf16 v[180:183], a[0:3], a[60:63], v[180:183]
    v_add_f32 v157, v157, v149
    v_add_f32 v158, v158, v150
    v_mfma_f32_16x16x32_bf16 v[176:179], a[192:195], a[72:75], v[176:179]
    v_add_f32 v159, v159, v151
    v_permlane16_swap_b32 v156, v160
    v_mfma_f32_16x16x32_bf16 v[184:187], a[60:63], a[60:63], v[184:187]
    v_permlane16_swap_b32 v157, v161
    v_permlane16_swap_b32 v158, v162
    s_waitcnt lgkmcnt(4)
    v_mfma_f32_16x16x32_bf16 v[164:167], a[120:123], a[12:15], v[164:167]
    ds_read_b128 a[60:63], v32 offset:51200
    ds_read_b128 a[64:67], v33 offset:51200
    v_permlane16_swap_b32 v159, v163
    v_add_f32_e64 v156, v156, v160
    v_mfma_f32_16x16x32_bf16 v[40:43], a[120:123], a[0:3], v[40:43]
    buffer_load_dwordx4 a[192:195], v3, s[12:15], s18 offen offset:2048 sc1
    v_add_f32 v157, v157, v161
    v_add_f32 v158, v158, v162
    v_mfma_f32_16x16x32_bf16 v[168:171], a[120:123], a[16:19], v[168:171]
    v_add_f32 v159, v159, v163
    v_permlane32_swap_b32 v156, v157
    s_waitcnt vmcnt(7)
    v_cmp_ne_u32 vcc, s47, v6
    s_nop 0
    s_cbranch_vccnz Lslow16
Lback17:
    v_lshrrev_b32 v16, 5, v2
    v_mul_u32_u24 v16, 14336, v16
    v_and_b32 v17, 31, v2
    v_lshl_add_u32 v16, v17, 4, v16
    s_lshl_b32 s69, s43, 2
    s_add_u32 s69, s69, s3
    s_mul_i32 s69, s69, 114688
    s_mul_i32 s70, s42, 448
    s_add_u32 s69, s69, s70
    s_nop 0
    s_add_u32 s69, s69, 24051712
    buffer_load_dwordx4 v[188:191], v16, s[12:15], s69 offen sc1
    s_add_u32 s69, s69, 28672
    buffer_load_dwordx4 v[192:195], v16, s[12:15], s69 offen sc1
    s_add_u32 s69, s69, 28672
    buffer_load_dwordx4 v[200:203], v16, s[12:15], s69 offen sc1
    s_add_u32 s69, s69, 28672
    buffer_load_dwordx4 v[204:207], v16, s[12:15], s69 offen sc1
    s_add_u32 s69, s69, 28672
    v_permlane32_swap_b32 v158, v159
    v_add_f32 v156, v156, v157
    v_mfma_f32_16x16x32_bf16 v[172:175], a[120:123], a[20:23], v[172:175]
    ds_read_b128 a[68:71], v34 offset:51200
    ds_read_b128 a[72:75], v35 offset:51200
    v_add_f32 v158, v158, v159
    v_mov_b32 v157, v156
    v_mov_b32 v159, v158
    s_nop 0
    v_permlane32_swap_b32 v156, v157
    v_mfma_f32_16x16x32_bf16 v[180:183], a[0:3], a[12:15], v[180:183]
    v_permlane32_swap_b32 v158, v159
    v_mov_b32 v160, v156
    v_mov_b32 v161, v157
    v_mov_b32 v162, v158
    v_mfma_f32_16x16x32_bf16 v[176:179], a[120:123], a[24:27], v[176:179]
    v_mov_b32 v163, v159
    v_permlane16_swap_b32 v156, v160
    v_permlane16_swap_b32 v157, v161
    v_permlane16_swap_b32 v158, v162
    v_mfma_f32_16x16x32_bf16 v[184:187], a[12:15], a[12:15], v[184:187]
    v_permlane16_swap_b32 v159, v163
    v_rcp_f32 v156, v156
    v_rcp_f32 v157, v157
    v_rcp_f32 v158, v158
    s_waitcnt lgkmcnt(4)
    v_mfma_f32_16x16x32_bf16 v[164:167], a[196:199], a[36:39], v[164:167]
    ds_read_b128 a[12:15], v32 offset:52224
    ds_read_b128 a[16:19], v33 offset:52224
    v_rcp_f32 v159, v159
    v_rcp_f32 v160, v160
    v_rcp_f32 v161, v161
    v_rcp_f32 v162, v162
    v_mfma_f32_16x16x32_bf16 v[40:43], a[196:199], a[0:3], v[40:43]
    buffer_load_dwordx4 a[120:123], v3, s[12:15], s18 offen offset:3072 sc1
    v_rcp_f32_e64 v163, v163
    v_mul_f32_e64 v108, v108, v156
    v_mul_f32_e64 v109, v109, v156
    v_mul_f32_e64 v110, v110, v156
    v_mul_f32_e64 v111, v111, v156
    v_mul_f32_e64 v112, v112, v157
    v_mul_f32_e64 v113, v113, v157
    v_mfma_f32_16x16x32_bf16 v[168:171], a[196:199], a[40:43], v[168:171]
    v_mul_f32_e64 v114, v114, v157
    v_mul_f32_e64 v115, v115, v157
    v_mul_f32_e64 v116, v116, v158
    v_mul_f32_e64 v117, v117, v158
    v_mul_f32_e64 v118, v118, v158
    v_mul_f32_e64 v119, v119, v158
    v_mul_f32_e64 v120, v120, v159
    v_mul_f32_e64 v121, v121, v159
    v_mfma_f32_16x16x32_bf16 v[172:175], a[196:199], a[44:47], v[172:175]
    ds_read_b128 a[20:23], v34 offset:52224
    ds_read_b128 a[24:27], v35 offset:52224
    v_mul_f32_e64 v122, v122, v159
    v_mul_f32_e64 v123, v123, v159
    v_mul_f32_e64 v148, v148, v156
    v_mul_f32_e64 v149, v149, v157
    v_mul_f32_e64 v150, v150, v158
    v_mul_f32_e64 v151, v151, v159
    v_mul_f32_e64 v132, v132, v160
    v_mul_f32_e64 v133, v133, v160
    v_mfma_f32_16x16x32_bf16 v[180:183], a[0:3], a[36:39], v[180:183]
    v_mul_f32_e64 v134, v134, v160
    v_mul_f32_e64 v135, v135, v160
    v_mul_f32_e64 v136, v136, v161
    v_mul_f32_e64 v137, v137, v161
    v_mul_f32_e64 v138, v138, v161
    v_mul_f32_e64 v139, v139, v161
    v_mul_f32_e64 v140, v140, v162
    v_mul_f32_e64 v141, v141, v162
    v_mfma_f32_16x16x32_bf16 v[176:179], a[196:199], a[48:51], v[176:179]
    v_mul_f32_e64 v142, v142, v162
    v_mul_f32_e64 v143, v143, v162
    v_mul_f32_e64 v144, v144, v163
    v_mul_f32_e64 v145, v145, v163
    v_mul_f32_e64 v146, v146, v163
    v_mul_f32_e64 v147, v147, v163
    v_mul_f32_e64 v152, v152, v160
    v_mul_f32_e64 v153, v153, v161
    v_mfma_f32_16x16x32_bf16 v[184:187], a[36:39], a[36:39], v[184:187]
    v_mul_f32_e64 v154, v154, v162
    v_mul_f32_e64 v155, v155, v163
    v_cvt_pk_bf16_f32 v80, v108, v109
    v_cvt_pk_bf16_f32 v82, v132, v133
    v_cvt_pk_bf16_f32 v81, v110, v111
    s_waitcnt lgkmcnt(0)
    s_barrier
    v_add_u32 v32, 65536, v28
    v_add_u32 v33, 65536, v29
    v_add_u32 v34, 65536, v30
    v_add_u32 v35, 65536, v31
    v_mfma_f32_16x16x32_bf16 v[164:167], a[200:203], a[60:63], v[164:167]
    ds_read_b128 a[36:39], v32 offset:0
    ds_read_b128 a[40:43], v33 offset:0
    v_cvt_pk_bf16_f32 v83, v134, v135
    v_cvt_pk_bf16_f32 v92, v148, v152
    v_cvt_pk_bf16_f32 v96, v112, v113
    v_cvt_pk_bf16_f32 v98, v136, v137
    v_mfma_f32_16x16x32_bf16 v[40:43], a[200:203], a[0:3], v[40:43]
    s_add_u32 s29, s90, 8110080
    buffer_load_dwordx4 a[196:199], v3, s[12:15], s29 offen offset:0 sc1
    v_cvt_pk_bf16_f32 v97, v114, v115
    v_cvt_pk_bf16_f32 v99, v138, v139
    v_cvt_pk_bf16_f32 v94, v149, v153
    v_cvt_pk_bf16_f32 v100, v116, v117
    v_mfma_f32_16x16x32_bf16 v[168:171], a[200:203], a[64:67], v[168:171]
    v_cvt_pk_bf16_f32 v102, v140, v141
    v_cvt_pk_bf16_f32 v101, v118, v119
    v_cvt_pk_bf16_f32 v103, v142, v143
    v_cvt_pk_bf16_f32 v104, v150, v154
    v_mfma_f32_16x16x32_bf16 v[172:175], a[200:203], a[68:71], v[172:175]
    ds_read_b128 a[44:47], v34 offset:0
    ds_read_b128 a[48:51], v35 offset:0
    v_cvt_pk_bf16_f32 v124, v120, v121
    v_cvt_pk_bf16_f32 v126, v144, v145
    v_cvt_pk_bf16_f32 v125, v122, v123
    v_cvt_pk_bf16_f32 v127, v146, v147
    v_mfma_f32_16x16x32_bf16 v[180:183], a[0:3], a[60:63], v[180:183]
    v_cvt_pk_bf16_f32 v106, v151, v155
    v_mfma_f32_16x16x32_bf16 v[176:179], a[200:203], a[72:75], v[176:179]
    v_mfma_f32_16x16x32_bf16 v[184:187], a[60:63], a[60:63], v[184:187]
    buffer_load_dwordx4 a[4:7], v3, s[12:15], s29 offen offset:1024 sc1
    v_mfma_f32_16x16x32_bf16 v[164:167], a[124:127], a[12:15], v[164:167]
    ds_read_b128 a[60:63], v32 offset:1024
    ds_read_b128 a[64:67], v33 offset:1024
    v_mfma_f32_16x16x32_bf16 v[40:43], a[124:127], a[0:3], v[40:43]
    buffer_load_dwordx4 a[8:11], v3, s[12:15], s29 offen offset:2048 sc1
    v_mfma_f32_16x16x32_bf16 v[168:171], a[124:127], a[16:19], v[168:171]
    v_mfma_f32_16x16x32_bf16 v[172:175], a[124:127], a[20:23], v[172:175]
    ds_read_b128 a[68:71], v34 offset:1024
    ds_read_b128 a[72:75], v35 offset:1024
    v_mfma_f32_16x16x32_bf16 v[180:183], a[0:3], a[12:15], v[180:183]
    buffer_load_dwordx4 a[200:203], v3, s[12:15], s29 offen offset:3072 sc1
    v_mfma_f32_16x16x32_bf16 v[176:179], a[124:127], a[24:27], v[176:179]
    v_mfma_f32_16x16x32_bf16 v[184:187], a[12:15], a[12:15], v[184:187]
    s_add_u32 m0, s61, 151552
    s_add_u32 s56, s39, 6160384
    buffer_load_dwordx4 v3, s[12:15], s56 offen sc1 lds
    s_waitcnt lgkmcnt(4)
    s_nop 0
    v_mfma_f32_16x16x32_bf16 v[164:167], a[204:207], a[36:39], v[164:167]
    ds_read_b128 a[12:15], v32 offset:2048
    ds_read_b128 a[16:19], v33 offset:2048
    v_mfma_f32_16x16x32_bf16 v[168:171], a[204:207], a[40:43], v[168:171]
    s_add_u32 s18, s38, 5963776
    buffer_load_dwordx4 a[124:127], v3, s[12:15], s18 offen offset:0 sc1
    v_mfma_f32_16x16x32_bf16 v[172:175], a[204:207], a[44:47], v[172:175]
    ds_read_b128 a[20:23], v34 offset:2048
    ds_read_b128 a[24:27], v35 offset:2048
    s_waitcnt vmcnt(7)
    s_nop 0
    v_add_f32_e64 v188, v188, v192
    v_add_f32_e64 v189, v189, v193
    v_add_f32_e64 v200, v200, v204
    v_add_f32_e64 v201, v201, v205
    v_add_f32_e64 v190, v190, v194
    v_add_f32_e64 v191, v191, v195
    v_mfma_f32_16x16x32_bf16 v[180:183], a[0:3], a[36:39], v[180:183]
    buffer_load_dwordx4 v[252:255], v3, s[12:15], s18 offen offset:1024 sc1
    v_add_f32_e64 v202, v202, v206
    v_add_f32_e64 v203, v203, v207
    v_add_f32_e64 v188, v188, v200
    v_add_f32_e64 v189, v189, v201
    v_add_f32_e64 v190, v190, v202
    v_add_f32_e64 v191, v191, v203
    v_mov_b32_e64 v192, v188
    v_mfma_f32_16x16x32_bf16 v[176:179], a[204:207], a[48:51], v[176:179]
    buffer_load_dwordx4 v[248:251], v3, s[12:15], s18 offen offset:2048 sc1
    v_mov_b32 v193, v189
    v_mov_b32 v194, v190
    v_mov_b32 v195, v191
    v_permlane32_swap_b32 v188, v192
    v_mfma_f32_16x16x32_bf16 v[184:187], a[36:39], a[36:39], v[184:187]
    v_permlane32_swap_b32 v189, v193
    v_permlane32_swap_b32 v190, v194
    v_permlane32_swap_b32 v191, v195
    v_add_f32_e64 v188, v188, v192
    v_add_f32_e64 v189, v189, v193
    s_waitcnt lgkmcnt(4)
    v_mfma_f32_16x16x32_bf16 v[164:167], a[208:211], a[60:63], v[164:167]
    ds_read_b128 a[36:39], v32 offset:3072
    ds_read_b128 a[40:43], v33 offset:3072
    v_add_f32_e64 v190, v190, v194
    v_add_f32_e64 v191, v191, v195
    v_and_b32 v208, 31, v2
    v_lshlrev_b32 v208, 4, v208
    v_add_u32 v209, 157696, v208
    v_mfma_f32_16x16x32_bf16 v[168:171], a[208:211], a[64:67], v[168:171]
    buffer_load_dwordx4 a[204:207], v3, s[12:15], s18 offen offset:3072 sc1
    s_lshl_b32 s8, s3, 9
    v_add_u32 v210, s8, v209
    ds_write_b128 v210, v[188:191]
    s_waitcnt lgkmcnt(0)
    s_barrier
    ds_read_b128 v[188:191], v209 offset:0
    v_mfma_f32_16x16x32_bf16 v[172:175], a[208:211], a[68:71], v[172:175]
    ds_read_b128 a[44:47], v34 offset:3072
    ds_read_b128 a[48:51], v35 offset:3072
    ds_read_b128 v[192:195], v209 offset:512
    ds_read_b128 v[200:203], v209 offset:1024
    ds_read_b128 v[204:207], v209 offset:1536
    v_mfma_f32_16x16x32_bf16 v[180:183], a[0:3], a[60:63], v[180:183]
    s_add_u32 m0, s61, 147456
    s_add_u32 s56, s39, 6164480
    buffer_load_dwordx4 v3, s[12:15], s56 offen sc1 lds
    v_mfma_f32_16x16x32_bf16 v[176:179], a[208:211], a[72:75], v[176:179]
    v_mfma_f32_16x16x32_bf16 v[184:187], a[60:63], a[60:63], v[184:187]
    v_mfma_f32_16x16x32_bf16 v[164:167], a[128:131], a[12:15], v[164:167]
    v_mfma_f32_16x16x32_bf16 v[168:171], a[128:131], a[16:19], v[168:171]
    s_add_u32 s29, s38, 5967872
    buffer_load_dwordx4 a[208:211], v3, s[12:15], s29 offen offset:0 sc1
    v_mfma_f32_16x16x32_bf16 v[172:175], a[128:131], a[20:23], v[172:175]
    v_mfma_f32_16x16x32_bf16 v[180:183], a[0:3], a[12:15], v[180:183]
    v_mfma_f32_16x16x32_bf16 v[176:179], a[128:131], a[24:27], v[176:179]
    s_waitcnt lgkmcnt(0)
    s_nop 0
    v_add_f32_e64 v188, v188, v192
    v_add_f32_e64 v189, v189, v193
    v_add_f32_e64 v200, v200, v204
    v_add_f32_e64 v201, v201, v205
    v_add_f32_e64 v190, v190, v194
    v_add_f32_e64 v191, v191, v195
    v_mfma_f32_16x16x32_bf16 v[184:187], a[12:15], a[12:15], v[184:187]
    v_add_f32_e64 v202, v202, v206
    v_add_f32_e64 v203, v203, v207
    v_add_f32_e64 v188, v188, v200
    v_add_f32_e64 v189, v189, v201
    v_add_f32_e64 v190, v190, v202
    v_add_f32_e64 v191, v191, v203
    s_lshl_b32 s8, s43, 5
    v_mfma_f32_16x16x32_bf16 v[164:167], a[212:215], a[36:39], v[164:167]
    s_add_u32 s8, s8, s42
    s_lshl_b32 s8, s8, 9
    s_add_u32 s8, s8, 27721728
    s_add_u32 s8, s8, s60
    v_mfma_f32_16x16x32_bf16 v[168:171], a[212:215], a[40:43], v[168:171]
    buffer_load_dwordx4 a[128:131], v3, s[12:15], s29 offen offset:1024 sc1
    s_mov_b32 exec_lo, 0xffffffff
    s_mov_b32 exec_hi, 0x0
    buffer_store_dwordx4 v[188:191], v208, s[12:15], s8 offen sc1
    s_mov_b64 exec, -1
    s_nop 1
    v_mfma_f32_16x16x32_bf16 v[172:175], a[212:215], a[44:47], v[172:175]
    v_mfma_f32_16x16x32_bf16 v[180:183], a[0:3], a[36:39], v[180:183]
    buffer_load_dwordx4 v[244:247], v3, s[12:15], s29 offen offset:2048 sc1
    v_mfma_f32_16x16x32_bf16 v[176:179], a[212:215], a[48:51], v[176:179]
    v_mfma_f32_16x16x32_bf16 v[184:187], a[36:39], a[36:39], v[184:187]
    v_and_b32 v9, 1, v5
    v_add_u32 v9, s3, v9
    v_add_u32 v10, 0, v9
    v_and_b32 v10, 3, v10
    v_mul_u32_u24 v10, 28672, v10
    v_add_u32 v16, v10, v64
    v_add_u32 v10, 2, v9
    buffer_load_dwordx4 a[212:215], v3, s[12:15], s29 offen offset:3072 sc1
    v_and_b32 v10, 3, v10
    v_mul_u32_u24 v10, 28672, v10
    v_add_u32 v17, v10, v65
    s_mov_b32 vcc_lo, 0x22222222
    s_mov_b32 vcc_hi, 0x22222222
    v_cndmask_b32_e64 v53, v184, v185, vcc
    s_mov_b32 vcc_lo, 0x44444444
    s_mov_b32 vcc_hi, 0x44444444
    v_cndmask_b32_e64 v53, v53, v186, vcc
    s_mov_b32 vcc_lo, 0x88888888
    s_mov_b32 vcc_hi, 0x88888888
    v_cndmask_b32_e64 v53, v53, v187, vcc
    v_mul_f32 v52, 0xbacccccd, v180
    s_add_u32 m0, s61, 143360
    s_add_u32 s56, s39, 6168576
    buffer_load_dwordx4 v3, s[12:15], s56 offen sc1 lds
    v_mul_f32 v53, 0x3acccccd, v53
    v_fma_f32 v53, -v52, v52, v53
    v_max_f32 v53, 0, v53
    v_add_f32 v53, 0x3727c5ac, v53
    v_rsq_f32 v53, v53
    v_lshlrev_b32_e64 v54, 3, v36
    v_add_u32 v54, 160768, v54
    s_mov_b32 exec_lo, 0xf0000f
    s_mov_b32 exec_hi, 0xf0000f00
    ds_write_b64 v54, v[52:53]
    s_mov_b64 exec, -1
    s_waitcnt lgkmcnt(0)
    s_barrier
    v_lshlrev_b32 v52, 3, v36
    v_add_u32 v52, 160768, v52
    ds_read_b64 v[108:109], v52
    v_lshlrev_b32_e64 v53, 3, v37
    v_add_u32 v53, 160768, v53
    ds_read_b64 v[110:111], v53
    v_lshlrev_b32_e64 v54, 3, v38
    v_add_u32 v54, 160768, v54
    ds_read_b64 v[112:113], v54
    v_lshlrev_b32_e64 v55, 3, v39
    v_add_u32 v55, 160768, v55
    ds_read_b64 v[114:115], v55
    s_waitcnt lgkmcnt(0)
    s_nop 0
    v_pk_fma_f32 v[164:165], v[40:41], v[108:109], v[164:165] op_sel_hi:[1,0,1]
    v_pk_fma_f32 v[166:167], v[42:43], v[108:109], v[166:167] op_sel_hi:[1,0,1]
    v_pk_fma_f32 v[168:169], v[40:41], v[110:111], v[168:169] op_sel_hi:[1,0,1]
    v_pk_fma_f32 v[170:171], v[42:43], v[110:111], v[170:171] op_sel_hi:[1,0,1]
    v_pk_fma_f32 v[172:173], v[40:41], v[112:113], v[172:173] op_sel_hi:[1,0,1]
    v_pk_fma_f32 v[174:175], v[42:43], v[112:113], v[174:175] op_sel_hi:[1,0,1]
    v_pk_fma_f32 v[176:177], v[40:41], v[114:115], v[176:177] op_sel_hi:[1,0,1]
    v_pk_fma_f32 v[178:179], v[42:43], v[114:115], v[178:179] op_sel_hi:[1,0,1]
    v_pk_mul_f32 v[164:165], v[164:165], v[108:109] op_sel:[0,1] op_sel_hi:[1,1]
    v_pk_mul_f32 v[166:167], v[166:167], v[108:109] op_sel:[0,1] op_sel_hi:[1,1]
    v_pk_mul_f32 v[168:169], v[168:169], v[110:111] op_sel:[0,1] op_sel_hi:[1,1]
    v_pk_mul_f32 v[170:171], v[170:171], v[110:111] op_sel:[0,1] op_sel_hi:[1,1]
    v_pk_mul_f32 v[116:117], v[164:165], v[164:165]
    v_pk_mul_f32 v[118:119], v[166:167], v[166:167]
    v_pk_mul_f32 v[120:121], v[168:169], v[168:169]
    v_pk_mul_f32 v[122:123], v[170:171], v[170:171]
    v_pk_fma_f32 v[116:117], v[116:117], s[40:41], v[66:67]
    v_pk_fma_f32 v[118:119], v[118:119], s[40:41], v[66:67]
    v_pk_fma_f32 v[120:121], v[120:121], s[40:41], v[66:67]
    v_pk_fma_f32 v[122:123], v[122:123], s[40:41], v[66:67]
    v_pk_mul_f32 v[116:117], v[116:117], v[164:165]
    v_pk_mul_f32 v[118:119], v[118:119], v[166:167]
    v_pk_mul_f32 v[120:121], v[120:121], v[168:169]
    v_pk_mul_f32 v[122:123], v[122:123], v[170:171]
    v_exp_f32 v116, v116
    v_exp_f32 v117, v117
    v_exp_f32 v118, v118
    v_exp_f32 v119, v119
    v_exp_f32 v120, v120
    v_exp_f32 v121, v121
    v_exp_f32 v122, v122
    v_exp_f32 v123, v123
    v_pk_add_f32 v[116:117], v[116:117], 1.0 op_sel_hi:[1,0]
    v_pk_add_f32 v[118:119], v[118:119], 1.0 op_sel_hi:[1,0]
    v_pk_add_f32 v[120:121], v[120:121], 1.0 op_sel_hi:[1,0]
    v_pk_add_f32 v[122:123], v[122:123], 1.0 op_sel_hi:[1,0]
    v_rcp_f32 v116, v116
    v_rcp_f32 v117, v117
    v_rcp_f32 v118, v118
    v_rcp_f32 v119, v119
    v_rcp_f32 v120, v120
    v_rcp_f32 v121, v121
    v_rcp_f32 v122, v122
    v_rcp_f32 v123, v123
    v_pk_mul_f32 v[164:165], v[164:165], v[116:117]
    v_pk_mul_f32 v[166:167], v[166:167], v[118:119]
    v_pk_mul_f32 v[168:169], v[168:169], v[120:121]
    v_pk_mul_f32 v[170:171], v[170:171], v[122:123]
    v_cvt_pk_bf16_f32 v164, v164, v165
    v_cvt_pk_bf16_f32 v165, v166, v167
    v_cvt_pk_bf16_f32 v166, v168, v169
    v_cvt_pk_bf16_f32 v167, v170, v171
    v_pk_mul_f32 v[172:173], v[172:173], v[112:113] op_sel:[0,1] op_sel_hi:[1,1]
    v_pk_mul_f32 v[174:175], v[174:175], v[112:113] op_sel:[0,1] op_sel_hi:[1,1]
    v_pk_mul_f32 v[176:177], v[176:177], v[114:115] op_sel:[0,1] op_sel_hi:[1,1]
    v_pk_mul_f32 v[178:179], v[178:179], v[114:115] op_sel:[0,1] op_sel_hi:[1,1]
    v_pk_mul_f32 v[116:117], v[172:173], v[172:173]
    v_pk_mul_f32 v[118:119], v[174:175], v[174:175]
    v_pk_mul_f32 v[120:121], v[176:177], v[176:177]
    v_pk_mul_f32 v[122:123], v[178:179], v[178:179]
    v_pk_fma_f32 v[116:117], v[116:117], s[40:41], v[66:67]
    v_pk_fma_f32 v[118:119], v[118:119], s[40:41], v[66:67]
    v_pk_fma_f32 v[120:121], v[120:121], s[40:41], v[66:67]
    v_pk_fma_f32 v[122:123], v[122:123], s[40:41], v[66:67]
    v_pk_mul_f32 v[116:117], v[116:117], v[172:173]
    v_pk_mul_f32 v[118:119], v[118:119], v[174:175]
    v_pk_mul_f32 v[120:121], v[120:121], v[176:177]
    v_pk_mul_f32 v[122:123], v[122:123], v[178:179]
    v_exp_f32 v116, v116
    v_exp_f32 v117, v117
    v_exp_f32 v118, v118
    v_exp_f32 v119, v119
    v_exp_f32 v120, v120
    v_exp_f32 v121, v121
    v_exp_f32 v122, v122
    v_exp_f32 v123, v123
    v_pk_add_f32 v[116:117], v[116:117], 1.0 op_sel_hi:[1,0]
    v_pk_add_f32 v[118:119], v[118:119], 1.0 op_sel_hi:[1,0]
    v_pk_add_f32 v[120:121], v[120:121], 1.0 op_sel_hi:[1,0]
    v_pk_add_f32 v[122:123], v[122:123], 1.0 op_sel_hi:[1,0]
    v_rcp_f32 v116, v116
    v_rcp_f32 v117, v117
    v_rcp_f32 v118, v118
    v_rcp_f32 v119, v119
    v_rcp_f32 v120, v120
    v_rcp_f32 v121, v121
    v_rcp_f32 v122, v122
    v_rcp_f32 v123, v123
    v_pk_mul_f32 v[172:173], v[172:173], v[116:117]
    v_pk_mul_f32 v[174:175], v[174:175], v[118:119]
    v_pk_mul_f32 v[176:177], v[176:177], v[120:121]
    v_pk_mul_f32 v[178:179], v[178:179], v[122:123]
    v_cvt_pk_bf16_f32 v168, v172, v173
    v_cvt_pk_bf16_f32 v169, v174, v175
    v_cvt_pk_bf16_f32 v170, v176, v177
    v_cvt_pk_bf16_f32 v171, v178, v179
    s_mul_i32 s8, s42, 196608
    s_lshl_b32 s9, s43, 11
    s_add_u32 s8, s8, s9
    s_add_u32 s8, s8, 17760256
    v_permlane16_swap_b32 v164, v166
    v_permlane16_swap_b32 v165, v167
    v_permlane16_swap_b32 v168, v170
    v_permlane16_swap_b32 v169, v171
    buffer_store_dwordx4 v[164:167], v16, s[12:15], s8 offen offset:0 sc1
    buffer_store_dwordx4 v[168:171], v17, s[12:15], s8 offen offset:0 sc1
    s_nop 1
    v_add_u32 v32, 0, v28
    s_add_u32 s18, s38, 5971968
    buffer_load_dwordx4 v[240:243], v3, s[12:15], s18 offen offset:0 sc1
    v_add_u32 v33, 0, v29
    v_add_u32 v34, 0, v30
    v_add_u32_e64 v35, 0, v31
    ds_read_b128 a[12:15], v32 offset:0
    ds_read_b128 a[16:19], v33 offset:0
    ds_read_b128 a[20:23], v34 offset:0
    ds_read_b128 a[24:27], v35 offset:0
    ds_read_b128 a[36:39], v32 offset:1024
    ds_read_b128 a[40:43], v33 offset:1024
    ds_read_b128 a[44:47], v34 offset:1024
    ds_read_b128 a[48:51], v35 offset:1024
    s_waitcnt lgkmcnt(7)
    v_mfma_f32_16x16x32_bf16 v[40:43], a[216:219], a[12:15], 0
    s_waitcnt vmcnt(6)
    s_add_u32 s69, s22, 65536
    s_mov_b64 exec, 1
    buffer_store_dword v23, v24, s[12:15], s69 offen sc1
    s_mov_b64 exec, -1
    ds_read_b128 a[60:63], v32 offset:2048
    ds_read_b128 a[64:67], v33 offset:2048
    s_waitcnt lgkmcnt(8)
    v_mfma_f32_16x16x32_bf16 v[52:55], a[216:219], a[16:19], 0
    s_waitcnt lgkmcnt(7)
    v_mfma_f32_16x16x32_bf16 v[116:119], a[216:219], a[20:23], 0
    ds_read_b128 a[68:71], v34 offset:2048
    ds_read_b128 a[72:75], v35 offset:2048
    s_waitcnt lgkmcnt(8)
    v_mfma_f32_16x16x32_bf16 v[120:123], a[216:219], a[24:27], 0
    s_waitcnt lgkmcnt(4)
    v_mfma_f32_16x16x32_bf16 v[40:43], a[132:135], a[36:39], v[40:43]
    ds_read_b128 a[12:15], v32 offset:3072
    ds_read_b128 a[16:19], v33 offset:3072
    v_mfma_f32_16x16x32_bf16 v[52:55], a[132:135], a[40:43], v[52:55]
    buffer_load_dwordx4 a[216:219], v3, s[12:15], s18 offen offset:1024 sc1
    v_mfma_f32_16x16x32_bf16 v[116:119], a[132:135], a[44:47], v[116:119]
    ds_read_b128 a[20:23], v34 offset:3072
    ds_read_b128 a[24:27], v35 offset:3072
    v_mfma_f32_16x16x32_bf16 v[120:123], a[132:135], a[48:51], v[120:123]
    s_waitcnt lgkmcnt(4)
    s_nop 0
    v_mfma_f32_16x16x32_bf16 v[40:43], a[220:223], a[60:63], v[40:43]
    ds_read_b128 a[36:39], v32 offset:16384
    ds_read_b128 a[40:43], v33 offset:16384
    v_mfma_f32_16x16x32_bf16 v[52:55], a[220:223], a[64:67], v[52:55]
    buffer_load_dwordx4 a[132:135], v3, s[12:15], s18 offen offset:2048 sc1
    v_mfma_f32_16x16x32_bf16 v[116:119], a[220:223], a[68:71], v[116:119]
    ds_read_b128 a[44:47], v34 offset:16384
    ds_read_b128 a[48:51], v35 offset:16384
    v_mfma_f32_16x16x32_bf16 v[120:123], a[220:223], a[72:75], v[120:123]
    s_waitcnt lgkmcnt(4)
    s_nop 0
    v_mfma_f32_16x16x32_bf16 v[40:43], a[136:139], a[12:15], v[40:43]
    ds_read_b128 a[60:63], v32 offset:17408
    ds_read_b128 a[64:67], v33 offset:17408
    v_mfma_f32_16x16x32_bf16 v[52:55], a[136:139], a[16:19], v[52:55]
    buffer_load_dwordx4 a[220:223], v3, s[12:15], s18 offen offset:3072 sc1
    s_add_u32 m0, s61, 139264
    s_add_u32 s56, s39, 6172672
    buffer_load_dwordx4 v3, s[12:15], s56 offen sc1 lds
    v_mfma_f32_16x16x32_bf16 v[116:119], a[136:139], a[20:23], v[116:119]
    ds_read_b128 a[68:71], v34 offset:17408
    ds_read_b128 a[72:75], v35 offset:17408
    v_mfma_f32_16x16x32_bf16 v[120:123], a[136:139], a[24:27], v[120:123]
    s_waitcnt lgkmcnt(4)
    s_nop 0
    v_mfma_f32_16x16x32_bf16 v[40:43], a[144:147], a[36:39], v[40:43]
    ds_read_b128 a[12:15], v32 offset:18432
    ds_read_b128 a[16:19], v33 offset:18432
    v_mfma_f32_16x16x32_bf16 v[52:55], a[144:147], a[40:43], v[52:55]
    s_add_u32 s29, s38, 5976064
    buffer_load_dwordx4 a[136:139], v3, s[12:15], s29 offen offset:0 sc1
    v_mfma_f32_16x16x32_bf16 v[116:119], a[144:147], a[44:47], v[116:119]
    ds_read_b128 a[20:23], v34 offset:18432
    ds_read_b128 a[24:27], v35 offset:18432
    v_mfma_f32_16x16x32_bf16 v[120:123], a[144:147], a[48:51], v[120:123]
    s_waitcnt lgkmcnt(4)
    s_nop 0
    v_mfma_f32_16x16x32_bf16 v[40:43], a[224:227], a[60:63], v[40:43]
    ds_read_b128 a[36:39], v32 offset:19456
    ds_read_b128 a[40:43], v33 offset:19456
    v_mfma_f32_16x16x32_bf16 v[52:55], a[224:227], a[64:67], v[52:55]
    buffer_load_dwordx4 a[144:147], v3, s[12:15], s29 offen offset:1024 sc1
    v_mfma_f32_16x16x32_bf16 v[116:119], a[224:227], a[68:71], v[116:119]
    ds_read_b128 a[44:47], v34 offset:19456
    ds_read_b128 a[48:51], v35 offset:19456
    v_mfma_f32_16x16x32_bf16 v[120:123], a[224:227], a[72:75], v[120:123]
    s_waitcnt lgkmcnt(4)
    s_nop 0
    v_mfma_f32_16x16x32_bf16 v[40:43], a[88:91], a[12:15], v[40:43]
    ds_read_b128 a[60:63], v32 offset:32768
    ds_read_b128 a[64:67], v33 offset:32768
    v_mfma_f32_16x16x32_bf16 v[52:55], a[88:91], a[16:19], v[52:55]
    buffer_load_dwordx4 a[224:227], v3, s[12:15], s29 offen offset:2048 sc1
    v_mfma_f32_16x16x32_bf16 v[116:119], a[88:91], a[20:23], v[116:119]
    ds_read_b128 a[68:71], v34 offset:32768
    ds_read_b128 a[72:75], v35 offset:32768
    v_mfma_f32_16x16x32_bf16 v[120:123], a[88:91], a[24:27], v[120:123]
    s_waitcnt lgkmcnt(4)
    s_nop 0
    v_mfma_f32_16x16x32_bf16 v[40:43], a[92:95], a[36:39], v[40:43]
    ds_read_b128 a[12:15], v32 offset:33792
    ds_read_b128 a[16:19], v33 offset:33792
    v_mfma_f32_16x16x32_bf16 v[52:55], a[92:95], a[40:43], v[52:55]
    buffer_load_dwordx4 a[88:91], v3, s[12:15], s29 offen offset:3072 sc1
    v_mfma_f32_16x16x32_bf16 v[116:119], a[92:95], a[44:47], v[116:119]
    ds_read_b128 a[20:23], v34 offset:33792
    ds_read_b128 a[24:27], v35 offset:33792
    v_mfma_f32_16x16x32_bf16 v[120:123], a[92:95], a[48:51], v[120:123]
    s_add_u32 m0, s61, 135168
    s_add_u32 s56, s39, 6176768
    buffer_load_dwordx4 v3, s[12:15], s56 offen sc1 lds
    s_waitcnt lgkmcnt(4)
    s_nop 0
    v_mfma_f32_16x16x32_bf16 v[40:43], a[96:99], a[60:63], v[40:43]
    ds_read_b128 a[36:39], v32 offset:34816
    ds_read_b128 a[40:43], v33 offset:34816
    v_mfma_f32_16x16x32_bf16 v[52:55], a[96:99], a[64:67], v[52:55]
    v_mfma_f32_16x16x32_bf16 v[116:119], a[96:99], a[68:71], v[116:119]
    ds_read_b128 a[44:47], v34 offset:34816
    ds_read_b128 a[48:51], v35 offset:34816
    v_mfma_f32_16x16x32_bf16 v[120:123], a[96:99], a[72:75], v[120:123]
    s_waitcnt lgkmcnt(4)
    s_nop 0
    v_mfma_f32_16x16x32_bf16 v[40:43], a[100:103], a[12:15], v[40:43]
    ds_read_b128 a[60:63], v32 offset:35840
    ds_read_b128 a[64:67], v33 offset:35840
    v_mfma_f32_16x16x32_bf16 v[52:55], a[100:103], a[16:19], v[52:55]
    v_mfma_f32_16x16x32_bf16 v[116:119], a[100:103], a[20:23], v[116:119]
    ds_read_b128 a[68:71], v34 offset:35840
    ds_read_b128 a[72:75], v35 offset:35840
    v_mfma_f32_16x16x32_bf16 v[120:123], a[100:103], a[24:27], v[120:123]
    s_waitcnt lgkmcnt(4)
    s_nop 0
    v_mfma_f32_16x16x32_bf16 v[40:43], a[104:107], a[36:39], v[40:43]
    ds_read_b128 a[12:15], v32 offset:49152
    ds_read_b128 a[16:19], v33 offset:49152
    v_mfma_f32_16x16x32_bf16 v[52:55], a[104:107], a[40:43], v[52:55]
    s_add_u32 s18, s38, 5980160
    buffer_load_dwordx4 a[92:95], v3, s[12:15], s18 offen offset:0 sc1
    v_mfma_f32_16x16x32_bf16 v[116:119], a[104:107], a[44:47], v[116:119]
    ds_read_b128 a[20:23], v34 offset:49152
    ds_read_b128 a[24:27], v35 offset:49152
    v_mfma_f32_16x16x32_bf16 v[120:123], a[104:107], a[48:51], v[120:123]
    s_waitcnt lgkmcnt(4)
    s_nop 0
    v_mfma_f32_16x16x32_bf16 v[40:43], a[140:143], a[60:63], v[40:43]
    ds_read_b128 a[36:39], v32 offset:50176
    ds_read_b128 a[40:43], v33 offset:50176
    v_mfma_f32_16x16x32_bf16 v[52:55], a[140:143], a[64:67], v[52:55]
    buffer_load_dwordx4 a[96:99], v3, s[12:15], s18 offen offset:1024 sc1
    v_mfma_f32_16x16x32_bf16 v[116:119], a[140:143], a[68:71], v[116:119]
    ds_read_b128 a[44:47], v34 offset:50176
    ds_read_b128 a[48:51], v35 offset:50176
    v_mfma_f32_16x16x32_bf16 v[120:123], a[140:143], a[72:75], v[120:123]
    s_waitcnt lgkmcnt(4)
    s_nop 0
    v_mfma_f32_16x16x32_bf16 v[40:43], a[148:151], a[12:15], v[40:43]
    ds_read_b128 a[60:63], v32 offset:51200
    ds_read_b128 a[64:67], v33 offset:51200
    v_mfma_f32_16x16x32_bf16 v[52:55], a[148:151], a[16:19], v[52:55]
    buffer_load_dwordx4 a[100:103], v3, s[12:15], s18 offen offset:2048 sc1
    v_mfma_f32_16x16x32_bf16 v[116:119], a[148:151], a[20:23], v[116:119]
    ds_read_b128 a[68:71], v34 offset:51200
    ds_read_b128 a[72:75], v35 offset:51200
    v_mfma_f32_16x16x32_bf16 v[120:123], a[148:151], a[24:27], v[120:123]
    s_waitcnt lgkmcnt(4)
    s_nop 0
    v_mfma_f32_16x16x32_bf16 v[40:43], a[152:155], a[36:39], v[40:43]
    ds_read_b128 a[12:15], v32 offset:52224
    ds_read_b128 a[16:19], v33 offset:52224
    v_mfma_f32_16x16x32_bf16 v[52:55], a[152:155], a[40:43], v[52:55]
    buffer_load_dwordx4 a[104:107], v3, s[12:15], s18 offen offset:3072 sc1
    v_mfma_f32_16x16x32_bf16 v[116:119], a[152:155], a[44:47], v[116:119]
    s_waitcnt vmcnt(15)
    ds_read_b128 a[20:23], v34 offset:52224
    ds_read_b128 a[24:27], v35 offset:52224
    v_mfma_f32_16x16x32_bf16 v[120:123], a[152:155], a[48:51], v[120:123]
    s_waitcnt lgkmcnt(0)
    s_barrier
    v_add_u32 v32, 65536, v28
    s_add_u32 s69, s21, 24576
    s_mov_b64 exec, 1
    buffer_store_dword v23, v24, s[12:15], s69 offen sc1
    s_mov_b64 exec, -1
    s_nop 0
    v_add_u32 v33, 65536, v29
    v_add_u32 v34, 65536, v30
    v_add_u32 v35, 65536, v31
    v_mfma_f32_16x16x32_bf16 v[40:43], a[156:159], a[60:63], v[40:43]
    ds_read_b128 a[36:39], v32 offset:0
    ds_read_b128 a[40:43], v33 offset:0
    v_mfma_f32_16x16x32_bf16 v[52:55], a[156:159], a[64:67], v[52:55]
    s_add_u32 m0, s61, 131072
    s_add_u32 s56, s39, 6180864
    buffer_load_dwordx4 v3, s[12:15], s56 offen sc1 lds
    v_mfma_f32_16x16x32_bf16 v[116:119], a[156:159], a[68:71], v[116:119]
    ds_read_b128 a[44:47], v34 offset:0
    ds_read_b128 a[48:51], v35 offset:0
    v_mfma_f32_16x16x32_bf16 v[120:123], a[156:159], a[72:75], v[120:123]
    s_add_u32 s29, s38, 5984256
    buffer_load_dwordx4 a[140:143], v3, s[12:15], s29 offen offset:0 sc1
    v_mfma_f32_16x16x32_bf16 v[40:43], a[160:163], a[12:15], v[40:43]
    ds_read_b128 a[60:63], v32 offset:1024
    ds_read_b128 a[64:67], v33 offset:1024
    v_mfma_f32_16x16x32_bf16 v[44:47], a[160:163], a[0:3], v[44:47]
    buffer_load_dwordx4 a[148:151], v3, s[12:15], s29 offen offset:1024 sc1
    v_mfma_f32_16x16x32_bf16 v[52:55], a[160:163], a[16:19], v[52:55]
    v_mfma_f32_16x16x32_bf16 v[116:119], a[160:163], a[20:23], v[116:119]
    ds_read_b128 a[68:71], v34 offset:1024
    ds_read_b128 a[72:75], v35 offset:1024
    v_mfma_f32_16x16x32_bf16 v[120:123], a[160:163], a[24:27], v[120:123]
    buffer_load_dwordx4 a[152:155], v3, s[12:15], s29 offen offset:2048 sc1
    s_waitcnt lgkmcnt(4)
    s_nop 0
    v_mfma_f32_16x16x32_bf16 v[40:43], a[164:167], a[36:39], v[40:43]
    ds_read_b128 a[12:15], v32 offset:2048
    ds_read_b128 a[16:19], v33 offset:2048
    v_mfma_f32_16x16x32_bf16 v[44:47], a[164:167], a[0:3], v[44:47]
    v_mfma_f32_16x16x32_bf16 v[52:55], a[164:167], a[40:43], v[52:55]
    v_mfma_f32_16x16x32_bf16 v[116:119], a[164:167], a[44:47], v[116:119]
    ds_read_b128 a[20:23], v34 offset:2048
    ds_read_b128 a[24:27], v35 offset:2048
    v_mfma_f32_16x16x32_bf16 v[120:123], a[164:167], a[48:51], v[120:123]
    buffer_load_dwordx4 a[156:159], v3, s[12:15], s29 offen offset:3072 sc1
    s_waitcnt lgkmcnt(4)
    s_nop 0
    v_mfma_f32_16x16x32_bf16 v[40:43], a[108:111], a[60:63], v[40:43]
    ds_read_b128 a[36:39], v32 offset:3072
    ds_read_b128 a[40:43], v33 offset:3072
    v_mfma_f32_16x16x32_bf16 v[44:47], a[108:111], a[0:3], v[44:47]
    v_mfma_f32_16x16x32_bf16 v[52:55], a[108:111], a[64:67], v[52:55]
    v_mfma_f32_16x16x32_bf16 v[116:119], a[108:111], a[68:71], v[116:119]
    ds_read_b128 a[44:47], v34 offset:3072
    ds_read_b128 a[48:51], v35 offset:3072
    v_mfma_f32_16x16x32_bf16 v[120:123], a[108:111], a[72:75], v[120:123]
    s_add_u32 m0, s61, 126976
    s_add_u32 s56, s39, 6184960
    buffer_load_dwordx4 v3, s[12:15], s56 offen sc1 lds
    s_waitcnt lgkmcnt(4)
    s_nop 0
    v_mfma_f32_16x16x32_bf16 v[40:43], a[168:171], a[12:15], v[40:43]
    v_mfma_f32_16x16x32_bf16 v[44:47], a[168:171], a[0:3], v[44:47]
    v_mfma_f32_16x16x32_bf16 v[52:55], a[168:171], a[16:19], v[52:55]
    s_add_u32 s18, s38, 5988352
    buffer_load_dwordx4 a[108:111], v3, s[12:15], s18 offen offset:0 sc1
    v_mfma_f32_16x16x32_bf16 v[116:119], a[168:171], a[20:23], v[116:119]
    v_mfma_f32_16x16x32_bf16 v[120:123], a[168:171], a[24:27], v[120:123]
    s_waitcnt lgkmcnt(0)
    s_nop 0
    v_mfma_f32_16x16x32_bf16 v[40:43], a[172:175], a[36:39], v[40:43]
    v_mfma_f32_16x16x32_bf16 v[44:47], a[172:175], a[0:3], v[44:47]
    v_mfma_f32_16x16x32_bf16 v[52:55], a[172:175], a[40:43], v[52:55]
    buffer_load_dwordx4 a[160:163], v3, s[12:15], s18 offen offset:1024 sc1
    v_mfma_f32_16x16x32_bf16 v[116:119], a[172:175], a[44:47], v[116:119]
    v_mfma_f32_16x16x32_bf16 v[120:123], a[172:175], a[48:51], v[120:123]
    s_nop 3
    s_nop 0
    v_fma_f32 v40, v44, v108, v40
    v_fma_f32 v41, v45, v108, v41
    v_fma_f32 v42, v46, v108, v42
    v_fma_f32 v43, v47, v108, v43
    v_fma_f32 v52, v44, v110, v52
    v_fma_f32 v53, v45, v110, v53
    v_fma_f32 v54, v46, v110, v54
    buffer_load_dwordx4 a[164:167], v3, s[12:15], s18 offen offset:2048 sc1
    v_fma_f32 v55, v47, v110, v55
    v_fma_f32 v116, v44, v112, v116
    v_fma_f32 v117, v45, v112, v117
    v_pk_fma_f32 v[118:119], v[46:47], v[112:113], v[118:119] op_sel_hi:[1,0,1]
    v_pk_fma_f32 v[120:121], v[44:45], v[114:115], v[120:121] op_sel_hi:[1,0,1]
    v_pk_fma_f32 v[122:123], v[46:47], v[114:115], v[122:123] op_sel_hi:[1,0,1]
    v_pk_mul_f32 v[40:41], v[40:41], v[108:109] op_sel:[0,1] op_sel_hi:[1,1]
    v_pk_mul_f32 v[42:43], v[42:43], v[108:109] op_sel:[0,1] op_sel_hi:[1,1]
    v_pk_mul_f32 v[52:53], v[52:53], v[110:111] op_sel:[0,1] op_sel_hi:[1,1]
    v_pk_mul_f32 v[54:55], v[54:55], v[110:111] op_sel:[0,1] op_sel_hi:[1,1]
    v_pk_mul_f32 v[128:129], v[40:41], v[40:41]
    v_pk_mul_f32 v[130:131], v[42:43], v[42:43]
    v_pk_mul_f32 v[132:133], v[52:53], v[52:53]
    v_pk_mul_f32 v[134:135], v[54:55], v[54:55]
    v_pk_fma_f32 v[128:129], v[128:129], s[40:41], v[66:67]
    v_pk_fma_f32 v[130:131], v[130:131], s[40:41], v[66:67]
    v_pk_fma_f32 v[132:133], v[132:133], s[40:41], v[66:67]
    v_pk_fma_f32 v[134:135], v[134:135], s[40:41], v[66:67]
    v_pk_mul_f32 v[128:129], v[128:129], v[40:41]
    v_pk_mul_f32 v[130:131], v[130:131], v[42:43]
    v_pk_mul_f32 v[132:133], v[132:133], v[52:53]
    v_pk_mul_f32 v[134:135], v[134:135], v[54:55]
    v_exp_f32 v128, v128
    v_exp_f32 v129, v129
    v_exp_f32 v130, v130
    v_exp_f32 v131, v131
    v_exp_f32 v132, v132
    v_exp_f32 v133, v133
    v_exp_f32 v134, v134
    v_exp_f32 v135, v135
    buffer_load_dwordx4 a[168:171], v3, s[12:15], s18 offen offset:3072 sc1
    v_pk_add_f32 v[128:129], v[128:129], 1.0 op_sel_hi:[1,0]
    v_pk_add_f32 v[130:131], v[130:131], 1.0 op_sel_hi:[1,0]
    v_pk_add_f32 v[132:133], v[132:133], 1.0 op_sel_hi:[1,0]
    v_pk_add_f32 v[134:135], v[134:135], 1.0 op_sel_hi:[1,0]
    v_rcp_f32 v128, v128
    v_rcp_f32 v129, v129
    v_rcp_f32 v130, v130
    v_rcp_f32 v131, v131
    v_rcp_f32 v132, v132
    v_rcp_f32 v133, v133
    s_add_u32 m0, s61, 122880
    s_add_u32 s56, s39, 6189056
    buffer_load_dwordx4 v3, s[12:15], s56 offen sc1 lds
    v_rcp_f32 v134, v134
    v_rcp_f32 v135, v135
    v_pk_mul_f32 v[40:41], v[40:41], v[128:129]
    v_pk_mul_f32 v[42:43], v[42:43], v[130:131]
    v_pk_mul_f32 v[52:53], v[52:53], v[132:133]
    v_pk_mul_f32 v[54:55], v[54:55], v[134:135]
    v_cvt_pk_bf16_f32 v40, v40, v41
    v_cvt_pk_bf16_f32 v41, v42, v43
    v_cvt_pk_bf16_f32 v42, v52, v53
    v_cvt_pk_bf16_f32 v43, v54, v55
    v_pk_mul_f32 v[116:117], v[116:117], v[112:113] op_sel:[0,1] op_sel_hi:[1,1]
    v_pk_mul_f32 v[118:119], v[118:119], v[112:113] op_sel:[0,1] op_sel_hi:[1,1]
    v_pk_mul_f32 v[120:121], v[120:121], v[114:115] op_sel:[0,1] op_sel_hi:[1,1]
    s_add_u32 s29, s38, 5992448
    buffer_load_dwordx4 a[172:175], v3, s[12:15], s29 offen offset:0 sc1
    v_pk_mul_f32 v[122:123], v[122:123], v[114:115] op_sel:[0,1] op_sel_hi:[1,1]
    v_pk_mul_f32 v[128:129], v[116:117], v[116:117]
    v_pk_mul_f32 v[130:131], v[118:119], v[118:119]
    v_pk_mul_f32 v[132:133], v[120:121], v[120:121]
    v_pk_mul_f32 v[134:135], v[122:123], v[122:123]
    v_pk_fma_f32 v[128:129], v[128:129], s[40:41], v[66:67]
    v_pk_fma_f32 v[130:131], v[130:131], s[40:41], v[66:67]
    v_pk_fma_f32 v[132:133], v[132:133], s[40:41], v[66:67]
    v_pk_fma_f32 v[134:135], v[134:135], s[40:41], v[66:67]
    v_pk_mul_f32 v[128:129], v[128:129], v[116:117]
    v_pk_mul_f32 v[130:131], v[130:131], v[118:119]
    v_pk_mul_f32 v[132:133], v[132:133], v[120:121]
    v_pk_mul_f32 v[134:135], v[134:135], v[122:123]
    v_exp_f32 v128, v128
    v_exp_f32 v129, v129
    v_exp_f32 v130, v130
    v_exp_f32 v131, v131
    v_exp_f32 v132, v132
    v_exp_f32 v133, v133
    v_exp_f32 v134, v134
    v_exp_f32 v135, v135
    v_pk_add_f32 v[128:129], v[128:129], 1.0 op_sel_hi:[1,0]
    v_pk_add_f32 v[130:131], v[130:131], 1.0 op_sel_hi:[1,0]
    v_pk_add_f32 v[132:133], v[132:133], 1.0 op_sel_hi:[1,0]
    v_pk_add_f32 v[134:135], v[134:135], 1.0 op_sel_hi:[1,0]
    v_rcp_f32 v128, v128
    v_rcp_f32 v129, v129
    v_rcp_f32 v130, v130
    v_rcp_f32 v131, v131
    v_rcp_f32 v132, v132
    v_rcp_f32 v133, v133
    v_rcp_f32 v134, v134
    v_rcp_f32 v135, v135
    v_pk_mul_f32 v[116:117], v[116:117], v[128:129]
    v_pk_mul_f32 v[118:119], v[118:119], v[130:131]
    v_pk_mul_f32 v[120:121], v[120:121], v[132:133]
    v_pk_mul_f32 v[122:123], v[122:123], v[134:135]
    v_cvt_pk_bf16_f32 v52, v116, v117
    v_cvt_pk_bf16_f32 v53, v118, v119
    v_cvt_pk_bf16_f32 v54, v120, v121
    v_cvt_pk_bf16_f32 v55, v122, v123
    s_mul_i32 s8, s42, 196608
    s_lshl_b32 s9, s43, 11
    s_add_u32 s8, s8, s9
    s_add_u32 s8, s8, 17776640
    v_permlane16_swap_b32 v40, v42
    v_permlane16_swap_b32 v41, v43
    v_permlane16_swap_b32 v52, v54
    v_permlane16_swap_b32 v53, v55
    buffer_store_dwordx4 v[40:43], v16, s[12:15], s8 offen offset:0 sc1
    buffer_store_dwordx4 v[52:55], v17, s[12:15], s8 offen offset:0 sc1
    s_nop 1
    v_add_u32 v32, 0, v28
    buffer_load_dwordx4 v[236:239], v3, s[12:15], s29 offen offset:1024 sc1
    v_add_u32 v33, 0, v29
    v_add_u32 v34, 0, v30
    v_add_u32_e64 v35, 0, v31
    ds_read_b128 a[12:15], v32 offset:0
    ds_read_b128 a[16:19], v33 offset:0
    ds_read_b128 a[20:23], v34 offset:0
    ds_read_b128 a[24:27], v35 offset:0
    ds_read_b128 a[36:39], v32 offset:1024
    ds_read_b128 a[40:43], v33 offset:1024
    ds_read_b128 a[44:47], v34 offset:1024
    ds_read_b128 a[48:51], v35 offset:1024
    s_waitcnt lgkmcnt(7)
    v_mfma_f32_16x16x32_bf16 v[40:43], a[176:179], a[12:15], 0
    ds_read_b128 a[60:63], v32 offset:2048
    ds_read_b128 a[64:67], v33 offset:2048
    v_mfma_f32_16x16x32_bf16 v[48:51], a[176:179], a[0:3], 0
    s_waitcnt lgkmcnt(8)
    v_mfma_f32_16x16x32_bf16 v[44:47], a[176:179], a[16:19], 0
    s_waitcnt lgkmcnt(7)
    v_mfma_f32_16x16x32_bf16 v[52:55], a[176:179], a[20:23], 0
    ds_read_b128 a[68:71], v34 offset:2048
    ds_read_b128 a[72:75], v35 offset:2048
    s_waitcnt lgkmcnt(8)
    v_mfma_f32_16x16x32_bf16 v[116:119], a[176:179], a[24:27], 0
    s_waitcnt lgkmcnt(4)
    s_nop 0
    v_mfma_f32_16x16x32_bf16 v[40:43], a[228:231], a[36:39], v[40:43]
    ds_read_b128 a[12:15], v32 offset:3072
    ds_read_b128 a[16:19], v33 offset:3072
    v_mfma_f32_16x16x32_bf16 v[48:51], a[228:231], a[0:3], v[48:51]
    buffer_load_dwordx4 a[176:179], v3, s[12:15], s29 offen offset:2048 sc1
    v_mfma_f32_16x16x32_bf16 v[44:47], a[228:231], a[40:43], v[44:47]
    v_mfma_f32_16x16x32_bf16 v[52:55], a[228:231], a[44:47], v[52:55]
    ds_read_b128 a[20:23], v34 offset:3072
    ds_read_b128 a[24:27], v35 offset:3072
    v_mfma_f32_16x16x32_bf16 v[116:119], a[228:231], a[48:51], v[116:119]
    s_waitcnt lgkmcnt(4)
    s_nop 0
    v_mfma_f32_16x16x32_bf16 v[40:43], a[180:183], a[60:63], v[40:43]
    ds_read_b128 a[36:39], v32 offset:16384
    ds_read_b128 a[40:43], v33 offset:16384
    v_mfma_f32_16x16x32_bf16 v[48:51], a[180:183], a[0:3], v[48:51]
    buffer_load_dwordx4 a[228:231], v3, s[12:15], s29 offen offset:3072 sc1
    s_add_u32 m0, s61, 118784
    s_add_u32 s56, s39, 6193152
    buffer_load_dwordx4 v3, s[12:15], s56 offen sc1 lds
    v_mfma_f32_16x16x32_bf16 v[44:47], a[180:183], a[64:67], v[44:47]
    v_mfma_f32_16x16x32_bf16 v[52:55], a[180:183], a[68:71], v[52:55]
    ds_read_b128 a[44:47], v34 offset:16384
    ds_read_b128 a[48:51], v35 offset:16384
    v_mfma_f32_16x16x32_bf16 v[116:119], a[180:183], a[72:75], v[116:119]
    s_waitcnt lgkmcnt(4)
    s_nop 0
    v_mfma_f32_16x16x32_bf16 v[40:43], a[232:235], a[12:15], v[40:43]
    ds_read_b128 a[60:63], v32 offset:17408
    ds_read_b128 a[64:67], v33 offset:17408
    v_mfma_f32_16x16x32_bf16 v[48:51], a[232:235], a[0:3], v[48:51]
    s_add_u32 s18, s38, 5996544
    buffer_load_dwordx4 a[180:183], v3, s[12:15], s18 offen offset:0 sc1
    v_mfma_f32_16x16x32_bf16 v[44:47], a[232:235], a[16:19], v[44:47]
    v_mfma_f32_16x16x32_bf16 v[52:55], a[232:235], a[20:23], v[52:55]
    ds_read_b128 a[68:71], v34 offset:17408
    ds_read_b128 a[72:75], v35 offset:17408
    v_mfma_f32_16x16x32_bf16 v[116:119], a[232:235], a[24:27], v[116:119]
    s_waitcnt lgkmcnt(4)
    s_nop 0
    v_mfma_f32_16x16x32_bf16 v[40:43], a[236:239], a[36:39], v[40:43]
    ds_read_b128 a[12:15], v32 offset:18432
    ds_read_b128 a[16:19], v33 offset:18432
    v_mfma_f32_16x16x32_bf16 v[48:51], a[236:239], a[0:3], v[48:51]
    buffer_load_dwordx4 a[232:235], v3, s[12:15], s18 offen offset:1024 sc1
    v_mfma_f32_16x16x32_bf16 v[44:47], a[236:239], a[40:43], v[44:47]
    v_mfma_f32_16x16x32_bf16 v[52:55], a[236:239], a[44:47], v[52:55]
    ds_read_b128 a[20:23], v34 offset:18432
    ds_read_b128 a[24:27], v35 offset:18432
    v_mfma_f32_16x16x32_bf16 v[116:119], a[236:239], a[48:51], v[116:119]
    s_waitcnt lgkmcnt(4)
    s_nop 0
    v_mfma_f32_16x16x32_bf16 v[40:43], a[184:187], a[60:63], v[40:43]
    ds_read_b128 a[36:39], v32 offset:19456
    ds_read_b128 a[40:43], v33 offset:19456
    v_mfma_f32_16x16x32_bf16 v[48:51], a[184:187], a[0:3], v[48:51]
    buffer_load_dwordx4 a[236:239], v3, s[12:15], s18 offen offset:2048 sc1
    v_mfma_f32_16x16x32_bf16 v[44:47], a[184:187], a[64:67], v[44:47]
    v_mfma_f32_16x16x32_bf16 v[52:55], a[184:187], a[68:71], v[52:55]
    ds_read_b128 a[44:47], v34 offset:19456
    ds_read_b128 a[48:51], v35 offset:19456
    v_mfma_f32_16x16x32_bf16 v[116:119], a[184:187], a[72:75], v[116:119]
    s_waitcnt lgkmcnt(4)
    s_nop 0
    v_mfma_f32_16x16x32_bf16 v[40:43], a[240:243], a[12:15], v[40:43]
    ds_read_b128 a[60:63], v32 offset:32768
    ds_read_b128 a[64:67], v33 offset:32768
    v_mfma_f32_16x16x32_bf16 v[48:51], a[240:243], a[0:3], v[48:51]
    buffer_load_dwordx4 a[184:187], v3, s[12:15], s18 offen offset:3072 sc1
    v_mfma_f32_16x16x32_bf16 v[44:47], a[240:243], a[16:19], v[44:47]
    v_mfma_f32_16x16x32_bf16 v[52:55], a[240:243], a[20:23], v[52:55]
    ds_read_b128 a[68:71], v34 offset:32768
    ds_read_b128 a[72:75], v35 offset:32768
    v_mfma_f32_16x16x32_bf16 v[116:119], a[240:243], a[24:27], v[116:119]
    s_add_u32 m0, s61, 114688
    s_add_u32 s56, s39, 6197248
    buffer_load_dwordx4 v3, s[12:15], s56 offen sc1 lds
    s_waitcnt lgkmcnt(4)
    s_nop 0
    v_mfma_f32_16x16x32_bf16 v[40:43], a[244:247], a[36:39], v[40:43]
    ds_read_b128 a[12:15], v32 offset:33792
    ds_read_b128 a[16:19], v33 offset:33792
    v_mfma_f32_16x16x32_bf16 v[48:51], a[244:247], a[0:3], v[48:51]
    v_mfma_f32_16x16x32_bf16 v[44:47], a[244:247], a[40:43], v[44:47]
    v_mfma_f32_16x16x32_bf16 v[52:55], a[244:247], a[44:47], v[52:55]
    ds_read_b128 a[20:23], v34 offset:33792
    ds_read_b128 a[24:27], v35 offset:33792
    v_mfma_f32_16x16x32_bf16 v[116:119], a[244:247], a[48:51], v[116:119]
    s_waitcnt lgkmcnt(4)
    s_nop 0
    v_mfma_f32_16x16x32_bf16 v[40:43], a[84:87], a[60:63], v[40:43]
    ds_read_b128 a[36:39], v32 offset:34816
    ds_read_b128 a[40:43], v33 offset:34816
    v_mfma_f32_16x16x32_bf16 v[48:51], a[84:87], a[0:3], v[48:51]
    v_mfma_f32_16x16x32_bf16 v[44:47], a[84:87], a[64:67], v[44:47]
    v_mfma_f32_16x16x32_bf16 v[52:55], a[84:87], a[68:71], v[52:55]
    ds_read_b128 a[44:47], v34 offset:34816
    ds_read_b128 a[48:51], v35 offset:34816
    v_mfma_f32_16x16x32_bf16 v[116:119], a[84:87], a[72:75], v[116:119]
    s_add_u32 s8, s28, 65536
    buffer_load_dword v6, v19, s[12:15], s8 offen offset:0 sc1
    s_add_u32 s29, s38, 6000640
    buffer_load_dwordx4 a[240:243], v3, s[12:15], s29 offen offset:0 sc1
    s_waitcnt lgkmcnt(4)
    s_nop 0
    v_mfma_f32_16x16x32_bf16 v[40:43], a[248:251], a[12:15], v[40:43]
    ds_read_b128 a[60:63], v32 offset:35840
    ds_read_b128 a[64:67], v33 offset:35840
    v_mfma_f32_16x16x32_bf16 v[48:51], a[248:251], a[0:3], v[48:51]
    v_mfma_f32_16x16x32_bf16 v[44:47], a[248:251], a[16:19], v[44:47]
    v_mfma_f32_16x16x32_bf16 v[52:55], a[248:251], a[20:23], v[52:55]
    ds_read_b128 a[68:71], v34 offset:35840
    ds_read_b128 a[72:75], v35 offset:35840
    v_mfma_f32_16x16x32_bf16 v[116:119], a[248:251], a[24:27], v[116:119]
    buffer_load_dwordx4 a[84:87], v3, s[12:15], s29 offen offset:1024 sc1
    s_waitcnt lgkmcnt(4)
    s_nop 0
    v_mfma_f32_16x16x32_bf16 v[40:43], a[252:255], a[36:39], v[40:43]
    ds_read_b128 a[12:15], v32 offset:49152
    ds_read_b128 a[16:19], v33 offset:49152
    v_mfma_f32_16x16x32_bf16 v[48:51], a[252:255], a[0:3], v[48:51]
    v_mfma_f32_16x16x32_bf16 v[44:47], a[252:255], a[40:43], v[44:47]
    buffer_load_dwordx4 a[244:247], v3, s[12:15], s29 offen offset:2048 sc1
    v_mfma_f32_16x16x32_bf16 v[52:55], a[252:255], a[44:47], v[52:55]
    ds_read_b128 a[20:23], v34 offset:49152
    ds_read_b128 a[24:27], v35 offset:49152
    v_mfma_f32_16x16x32_bf16 v[116:119], a[252:255], a[48:51], v[116:119]
    s_waitcnt lgkmcnt(4)
    s_nop 0
    v_mfma_f32_16x16x32_bf16 v[40:43], a[112:115], a[60:63], v[40:43]
    ds_read_b128 a[36:39], v32 offset:50176
    ds_read_b128 a[40:43], v33 offset:50176
    v_mfma_f32_16x16x32_bf16 v[48:51], a[112:115], a[0:3], v[48:51]
    v_mfma_f32_16x16x32_bf16 v[44:47], a[112:115], a[64:67], v[44:47]
    buffer_load_dwordx4 a[248:251], v3, s[12:15], s29 offen offset:3072 sc1
    v_mfma_f32_16x16x32_bf16 v[52:55], a[112:115], a[68:71], v[52:55]
    ds_read_b128 a[44:47], v34 offset:50176
    ds_read_b128 a[48:51], v35 offset:50176
    v_mfma_f32_16x16x32_bf16 v[116:119], a[112:115], a[72:75], v[116:119]
    s_waitcnt vmcnt(14)
    s_add_u32 s9, s58, 24576
    buffer_load_dword v18, v7, s[12:15], s9 offen offset:0 sc1
    s_waitcnt lgkmcnt(4)
    v_mfma_f32_16x16x32_bf16 v[40:43], a[116:119], a[12:15], v[40:43]
    ds_read_b128 a[60:63], v32 offset:51200
    ds_read_b128 a[64:67], v33 offset:51200
    v_mfma_f32_16x16x32_bf16 v[48:51], a[116:119], a[0:3], v[48:51]
    s_add_u32 m0, s61, 110592
    s_add_u32 s56, s39, 6201344
    buffer_load_dwordx4 v3, s[12:15], s56 offen sc1 lds
    v_mfma_f32_16x16x32_bf16 v[44:47], a[116:119], a[16:19], v[44:47]
    v_mfma_f32_16x16x32_bf16 v[52:55], a[116:119], a[20:23], v[52:55]
    ds_read_b128 a[68:71], v34 offset:51200
    ds_read_b128 a[72:75], v35 offset:51200
    v_mfma_f32_16x16x32_bf16 v[116:119], a[116:119], a[24:27], v[116:119]
    s_waitcnt lgkmcnt(4)
    s_nop 0
    v_mfma_f32_16x16x32_bf16 v[40:43], a[188:191], a[36:39], v[40:43]
    ds_read_b128 a[12:15], v32 offset:52224
    ds_read_b128 a[16:19], v33 offset:52224
    v_mfma_f32_16x16x32_bf16 v[48:51], a[188:191], a[0:3], v[48:51]
    s_add_u32 s18, s38, 6004736
    buffer_load_dwordx4 a[112:115], v3, s[12:15], s18 offen offset:0 sc1
    v_mfma_f32_16x16x32_bf16 v[44:47], a[188:191], a[40:43], v[44:47]
    v_mfma_f32_16x16x32_bf16 v[52:55], a[188:191], a[44:47], v[52:55]
    ds_read_b128 a[20:23], v34 offset:52224
    ds_read_b128 a[24:27], v35 offset:52224
    v_mfma_f32_16x16x32_bf16 v[116:119], a[188:191], a[48:51], v[116:119]
    v_add_u32 v32, 65536, v28
    v_add_u32 v33, 65536, v29
    v_add_u32 v34, 65536, v30
    v_add_u32 v35, 65536, v31
    s_waitcnt lgkmcnt(4)
    v_mfma_f32_16x16x32_bf16 v[40:43], a[192:195], a[60:63], v[40:43]
    s_barrier
    s_add_u32 s69, s21, 28672
    s_mov_b64 exec, 1
    buffer_store_dword v23, v24, s[12:15], s69 offen sc1
    s_mov_b64 exec, -1
    ds_read_b128 a[36:39], v32 offset:0
    ds_read_b128 a[40:43], v33 offset:0
    v_mfma_f32_16x16x32_bf16 v[48:51], a[192:195], a[0:3], v[48:51]
    buffer_load_dwordx4 a[116:119], v3, s[12:15], s18 offen offset:1024 sc1
    v_mfma_f32_16x16x32_bf16 v[44:47], a[192:195], a[64:67], v[44:47]
    v_mfma_f32_16x16x32_bf16 v[52:55], a[192:195], a[68:71], v[52:55]
    ds_read_b128 a[44:47], v34 offset:0
    ds_read_b128 a[48:51], v35 offset:0
    v_mfma_f32_16x16x32_bf16 v[116:119], a[192:195], a[72:75], v[116:119]
    buffer_load_dwordx4 a[188:191], v3, s[12:15], s18 offen offset:2048 sc1
    s_waitcnt lgkmcnt(4)
    s_nop 0
    v_mfma_f32_16x16x32_bf16 v[40:43], a[120:123], a[12:15], v[40:43]
    ds_read_b128 a[60:63], v32 offset:1024
    ds_read_b128 a[64:67], v33 offset:1024
    v_mfma_f32_16x16x32_bf16 v[48:51], a[120:123], a[0:3], v[48:51]
    v_mfma_f32_16x16x32_bf16 v[44:47], a[120:123], a[16:19], v[44:47]
    v_mfma_f32_16x16x32_bf16 v[52:55], a[120:123], a[20:23], v[52:55]
    ds_read_b128 a[68:71], v34 offset:1024
    ds_read_b128 a[72:75], v35 offset:1024
    v_mfma_f32_16x16x32_bf16 v[116:119], a[120:123], a[24:27], v[116:119]
    buffer_load_dwordx4 a[192:195], v3, s[12:15], s18 offen offset:3072 sc1
    s_waitcnt lgkmcnt(4)
    v_mfma_f32_16x16x32_bf16 v[40:43], a[196:199], a[36:39], v[40:43]
    ds_read_b128 a[12:15], v32 offset:2048
    ds_read_b128 a[16:19], v33 offset:2048
    v_mfma_f32_16x16x32_bf16 v[48:51], a[196:199], a[0:3], v[48:51]
    v_mfma_f32_16x16x32_bf16 v[44:47], a[196:199], a[40:43], v[44:47]
    s_waitcnt vmcnt(11)
    v_cmp_ne_u32 vcc, s47, v6
    s_nop 0
    s_cbranch_vccnz Lslow19
Lback20:
    s_lshl_b32 s69, s43, 14
    s_add_u32 s69, s69, s62
    s_nop 0
    s_add_u32 s69, s69, 27721728
    buffer_load_dwordx4 v[188:191], v3, s[12:15], s69 offen offset:0 sc1
    buffer_load_dwordx4 v[192:195], v3, s[12:15], s69 offen offset:1024 sc1
    buffer_load_dwordx4 v[200:203], v3, s[12:15], s69 offen offset:2048 sc1
    buffer_load_dwordx4 v[204:207], v3, s[12:15], s69 offen offset:3072 sc1
    v_mfma_f32_16x16x32_bf16 v[52:55], a[196:199], a[44:47], v[52:55]
    ds_read_b128 a[20:23], v34 offset:2048
    ds_read_b128 a[24:27], v35 offset:2048
    v_mfma_f32_16x16x32_bf16 v[116:119], a[196:199], a[48:51], v[116:119]
    s_waitcnt lgkmcnt(4)
    s_nop 0
    v_mfma_f32_16x16x32_bf16 v[40:43], a[4:7], a[60:63], v[40:43]
    ds_read_b128 a[36:39], v32 offset:3072
    ds_read_b128 a[40:43], v33 offset:3072
    v_mfma_f32_16x16x32_bf16 v[48:51], a[4:7], a[0:3], v[48:51]
    v_mfma_f32_16x16x32_bf16 v[44:47], a[4:7], a[64:67], v[44:47]
    v_mfma_f32_16x16x32_bf16 v[52:55], a[4:7], a[68:71], v[52:55]
    ds_read_b128 a[44:47], v34 offset:3072
    ds_read_b128 a[48:51], v35 offset:3072
    v_mfma_f32_16x16x32_bf16 v[116:119], a[4:7], a[72:75], v[116:119]
    s_waitcnt lgkmcnt(4)
    v_mfma_f32_16x16x32_bf16 v[40:43], a[8:11], a[12:15], v[40:43]
    v_mfma_f32_16x16x32_bf16 v[48:51], a[8:11], a[0:3], v[48:51]
    v_mfma_f32_16x16x32_bf16 v[44:47], a[8:11], a[16:19], v[44:47]
    v_mfma_f32_16x16x32_bf16 v[52:55], a[8:11], a[20:23], v[52:55]
    v_mfma_f32_16x16x32_bf16 v[116:119], a[8:11], a[24:27], v[116:119]
    s_waitcnt lgkmcnt(0)
    v_mfma_f32_16x16x32_bf16 v[40:43], a[200:203], a[36:39], v[40:43]
    v_mfma_f32_16x16x32_bf16 v[48:51], a[200:203], a[0:3], v[48:51]
    v_mfma_f32_16x16x32_bf16 v[44:47], a[200:203], a[40:43], v[44:47]
    v_mfma_f32_16x16x32_bf16 v[52:55], a[200:203], a[44:47], v[52:55]
    s_waitcnt vmcnt(10)
    v_cmp_ne_u32 vcc, s47, v18
    s_nop 0
    s_cbranch_vccnz Lslow22
Lback23:
    v_mfma_f32_16x16x32_bf16 v[116:119], a[200:203], a[48:51], v[116:119]
    s_nop 0
    s_nop 0
    v_fma_f32 v40, v48, v108, v40
    v_fma_f32 v41, v49, v108, v41
    v_fma_f32 v42, v50, v108, v42
    v_fma_f32 v43, v51, v108, v43
    v_fma_f32 v44, v48, v110, v44
    v_fma_f32 v45, v49, v110, v45
    v_fma_f32 v46, v50, v110, v46
    v_fma_f32 v47, v51, v110, v47
    v_fma_f32 v52, v48, v112, v52
    v_fma_f32 v53, v49, v112, v53
    s_add_u32 m0, s61, 106496
    s_add_u32 s56, s39, 6205440
    buffer_load_dwordx4 v3, s[12:15], s56 offen sc1 lds
    v_pk_fma_f32 v[54:55], v[50:51], v[112:113], v[54:55] op_sel_hi:[1,0,1]
    v_pk_fma_f32 v[116:117], v[48:49], v[114:115], v[116:117] op_sel_hi:[1,0,1]
    v_pk_fma_f32 v[118:119], v[50:51], v[114:115], v[118:119] op_sel_hi:[1,0,1]
    v_pk_mul_f32 v[40:41], v[40:41], v[108:109] op_sel:[0,1] op_sel_hi:[1,1]
    v_pk_mul_f32 v[42:43], v[42:43], v[108:109] op_sel:[0,1] op_sel_hi:[1,1]
    v_pk_mul_f32 v[44:45], v[44:45], v[110:111] op_sel:[0,1] op_sel_hi:[1,1]
    v_pk_mul_f32 v[46:47], v[46:47], v[110:111] op_sel:[0,1] op_sel_hi:[1,1]
    v_pk_mul_f32 v[120:121], v[40:41], v[40:41]
    v_pk_mul_f32 v[122:123], v[42:43], v[42:43]
    v_pk_mul_f32 v[128:129], v[44:45], v[44:45]
    v_pk_mul_f32 v[130:131], v[46:47], v[46:47]
    v_pk_fma_f32 v[120:121], v[120:121], s[40:41], v[66:67]
    v_pk_fma_f32 v[122:123], v[122:123], s[40:41], v[66:67]
    v_pk_fma_f32 v[128:129], v[128:129], s[40:41], v[66:67]
    s_add_u32 s29, s38, 6008832
    buffer_load_dwordx4 a[4:7], v3, s[12:15], s29 offen offset:0 sc1
    v_pk_fma_f32 v[130:131], v[130:131], s[40:41], v[66:67]
    v_pk_mul_f32 v[120:121], v[120:121], v[40:41]
    v_pk_mul_f32 v[122:123], v[122:123], v[42:43]
    v_pk_mul_f32 v[128:129], v[128:129], v[44:45]
    v_pk_mul_f32 v[130:131], v[130:131], v[46:47]
    v_exp_f32 v120, v120
    v_exp_f32 v121, v121
    v_exp_f32 v122, v122
    v_exp_f32 v123, v123
    v_exp_f32 v128, v128
    v_exp_f32 v129, v129
    v_exp_f32 v130, v130
    buffer_load_dwordx4 a[8:11], v3, s[12:15], s29 offen offset:1024 sc1
    v_exp_f32 v131, v131
    v_pk_add_f32 v[120:121], v[120:121], 1.0 op_sel_hi:[1,0]
    v_pk_add_f32 v[122:123], v[122:123], 1.0 op_sel_hi:[1,0]
    v_pk_add_f32 v[128:129], v[128:129], 1.0 op_sel_hi:[1,0]
    v_pk_add_f32 v[130:131], v[130:131], 1.0 op_sel_hi:[1,0]
    v_rcp_f32 v120, v120
    v_rcp_f32 v121, v121
    v_rcp_f32 v122, v122
    v_rcp_f32 v123, v123
    v_rcp_f32 v128, v128
    buffer_load_dwordx4 a[120:123], v3, s[12:15], s29 offen offset:2048 sc1
    v_rcp_f32 v129, v129
    v_rcp_f32 v130, v130
    v_rcp_f32 v131, v131
    v_pk_mul_f32 v[40:41], v[40:41], v[120:121]
    v_pk_mul_f32 v[42:43], v[42:43], v[122:123]
    v_pk_mul_f32 v[44:45], v[44:45], v[128:129]
    v_pk_mul_f32 v[46:47], v[46:47], v[130:131]
    v_cvt_pk_bf16_f32 v40, v40, v41
    v_cvt_pk_bf16_f32 v41, v42, v43
    v_cvt_pk_bf16_f32 v42, v44, v45
    v_cvt_pk_bf16_f32 v43, v46, v47
    v_pk_mul_f32 v[52:53], v[52:53], v[112:113] op_sel:[0,1] op_sel_hi:[1,1]
    v_pk_mul_f32 v[54:55], v[54:55], v[112:113] op_sel:[0,1] op_sel_hi:[1,1]
    v_pk_mul_f32 v[116:117], v[116:117], v[114:115] op_sel:[0,1] op_sel_hi:[1,1]
    v_pk_mul_f32 v[118:119], v[118:119], v[114:115] op_sel:[0,1] op_sel_hi:[1,1]
    buffer_load_dwordx4 a[196:199], v3, s[12:15], s29 offen offset:3072 sc1
    v_pk_mul_f32 v[120:121], v[52:53], v[52:53]
    v_pk_mul_f32 v[122:123], v[54:55], v[54:55]
    v_pk_mul_f32 v[128:129], v[116:117], v[116:117]
    v_pk_mul_f32 v[130:131], v[118:119], v[118:119]
    v_pk_fma_f32 v[120:121], v[120:121], s[40:41], v[66:67]
    v_pk_fma_f32 v[122:123], v[122:123], s[40:41], v[66:67]
    v_pk_fma_f32 v[128:129], v[128:129], s[40:41], v[66:67]
    v_pk_fma_f32 v[130:131], v[130:131], s[40:41], v[66:67]
    v_pk_mul_f32 v[120:121], v[120:121], v[52:53]
    v_pk_mul_f32 v[122:123], v[122:123], v[54:55]
    v_pk_mul_f32 v[128:129], v[128:129], v[116:117]
    v_pk_mul_f32 v[130:131], v[130:131], v[118:119]
    v_exp_f32 v120, v120
    v_exp_f32 v121, v121
    s_add_u32 m0, s61, 102400
    s_add_u32 s56, s17, 5226496
    buffer_load_dwordx4 v3, s[12:15], s56 offen sc1 lds
    v_exp_f32 v122, v122
    v_exp_f32 v123, v123
    v_exp_f32 v128, v128
    v_exp_f32 v129, v129
    v_exp_f32 v130, v130
    v_exp_f32 v131, v131
    v_pk_add_f32 v[120:121], v[120:121], 1.0 op_sel_hi:[1,0]
    v_pk_add_f32 v[122:123], v[122:123], 1.0 op_sel_hi:[1,0]
    v_pk_add_f32 v[128:129], v[128:129], 1.0 op_sel_hi:[1,0]
    s_add_u32 s18, s16, 5144576
    buffer_load_dwordx4 a[200:203], v3, s[12:15], s18 offen offset:0 sc1
    v_pk_add_f32 v[130:131], v[130:131], 1.0 op_sel_hi:[1,0]
    v_rcp_f32 v120, v120
    v_rcp_f32 v121, v121
    v_rcp_f32 v122, v122
    v_rcp_f32 v123, v123
    v_rcp_f32 v128, v128
    v_rcp_f32 v129, v129
    v_rcp_f32 v130, v130
    buffer_load_dwordx4 a[252:255], v3, s[12:15], s18 offen offset:1024 sc1
    v_rcp_f32 v131, v131
    v_pk_mul_f32 v[52:53], v[52:53], v[120:121]
    v_pk_mul_f32 v[54:55], v[54:55], v[122:123]
    v_pk_mul_f32 v[116:117], v[116:117], v[128:129]
    v_pk_mul_f32 v[118:119], v[118:119], v[130:131]
    v_cvt_pk_bf16_f32 v44, v52, v53
    v_cvt_pk_bf16_f32 v45, v54, v55
    v_cvt_pk_bf16_f32 v46, v116, v117
    v_cvt_pk_bf16_f32 v47, v118, v119
    s_mul_i32 s8, s42, 196608
    s_lshl_b32 s9, s43, 11
    s_add_u32 s8, s8, s9
    s_add_u32 s8, s8, 17793024
    v_permlane16_swap_b32 v40, v42
    v_permlane16_swap_b32 v41, v43
    v_permlane16_swap_b32 v44, v46
    v_permlane16_swap_b32 v45, v47
    buffer_store_dwordx4 v[40:43], v16, s[12:15], s8 offen offset:0 sc1
    buffer_store_dwordx4 v[44:47], v17, s[12:15], s8 offen offset:0 sc1
    s_nop 1
    s_barrier
    s_add_u32 m0, s62, 0
    s_add_u32 s57, s20, 17760256
    buffer_load_dwordx4 v3, s[12:15], s57 offen offset:0 sc1 lds
    buffer_load_dwordx4 v3, s[12:15], s57 offen offset:1024 sc1 lds
    buffer_load_dwordx4 v3, s[12:15], s57 offen offset:2048 sc1 lds
    buffer_load_dwordx4 v3, s[12:15], s57 offen offset:3072 sc1 lds
    v_lshrrev_b32 v136, 5, v2
    v_and_b32 v137, 31, v2
    v_mad_u32_u24 v136, v136, 28, v137
    s_lshl_b32 s8, s3, 11
    s_add_u32 s8, s8, 92160
    v_lshl_add_u32 v136, v136, 3, s8
    s_waitcnt vmcnt(14)
    s_nop 0
    v_cvt_pk_bf16_f32 v188, v188, v189
    v_cvt_pk_bf16_f32 v189, v190, v191
    v_cvt_pk_bf16_f32 v192, v192, v193
    v_cvt_pk_bf16_f32 v193, v194, v195
    v_cvt_pk_bf16_f32 v200, v200, v201
    v_cvt_pk_bf16_f32 v201, v202, v203
    v_cvt_pk_bf16_f32 v204, v204, v205
    v_cvt_pk_bf16_f32 v205, v206, v207
    s_mov_b32 exec_lo, 0xfffffff
    s_mov_b32 exec_hi, 0xfffffff
    ds_write_b64 v136, v[188:189] offset:0
    ds_write_b64 v136, v[192:193] offset:448
    ds_write_b64 v136, v[200:201] offset:896
    s_mov_b32 exec_hi, 0x3fff
    ds_write_b64 v136, v[204:205] offset:1344
    s_mov_b64 exec, -1
    v_add_u32 v137, 16, v4
    v_min_u32_e64 v137, 20, v137
    v_mul_u32_u24 v136, 80, v4
    v_mul_u32_u24 v137, 80, v137
    v_add_u32 v136, s8, v136
    v_add_u32 v137, s8, v137
    v_lshl_add_u32 v138, v5, 4, v136
    v_lshl_add_u32 v139, v5, 4, v137
    v_lshl_add_u32 v136, v5, 2, v136
    v_lshl_add_u32 v137, v5, 2, v137
    v_mov_b32 v201, 0
    v_mov_b32 v203, 0
    s_add_u32 m0, s62, 16384
    s_add_u32 s57, s20, 17764352
    buffer_load_dwordx4 v3, s[12:15], s57 offen offset:0 sc1 lds
    buffer_load_dwordx4 v3, s[12:15], s57 offen offset:1024 sc1 lds
    buffer_load_dwordx4 v3, s[12:15], s57 offen offset:2048 sc1 lds
    buffer_load_dwordx4 v3, s[12:15], s57 offen offset:3072 sc1 lds
    s_waitcnt lgkmcnt(0)
    s_nop 0
    ds_read_b128 v[188:191], v138
    ds_read_b128 v[192:195], v139
    ds_read_b32 v200, v136 offset:64
    ds_read_b32 v202, v137 offset:64
    s_add_u32 m0, s62, 32768
    s_add_u32 s57, s20, 17768448
    buffer_load_dwordx4 v3, s[12:15], s57 offen offset:0 sc1 lds
    buffer_load_dwordx4 v3, s[12:15], s57 offen offset:1024 sc1 lds
    s_waitcnt lgkmcnt(0)
    s_nop 0
    v_mfma_f32_16x16x32_bf16 v[140:143], v[188:191], v[80:83], 0
    v_mfma_f32_16x16x32_bf16 v[156:159], v[192:195], v[80:83], 0
    v_mfma_f32_16x16x32_bf16 v[144:147], v[188:191], v[96:99], 0
    v_mfma_f32_16x16x32_bf16 v[160:163], v[192:195], v[96:99], 0
    v_mfma_f32_16x16x32_bf16 v[148:151], v[188:191], v[100:103], 0
    v_mfma_f32_16x16x32_bf16 v[164:167], v[192:195], v[100:103], 0
    v_mfma_f32_16x16x32_bf16 v[152:155], v[188:191], v[124:127], 0
    v_mfma_f32_16x16x32_bf16 v[168:171], v[192:195], v[124:127], 0
    v_mfma_f32_16x16x16_bf16 v[140:143], v[200:201], v[92:93], v[140:143]
    v_mfma_f32_16x16x16_bf16 v[156:159], v[202:203], v[92:93], v[156:159]
    v_mfma_f32_16x16x16_bf16 v[144:147], v[200:201], v[94:95], v[144:147]
    v_mfma_f32_16x16x16_bf16 v[160:163], v[202:203], v[94:95], v[160:163]
    v_mfma_f32_16x16x16_bf16 v[148:151], v[200:201], v[104:105], v[148:151]
    v_mfma_f32_16x16x16_bf16 v[164:167], v[202:203], v[104:105], v[164:167]
    v_mfma_f32_16x16x16_bf16 v[152:155], v[200:201], v[106:107], v[152:155]
    v_mfma_f32_16x16x16_bf16 v[168:171], v[202:203], v[106:107], v[168:171]
    buffer_load_dwordx4 v3, s[12:15], s57 offen offset:2048 sc1 lds
    buffer_load_dwordx4 v3, s[12:15], s57 offen offset:3072 sc1 lds
    s_add_u32 m0, s62, 49152
    s_add_u32 s57, s20, 17772544
    buffer_load_dwordx4 v3, s[12:15], s57 offen offset:0 sc1 lds
    s_add_u32 s10, s58, 28672
    buffer_load_dword v6, v7, s[12:15], s10 offen offset:0 sc1
    s_waitcnt vmcnt(14)
    v_mov_b32 v172, v156
    v_mov_b32 v176, v156
    v_mov_b32 v173, v160
    v_mov_b32 v177, v160
    v_mov_b32 v174, v164
    v_mov_b32 v178, v164
    v_mov_b32 v175, v168
    v_mov_b32 v179, v168
    v_permlane16_swap_b32 v176, v172
    v_permlane16_swap_b32 v177, v173
    v_permlane16_swap_b32 v178, v174
    v_permlane16_swap_b32 v179, v175
    v_cvt_pk_bf16_f32 v176, v172, v173
    v_cvt_pk_bf16_f32 v177, v174, v175
    v_lshlrev_b32 v172, 16, v176
    v_and_b32 v173, 0xffff0000, v176
    v_lshlrev_b32_e64 v174, 16, v177
    v_and_b32 v175, 0xffff0000, v177
    v_add_f32 v172, 0x358637bd, v172
    v_add_f32 v173, 0x358637bd, v173
    v_add_f32 v174, 0x358637bd, v174
    v_add_f32 v175, 0x358637bd, v175
    v_cvt_pk_bf16_f32 v176, v172, v173
    v_cvt_pk_bf16_f32 v177, v174, v175
    v_lshlrev_b32 v172, 16, v176
    v_and_b32 v173, 0xffff0000, v176
    v_lshlrev_b32 v174, 16, v177
    v_and_b32 v175, 0xffff0000, v177
    v_rcp_f32 v172, v172
    v_rcp_f32 v173, v173
    s_waitcnt vmcnt(10)
    s_barrier
    v_add_u32 v32, 0, v28
    s_add_u32 s69, s21, 102400
    s_mov_b64 exec, 1
    buffer_store_dword v23, v24, s[12:15], s69 offen sc1
    s_mov_b64 exec, -1
    v_add_u32 v33, 0, v29
    v_add_u32 v34, 0, v30
    v_add_u32 v35, 0, v31
    ds_read_b128 a[12:15], v32 offset:0
    ds_read_b128 a[28:31], v27 offset:61440
    ds_read_b128 a[16:19], v33 offset:0
    ds_read_b128 a[20:23], v34 offset:0
    ds_read_b128 a[24:27], v35 offset:0
    ds_read_b128 a[36:39], v32 offset:1024
    ds_read_b128 a[52:55], v27 offset:62464
    ds_read_b128 a[40:43], v33 offset:1024
    ds_read_b128 a[44:47], v34 offset:1024
    ds_read_b128 a[48:51], v35 offset:1024
    s_waitcnt lgkmcnt(9)
    v_mfma_f32_16x16x32_bf16 v[40:43], a[124:127], a[12:15], 0
    ds_read_b128 a[60:63], v32 offset:2048
    ds_read_b128 a[76:79], v27 offset:63488
    v_rcp_f32 v174, v174
    v_rcp_f32_e64 v175, v175
    v_cvt_pk_bf16_f32 v80, v156, v157
    v_cvt_pk_bf16_f32 v81, v158, v159
    s_waitcnt lgkmcnt(10)
    s_nop 0
    v_mfma_f32_16x16x32_bf16 v[108:111], a[28:31], a[12:15], 0
    buffer_load_dwordx4 v3, s[12:15], s57 offen offset:1024 sc1 lds
    v_cvt_pk_bf16_f32 v82, v160, v161
    v_cvt_pk_bf16_f32 v83, v162, v163
    v_cvt_pk_bf16_f32 v96, v164, v165
    v_cvt_pk_bf16_f32 v97, v166, v167
    s_waitcnt lgkmcnt(9)
    v_mfma_f32_16x16x32_bf16 v[44:47], a[124:127], a[16:19], 0
    ds_read_b128 a[64:67], v33 offset:2048
    ds_read_b128 a[68:71], v34 offset:2048
    v_cvt_pk_bf16_f32 v98, v168, v169
    v_cvt_pk_bf16_f32 v99, v170, v171
    v_lshlrev_b32 v156, 16, v80
    v_and_b32 v157, 0xffff0000, v80
    s_waitcnt lgkmcnt(10)
    v_mfma_f32_16x16x32_bf16 v[48:51], a[124:127], a[20:23], 0
    ds_read_b128 a[72:75], v35 offset:2048
    v_lshlrev_b32 v158, 16, v81
    v_and_b32 v159, 0xffff0000, v81
    v_lshlrev_b32 v160, 16, v82
    v_and_b32 v161, 0xffff0000, v82
    s_waitcnt lgkmcnt(10)
    v_mfma_f32_16x16x32_bf16 v[52:55], a[124:127], a[24:27], 0
    buffer_load_dwordx4 v3, s[12:15], s57 offen offset:2048 sc1 lds
    v_lshlrev_b32 v162, 16, v83
    v_and_b32 v163, 0xffff0000, v83
    v_lshlrev_b32 v164, 16, v96
    v_and_b32 v165, 0xffff0000, v96
    s_waitcnt lgkmcnt(5)
    v_mfma_f32_16x16x32_bf16 v[40:43], v[252:255], a[36:39], v[40:43]
    ds_read_b128 a[12:15], v32 offset:3072
    ds_read_b128 a[28:31], v27 offset:64512
    v_lshlrev_b32 v166, 16, v97
    v_and_b32 v167, 0xffff0000, v97
    v_lshlrev_b32_e64 v168, 16, v98
    v_and_b32 v169, 0xffff0000, v98
    v_mfma_f32_16x16x32_bf16 v[108:111], a[52:55], a[36:39], v[108:111]
    buffer_load_dwordx4 v3, s[12:15], s57 offen offset:3072 sc1 lds
    v_lshlrev_b32_e64 v170, 16, v99
    v_and_b32 v171, 0xffff0000, v99
    v_mul_f32_e64 v156, v156, v172
    v_mul_f32_e64 v157, v157, v172
    v_mul_f32_e64 v158, v158, v172
    v_mul_f32_e64 v159, v159, v172
    v_mfma_f32_16x16x32_bf16 v[44:47], v[252:255], a[40:43], v[44:47]
    ds_read_b128 a[16:19], v33 offset:3072
    ds_read_b128 a[20:23], v34 offset:3072
    v_mul_f32_e64 v160, v160, v173
    v_mul_f32_e64 v161, v161, v173
    v_mul_f32_e64 v162, v162, v173
    v_mul_f32_e64 v163, v163, v173
    v_mul_f32_e64 v164, v164, v174
    v_mul_f32_e64 v165, v165, v174
    v_mul_f32_e64 v166, v166, v174
    v_mul_f32_e64 v167, v167, v174
    v_mfma_f32_16x16x32_bf16 v[48:51], v[252:255], a[44:47], v[48:51]
    ds_read_b128 a[24:27], v35 offset:3072
    v_mul_f32_e64 v168, v168, v175
    v_mul_f32_e64 v169, v169, v175
    v_mul_f32_e64 v170, v170, v175
    v_mul_f32_e64 v171, v171, v175
    v_cvt_pk_bf16_f32 v156, v156, v157
    v_cvt_pk_bf16_f32 v157, v158, v159
    v_mfma_f32_16x16x32_bf16 v[52:55], v[252:255], a[48:51], v[52:55]
    buffer_load_dwordx4 a[124:127], v3, s[12:15], s18 offen offset:2048 sc1
    v_cvt_pk_bf16_f32 v158, v160, v161
    v_cvt_pk_bf16_f32 v159, v162, v163
    v_cvt_pk_bf16_f32 v160, v164, v165
    v_cvt_pk_bf16_f32 v161, v166, v167
    s_waitcnt vmcnt(11)
    s_waitcnt lgkmcnt(0)
    s_barrier
    s_nop 0
    v_mfma_f32_16x16x32_bf16 v[40:43], v[248:251], a[60:63], v[40:43]
    ds_read_b128 a[36:39], v32 offset:16384
    ds_read_b128 a[52:55], v27 offset:57344
    v_cvt_pk_bf16_f32 v162, v168, v169
    v_cvt_pk_bf16_f32 v163, v170, v171
    s_mov_b64 exec, 0xffff
    ds_write_b64 v68, v[156:157]
    ds_write_b64 v69, v[158:159]
    ds_write_b64 v70, v[160:161]
    ds_write_b64 v71, v[162:163]
    s_mov_b64 exec, -1
    s_nop 0
    v_cvt_pk_bf16_f32 v80, v140, v141
    v_mfma_f32_16x16x32_bf16 v[108:111], a[76:79], a[60:63], v[108:111]
    v_cvt_pk_bf16_f32 v81, v142, v143
    v_cvt_pk_bf16_f32 v82, v144, v145
    v_cvt_pk_bf16_f32 v83, v146, v147
    v_cvt_pk_bf16_f32 v96, v148, v149
    v_mfma_f32_16x16x32_bf16 v[44:47], v[248:251], a[64:67], v[44:47]
    ds_read_b128 a[40:43], v33 offset:16384
    ds_read_b128 a[44:47], v34 offset:16384
    v_cvt_pk_bf16_f32 v97, v150, v151
    v_cvt_pk_bf16_f32 v98, v152, v153
    v_cvt_pk_bf16_f32 v99, v154, v155
    v_lshlrev_b32_e64 v140, 16, v80
    v_mfma_f32_16x16x32_bf16 v[48:51], v[248:251], a[68:71], v[48:51]
    ds_read_b128 a[48:51], v35 offset:16384
    v_and_b32 v141, 0xffff0000, v80
    v_lshlrev_b32 v142, 16, v81
    v_and_b32 v143, 0xffff0000, v81
    v_lshlrev_b32 v144, 16, v82
    v_mfma_f32_16x16x32_bf16 v[52:55], v[248:251], a[72:75], v[52:55]
    v_and_b32 v145, 0xffff0000, v82
    v_lshlrev_b32 v146, 16, v83
    s_waitcnt vmcnt(5)
    v_cmp_ne_u32 vcc, s47, v6
    s_nop 0
    s_cbranch_vccnz Lslow25
Lback26:
    v_and_b32 v147, 0xffff0000, v83
    v_lshlrev_b32 v148, 16, v96
    v_mfma_f32_16x16x32_bf16 v[40:43], a[204:207], a[12:15], v[40:43]
    ds_read_b128 a[60:63], v32 offset:17408
    ds_read_b128 a[76:79], v27 offset:58368
    v_and_b32 v149, 0xffff0000, v96
    v_lshlrev_b32 v150, 16, v97
    v_and_b32 v151, 0xffff0000, v97
    v_lshlrev_b32 v152, 16, v98
    v_mfma_f32_16x16x32_bf16 v[108:111], a[28:31], a[12:15], v[108:111]
    s_add_u32 m0, s62, 0
    s_add_u32 s57, s20, 17776640
    buffer_load_dwordx4 v3, s[12:15], s57 offen offset:0 sc1 lds
    buffer_load_dwordx4 v3, s[12:15], s57 offen offset:1024 sc1 lds
    v_and_b32 v153, 0xffff0000, v98
    v_lshlrev_b32 v154, 16, v99
    v_and_b32 v155, 0xffff0000, v99
    v_mul_f32_e64 v140, v140, v172
    v_mul_f32_e64 v141, v141, v172
    v_mfma_f32_16x16x32_bf16 v[44:47], a[204:207], a[16:19], v[44:47]
    ds_read_b128 a[64:67], v33 offset:17408
    ds_read_b128 a[68:71], v34 offset:17408
    v_mul_f32_e64 v142, v142, v172
    v_mul_f32_e64 v143, v143, v172
    v_mul_f32_e64 v144, v144, v173
    v_mul_f32_e64 v145, v145, v173
    v_mul_f32_e64 v146, v146, v173
    v_mul_f32_e64 v147, v147, v173
    v_mul_f32_e64 v148, v148, v174
    v_mul_f32_e64 v149, v149, v174
    v_mfma_f32_16x16x32_bf16 v[48:51], a[204:207], a[20:23], v[48:51]
    ds_read_b128 a[72:75], v35 offset:17408
    v_mul_f32_e64 v150, v150, v174
    v_mul_f32_e64 v151, v151, v174
    v_mul_f32_e64 v152, v152, v175
    v_mul_f32_e64 v153, v153, v175
    v_mul_f32_e64 v154, v154, v175
    v_mul_f32_e64 v155, v155, v175
    v_cvt_pk_bf16_f32 v140, v140, v141
    v_mfma_f32_16x16x32_bf16 v[52:55], a[204:207], a[24:27], v[52:55]
    buffer_load_dwordx4 v3, s[12:15], s57 offen offset:2048 sc1 lds
    buffer_load_dwordx4 v3, s[12:15], s57 offen offset:3072 sc1 lds
    v_cvt_pk_bf16_f32 v141, v142, v143
    v_cvt_pk_bf16_f32 v142, v144, v145
    v_cvt_pk_bf16_f32 v143, v146, v147
    v_cvt_pk_bf16_f32 v144, v148, v149
    s_waitcnt lgkmcnt(5)
    s_nop 0
    v_mfma_f32_16x16x32_bf16 v[40:43], a[208:211], a[36:39], v[40:43]
    ds_read_b128 a[12:15], v32 offset:18432
    ds_read_b128 a[28:31], v27 offset:59392
    v_cvt_pk_bf16_f32 v145, v150, v151
    v_cvt_pk_bf16_f32 v146, v152, v153
    v_cvt_pk_bf16_f32 v147, v154, v155
    s_waitcnt lgkmcnt(0)
    s_barrier
    ds_read_b64 v[148:149], v75
    v_mfma_f32_16x16x32_bf16 v[108:111], a[52:55], a[36:39], v[108:111]
    s_add_u32 m0, s62, 65536
    s_add_u32 s57, s20, 17780736
    buffer_load_dwordx4 v3, s[12:15], s57 offen offset:0 sc1 lds
    buffer_load_dwordx4 v3, s[12:15], s57 offen offset:1024 sc1 lds
    v_mfma_f32_16x16x32_bf16 v[44:47], a[208:211], a[40:43], v[44:47]
    ds_read_b128 a[16:19], v33 offset:18432
    ds_read_b128 a[20:23], v34 offset:18432
    v_mfma_f32_16x16x32_bf16 v[48:51], a[208:211], a[44:47], v[48:51]
    ds_read_b128 a[24:27], v35 offset:18432
    v_mfma_f32_16x16x32_bf16 v[52:55], a[208:211], a[48:51], v[52:55]
    buffer_load_dwordx4 v3, s[12:15], s57 offen offset:2048 sc1 lds
    s_waitcnt lgkmcnt(3)
    v_mov_b32 v150, v148
    v_mov_b32_e64 v151, v149
    s_add_u32 s8, s23, 15138816
    v_mfma_f32_16x16x32_bf16 v[40:43], a[128:131], a[60:63], v[40:43]
    ds_read_b128 a[36:39], v32 offset:19456
    ds_read_b128 a[52:55], v27 offset:60416
    v_permlane16_swap_b32 v140, v142
    v_permlane16_swap_b32 v141, v143
    v_permlane16_swap_b32 v144, v146
    v_permlane16_swap_b32 v145, v147
    v_mfma_f32_16x16x32_bf16 v[108:111], a[76:79], a[60:63], v[108:111]
    buffer_load_dwordx4 v3, s[12:15], s57 offen offset:3072 sc1 lds
    v_permlane16_swap_b32 v148, v150
    v_permlane16_swap_b32 v149, v151
    buffer_store_dwordx4 v[140:143], v64, s[12:15], s8 offen sc1
    buffer_store_dwordx4 v[144:147], v65, s[12:15], s8 offen sc1
    buffer_store_dwordx4 v[148:151], v25, s[12:15], s8 offen sc1
    s_nop 1
    s_nop 0
    v_mfma_f32_16x16x32_bf16 v[44:47], a[128:131], a[64:67], v[44:47]
    ds_read_b128 a[40:43], v33 offset:19456
    ds_read_b128 a[44:47], v34 offset:19456
    v_mfma_f32_16x16x32_bf16 v[48:51], a[128:131], a[68:71], v[48:51]
    ds_read_b128 a[48:51], v35 offset:19456
    v_mfma_f32_16x16x32_bf16 v[52:55], a[128:131], a[72:75], v[52:55]
    buffer_load_dwordx4 a[204:207], v3, s[12:15], s18 offen offset:3072 sc1
    s_waitcnt lgkmcnt(0)
    s_barrier
    v_mfma_f32_16x16x32_bf16 v[40:43], v[244:247], a[12:15], v[40:43]
    ds_read_b128 a[60:63], v32 offset:32768
    ds_read_b128 a[76:79], v27 offset:53248
    v_mfma_f32_16x16x32_bf16 v[108:111], a[28:31], a[12:15], v[108:111]
    s_add_u32 m0, s62, 16384
    s_add_u32 s57, s20, 17784832
    buffer_load_dwordx4 v3, s[12:15], s57 offen offset:0 sc1 lds
    v_mfma_f32_16x16x32_bf16 v[44:47], v[244:247], a[16:19], v[44:47]
    ds_read_b128 a[64:67], v33 offset:32768
    ds_read_b128 a[68:71], v34 offset:32768
    v_mfma_f32_16x16x32_bf16 v[48:51], v[244:247], a[20:23], v[48:51]
    ds_read_b128 a[72:75], v35 offset:32768
    v_mfma_f32_16x16x32_bf16 v[52:55], v[244:247], a[24:27], v[52:55]
    v_mfma_f32_16x16x32_bf16 v[40:43], a[212:215], a[36:39], v[40:43]
    ds_read_b128 a[12:15], v32 offset:33792
    ds_read_b128 a[28:31], v27 offset:54272
    v_mfma_f32_16x16x32_bf16 v[108:111], a[52:55], a[36:39], v[108:111]
    buffer_load_dwordx4 v3, s[12:15], s57 offen offset:1024 sc1 lds
    v_mfma_f32_16x16x32_bf16 v[44:47], a[212:215], a[40:43], v[44:47]
    ds_read_b128 a[16:19], v33 offset:33792
    ds_read_b128 a[20:23], v34 offset:33792
    v_mfma_f32_16x16x32_bf16 v[48:51], a[212:215], a[44:47], v[48:51]
    ds_read_b128 a[24:27], v35 offset:33792
    v_mfma_f32_16x16x32_bf16 v[52:55], a[212:215], a[48:51], v[52:55]
    buffer_load_dwordx4 v3, s[12:15], s57 offen offset:2048 sc1 lds
    s_waitcnt lgkmcnt(5)
    s_nop 0
    v_mfma_f32_16x16x32_bf16 v[40:43], v[240:243], a[60:63], v[40:43]
    ds_read_b128 a[36:39], v32 offset:34816
    ds_read_b128 a[52:55], v27 offset:55296
    v_mfma_f32_16x16x32_bf16 v[108:111], a[76:79], a[60:63], v[108:111]
    v_mfma_f32_16x16x32_bf16 v[44:47], v[240:243], a[64:67], v[44:47]
    ds_read_b128 a[40:43], v33 offset:34816
    ds_read_b128 a[44:47], v34 offset:34816
    v_mfma_f32_16x16x32_bf16 v[48:51], v[240:243], a[68:71], v[48:51]
    ds_read_b128 a[48:51], v35 offset:34816
    v_mfma_f32_16x16x32_bf16 v[52:55], v[240:243], a[72:75], v[52:55]
    buffer_load_dwordx4 v3, s[12:15], s57 offen offset:3072 sc1 lds
    s_waitcnt lgkmcnt(5)
    s_nop 0
    v_mfma_f32_16x16x32_bf16 v[40:43], a[216:219], a[12:15], v[40:43]
    ds_read_b128 a[60:63], v32 offset:35840
    ds_read_b128 a[76:79], v27 offset:56320
    v_mfma_f32_16x16x32_bf16 v[108:111], a[28:31], a[12:15], v[108:111]
    v_mfma_f32_16x16x32_bf16 v[44:47], a[216:219], a[16:19], v[44:47]
    ds_read_b128 a[64:67], v33 offset:35840
    ds_read_b128 a[68:71], v34 offset:35840
    v_mfma_f32_16x16x32_bf16 v[48:51], a[216:219], a[20:23], v[48:51]
    ds_read_b128 a[72:75], v35 offset:35840
    v_mfma_f32_16x16x32_bf16 v[52:55], a[216:219], a[24:27], v[52:55]
    s_waitcnt vmcnt(17)
    s_waitcnt lgkmcnt(0)
    s_barrier
    s_nop 0
    v_mfma_f32_16x16x32_bf16 v[40:43], a[132:135], a[36:39], v[40:43]
    ds_read_b128 a[12:15], v32 offset:49152
    ds_read_b128 a[28:31], v27 offset:49152
    v_mfma_f32_16x16x32_bf16 v[108:111], a[52:55], a[36:39], v[108:111]
    s_add_u32 m0, s62, 32768
    s_add_u32 s57, s20, 17788928
    buffer_load_dwordx4 v3, s[12:15], s57 offen offset:0 sc1 lds
    v_mfma_f32_16x16x32_bf16 v[44:47], a[132:135], a[40:43], v[44:47]
    ds_read_b128 a[16:19], v33 offset:49152
    ds_read_b128 a[20:23], v34 offset:49152
    v_mfma_f32_16x16x32_bf16 v[48:51], a[132:135], a[44:47], v[48:51]
    ds_read_b128 a[24:27], v35 offset:49152
    v_mfma_f32_16x16x32_bf16 v[52:55], a[132:135], a[48:51], v[52:55]
    buffer_load_dwordx4 v3, s[12:15], s57 offen offset:1024 sc1 lds
    v_mfma_f32_16x16x32_bf16 v[40:43], a[220:223], a[60:63], v[40:43]
    ds_read_b128 a[36:39], v32 offset:50176
    ds_read_b128 a[52:55], v27 offset:50176
    v_mfma_f32_16x16x32_bf16 v[108:111], a[76:79], a[60:63], v[108:111]
    buffer_load_dwordx4 v3, s[12:15], s57 offen offset:2048 sc1 lds
    v_mfma_f32_16x16x32_bf16 v[44:47], a[220:223], a[64:67], v[44:47]
    ds_read_b128 a[40:43], v33 offset:50176
    ds_read_b128 a[44:47], v34 offset:50176
    v_mfma_f32_16x16x32_bf16 v[48:51], a[220:223], a[68:71], v[48:51]
    ds_read_b128 a[48:51], v35 offset:50176
    v_mfma_f32_16x16x32_bf16 v[52:55], a[220:223], a[72:75], v[52:55]
    buffer_load_dwordx4 v3, s[12:15], s57 offen offset:3072 sc1 lds
    s_waitcnt lgkmcnt(5)
    s_nop 0
    v_mfma_f32_16x16x32_bf16 v[40:43], a[136:139], a[12:15], v[40:43]
    ds_read_b128 a[60:63], v32 offset:51200
    ds_read_b128 a[76:79], v27 offset:51200
    v_mfma_f32_16x16x32_bf16 v[108:111], a[28:31], a[12:15], v[108:111]
    v_mfma_f32_16x16x32_bf16 v[44:47], a[136:139], a[16:19], v[44:47]
    ds_read_b128 a[64:67], v33 offset:51200
    ds_read_b128 a[68:71], v34 offset:51200
    v_mfma_f32_16x16x32_bf16 v[48:51], a[136:139], a[20:23], v[48:51]
    ds_read_b128 a[72:75], v35 offset:51200
    v_mfma_f32_16x16x32_bf16 v[52:55], a[136:139], a[24:27], v[52:55]
    s_waitcnt lgkmcnt(5)
    s_nop 0
    v_mfma_f32_16x16x32_bf16 v[40:43], a[144:147], a[36:39], v[40:43]
    ds_read_b128 a[12:15], v32 offset:52224
    ds_read_b128 a[28:31], v27 offset:52224
    v_mfma_f32_16x16x32_bf16 v[108:111], a[52:55], a[36:39], v[108:111]
    v_mfma_f32_16x16x32_bf16 v[44:47], a[144:147], a[40:43], v[44:47]
    ds_read_b128 a[16:19], v33 offset:52224
    ds_read_b128 a[20:23], v34 offset:52224
    v_mfma_f32_16x16x32_bf16 v[48:51], a[144:147], a[44:47], v[48:51]
    ds_read_b128 a[24:27], v35 offset:52224
    v_mfma_f32_16x16x32_bf16 v[52:55], a[144:147], a[48:51], v[52:55]
    s_waitcnt lgkmcnt(5)
    v_mfma_f32_16x16x32_bf16 v[40:43], a[224:227], a[60:63], v[40:43]
    v_mfma_f32_16x16x32_bf16 v[108:111], a[76:79], a[60:63], v[108:111]
    v_mfma_f32_16x16x32_bf16 v[44:47], a[224:227], a[64:67], v[44:47]
    v_mfma_f32_16x16x32_bf16 v[48:51], a[224:227], a[68:71], v[48:51]
    v_mfma_f32_16x16x32_bf16 v[52:55], a[224:227], a[72:75], v[52:55]
    s_waitcnt lgkmcnt(0)
    v_mfma_f32_16x16x32_bf16 v[40:43], a[88:91], a[12:15], v[40:43]
    s_add_u32 s8, s58, 102400
    buffer_load_dword v6, v7, s[12:15], s8 offen offset:0 sc1
    v_mfma_f32_16x16x32_bf16 v[108:111], a[28:31], a[12:15], v[108:111]
    v_mfma_f32_16x16x32_bf16 v[44:47], a[88:91], a[16:19], v[44:47]
    v_mfma_f32_16x16x32_bf16 v[48:51], a[88:91], a[20:23], v[48:51]
    v_mfma_f32_16x16x32_bf16 v[52:55], a[88:91], a[24:27], v[52:55]
    s_waitcnt vmcnt(13)
    s_barrier
    ds_read_b128 a[12:15], v32 offset:0
    ds_read_b128 a[28:31], v27 offset:45056
    ds_read_b128 a[16:19], v33 offset:0
    ds_read_b128 a[20:23], v34 offset:0
    ds_read_b128 a[24:27], v35 offset:0
    ds_read_b128 a[36:39], v32 offset:1024
    ds_read_b128 a[52:55], v27 offset:46080
    ds_read_b128 a[40:43], v33 offset:1024
    ds_read_b128 a[44:47], v34 offset:1024
    ds_read_b128 a[48:51], v35 offset:1024
    s_waitcnt lgkmcnt(9)
    v_mfma_f32_16x16x32_bf16 v[40:43], a[92:95], a[12:15], v[40:43]
    ds_read_b128 a[60:63], v32 offset:2048
    ds_read_b128 a[76:79], v27 offset:47104
    s_waitcnt lgkmcnt(10)
    v_mfma_f32_16x16x32_bf16 v[108:111], a[28:31], a[12:15], v[108:111]
    s_waitcnt lgkmcnt(9)
    v_mfma_f32_16x16x32_bf16 v[44:47], a[92:95], a[16:19], v[44:47]
    ds_read_b128 a[64:67], v33 offset:2048
    ds_read_b128 a[68:71], v34 offset:2048
    s_waitcnt lgkmcnt(10)
    v_mfma_f32_16x16x32_bf16 v[48:51], a[92:95], a[20:23], v[48:51]
    ds_read_b128 a[72:75], v35 offset:2048
    s_waitcnt lgkmcnt(10)
    v_mfma_f32_16x16x32_bf16 v[52:55], a[92:95], a[24:27], v[52:55]
    s_waitcnt lgkmcnt(5)
    v_mfma_f32_16x16x32_bf16 v[40:43], a[96:99], a[36:39], v[40:43]
    s_waitcnt vmcnt(10)
    s_nop 0
    ds_read_b128 a[12:15], v32 offset:3072
    ds_read_b128 a[28:31], v27 offset:48128
    v_mfma_f32_16x16x32_bf16 v[108:111], a[52:55], a[36:39], v[108:111]
    v_mfma_f32_16x16x32_bf16 v[44:47], a[96:99], a[40:43], v[44:47]
    ds_read_b128 a[16:19], v33 offset:3072
    ds_read_b128 a[20:23], v34 offset:3072
    v_mfma_f32_16x16x32_bf16 v[48:51], a[96:99], a[44:47], v[48:51]
    ds_read_b128 a[24:27], v35 offset:3072
    v_mfma_f32_16x16x32_bf16 v[52:55], a[96:99], a[48:51], v[52:55]
    s_add_u32 m0, s61, 151552
    s_add_u32 s56, s17, 5230592
    buffer_load_dwordx4 v3, s[12:15], s56 offen sc1 lds
    v_add_u32 v32, 16384, v28
    v_add_u32 v33, 16384, v29
    v_add_u32 v34, 16384, v30
    v_add_u32 v35, 16384, v31
    s_waitcnt lgkmcnt(5)
    s_nop 0
    v_mfma_f32_16x16x32_bf16 v[40:43], a[100:103], a[60:63], v[40:43]
    ds_read_b128 a[36:39], v32 offset:49152
    ds_read_b128 a[52:55], v27 offset:40960
    v_mfma_f32_16x16x32_bf16 v[108:111], a[76:79], a[60:63], v[108:111]
    s_add_u32 s29, s16, 5148672
    buffer_load_dwordx4 a[88:91], v3, s[12:15], s29 offen offset:0 sc1
    v_mfma_f32_16x16x32_bf16 v[44:47], a[100:103], a[64:67], v[44:47]
    ds_read_b128 a[40:43], v33 offset:49152
    ds_read_b128 a[44:47], v34 offset:49152
    v_mfma_f32_16x16x32_bf16 v[48:51], a[100:103], a[68:71], v[48:51]
    ds_read_b128 a[48:51], v35 offset:49152
    v_mfma_f32_16x16x32_bf16 v[52:55], a[100:103], a[72:75], v[52:55]
    s_waitcnt lgkmcnt(5)
    v_mfma_f32_16x16x32_bf16 v[40:43], a[104:107], a[12:15], v[40:43]
    ds_read_b128 a[60:63], v32 offset:50176
    ds_read_b128 a[76:79], v27 offset:41984
    v_mfma_f32_16x16x32_bf16 v[108:111], a[28:31], a[12:15], v[108:111]
    s_barrier
    s_add_u32 s69, s21, 20480
    s_mov_b64 exec, 1
    buffer_store_dword v23, v24, s[12:15], s69 offen sc1
    s_mov_b64 exec, -1
    buffer_load_dwordx4 a[92:95], v3, s[12:15], s29 offen offset:1024 sc1
    v_mfma_f32_16x16x32_bf16 v[44:47], a[104:107], a[16:19], v[44:47]
    ds_read_b128 a[64:67], v33 offset:50176
    ds_read_b128 a[68:71], v34 offset:50176
    v_mfma_f32_16x16x32_bf16 v[48:51], a[104:107], a[20:23], v[48:51]
    ds_read_b128 a[72:75], v35 offset:50176
    v_mfma_f32_16x16x32_bf16 v[52:55], a[104:107], a[24:27], v[52:55]
    buffer_load_dwordx4 a[96:99], v3, s[12:15], s29 offen offset:2048 sc1
    s_waitcnt lgkmcnt(5)
    s_nop 0
    v_mfma_f32_16x16x32_bf16 v[40:43], a[140:143], a[36:39], v[40:43]
    ds_read_b128 a[12:15], v32 offset:51200
    ds_read_b128 a[28:31], v27 offset:43008
    v_mfma_f32_16x16x32_bf16 v[108:111], a[52:55], a[36:39], v[108:111]
    buffer_load_dwordx4 a[100:103], v3, s[12:15], s29 offen offset:3072 sc1
    v_mfma_f32_16x16x32_bf16 v[44:47], a[140:143], a[40:43], v[44:47]
    ds_read_b128 a[16:19], v33 offset:51200
    ds_read_b128 a[20:23], v34 offset:51200
    v_mfma_f32_16x16x32_bf16 v[48:51], a[140:143], a[44:47], v[48:51]
    ds_read_b128 a[24:27], v35 offset:51200
    v_mfma_f32_16x16x32_bf16 v[52:55], a[140:143], a[48:51], v[52:55]
    s_waitcnt lgkmcnt(5)
    s_nop 0
    v_mfma_f32_16x16x32_bf16 v[40:43], a[148:151], a[60:63], v[40:43]
    ds_read_b128 a[36:39], v32 offset:52224
    ds_read_b128 a[52:55], v27 offset:44032
    v_mfma_f32_16x16x32_bf16 v[108:111], a[76:79], a[60:63], v[108:111]
    s_add_u32 m0, s61, 147456
    s_add_u32 s56, s17, 5234688
    buffer_load_dwordx4 v3, s[12:15], s56 offen sc1 lds
    v_mfma_f32_16x16x32_bf16 v[44:47], a[148:151], a[64:67], v[44:47]
    ds_read_b128 a[40:43], v33 offset:52224
    ds_read_b128 a[44:47], v34 offset:52224
    v_mfma_f32_16x16x32_bf16 v[48:51], a[148:151], a[68:71], v[48:51]
    ds_read_b128 a[48:51], v35 offset:52224
    v_mfma_f32_16x16x32_bf16 v[52:55], a[148:151], a[72:75], v[52:55]
    s_waitcnt vmcnt(12)
    s_waitcnt lgkmcnt(0)
    s_barrier
    s_nop 0
    v_mfma_f32_16x16x32_bf16 v[40:43], a[152:155], a[12:15], v[40:43]
    ds_read_b128 a[60:63], v32 offset:0
    ds_read_b128 a[76:79], v27 offset:36864
    v_mfma_f32_16x16x32_bf16 v[108:111], a[28:31], a[12:15], v[108:111]
    s_add_u32 s18, s16, 5152768
    buffer_load_dwordx4 a[104:107], v3, s[12:15], s18 offen offset:0 sc1
    v_mfma_f32_16x16x32_bf16 v[44:47], a[152:155], a[16:19], v[44:47]
    ds_read_b128 a[64:67], v33 offset:0
    ds_read_b128 a[68:71], v34 offset:0
    v_mfma_f32_16x16x32_bf16 v[48:51], a[152:155], a[20:23], v[48:51]
    ds_read_b128 a[72:75], v35 offset:0
    v_mfma_f32_16x16x32_bf16 v[52:55], a[152:155], a[24:27], v[52:55]
    buffer_load_dwordx4 a[128:131], v3, s[12:15], s18 offen offset:1024 sc1
    v_mfma_f32_16x16x32_bf16 v[40:43], a[156:159], a[36:39], v[40:43]
    ds_read_b128 a[12:15], v32 offset:1024
    ds_read_b128 a[28:31], v27 offset:37888
    v_mfma_f32_16x16x32_bf16 v[108:111], a[52:55], a[36:39], v[108:111]
    buffer_load_dwordx4 a[132:135], v3, s[12:15], s18 offen offset:2048 sc1
    v_mfma_f32_16x16x32_bf16 v[44:47], a[156:159], a[40:43], v[44:47]
    ds_read_b128 a[16:19], v33 offset:1024
    ds_read_b128 a[20:23], v34 offset:1024
    v_mfma_f32_16x16x32_bf16 v[48:51], a[156:159], a[44:47], v[48:51]
    ds_read_b128 a[24:27], v35 offset:1024
    v_mfma_f32_16x16x32_bf16 v[52:55], a[156:159], a[48:51], v[52:55]
    s_waitcnt vmcnt(10)
    v_cmp_ne_u32 vcc, s47, v6
    s_nop 0
    s_cbranch_vccnz Lslow28
Lback29:
    s_waitcnt lgkmcnt(5)
    s_nop 0
    v_mfma_f32_16x16x32_bf16 v[40:43], a[108:111], a[60:63], v[40:43]
    ds_read_b128 a[36:39], v32 offset:2048
    ds_read_b128 a[52:55], v27 offset:38912
    v_mfma_f32_16x16x32_bf16 v[108:111], a[76:79], a[60:63], v[108:111]
    v_mfma_f32_16x16x32_bf16 v[44:47], a[108:111], a[64:67], v[44:47]
    ds_read_b128 a[40:43], v33 offset:2048
    ds_read_b128 a[44:47], v34 offset:2048
    v_mfma_f32_16x16x32_bf16 v[48:51], a[108:111], a[68:71], v[48:51]
    ds_read_b128 a[48:51], v35 offset:2048
    v_mfma_f32_16x16x32_bf16 v[52:55], a[108:111], a[72:75], v[52:55]
    s_add_u32 m0, s62, 0
    s_add_u32 s57, s20, 17793024
    buffer_load_dwordx4 v3, s[12:15], s57 offen offset:0 sc1 lds
    s_waitcnt lgkmcnt(5)
    v_mfma_f32_16x16x32_bf16 v[40:43], a[160:163], a[12:15], v[40:43]
    ds_read_b128 a[60:63], v32 offset:3072
    ds_read_b128 a[76:79], v27 offset:39936
    v_mfma_f32_16x16x32_bf16 v[108:111], a[28:31], a[12:15], v[108:111]
    v_mfma_f32_16x16x32_bf16 v[44:47], a[160:163], a[16:19], v[44:47]
    ds_read_b128 a[64:67], v33 offset:3072
    ds_read_b128 a[68:71], v34 offset:3072
    v_mfma_f32_16x16x32_bf16 v[48:51], a[160:163], a[20:23], v[48:51]
    ds_read_b128 a[72:75], v35 offset:3072
    v_mfma_f32_16x16x32_bf16 v[52:55], a[160:163], a[24:27], v[52:55]
    buffer_load_dwordx4 v3, s[12:15], s57 offen offset:1024 sc1 lds
    s_waitcnt lgkmcnt(0)
    s_barrier
    v_mfma_f32_16x16x32_bf16 v[40:43], a[164:167], a[36:39], v[40:43]
    ds_read_b128 a[12:15], v32 offset:16384
    ds_read_b128 a[28:31], v27 offset:32768
    v_mfma_f32_16x16x32_bf16 v[108:111], a[52:55], a[36:39], v[108:111]
    buffer_load_dwordx4 v3, s[12:15], s57 offen offset:2048 sc1 lds
    v_mfma_f32_16x16x32_bf16 v[44:47], a[164:167], a[40:43], v[44:47]
    ds_read_b128 a[16:19], v33 offset:16384
    ds_read_b128 a[20:23], v34 offset:16384
    v_mfma_f32_16x16x32_bf16 v[48:51], a[164:167], a[44:47], v[48:51]
    ds_read_b128 a[24:27], v35 offset:16384
    v_mfma_f32_16x16x32_bf16 v[52:55], a[164:167], a[48:51], v[52:55]
    buffer_load_dwordx4 v3, s[12:15], s57 offen offset:3072 sc1 lds
    v_mfma_f32_16x16x32_bf16 v[40:43], a[168:171], a[60:63], v[40:43]
    ds_read_b128 a[36:39], v32 offset:17408
    ds_read_b128 a[52:55], v27 offset:33792
    v_mfma_f32_16x16x32_bf16 v[108:111], a[76:79], a[60:63], v[108:111]
    s_add_u32 m0, s62, 16384
    s_add_u32 s57, s20, 17797120
    buffer_load_dwordx4 v3, s[12:15], s57 offen offset:0 sc1 lds
    v_mfma_f32_16x16x32_bf16 v[44:47], a[168:171], a[64:67], v[44:47]
    ds_read_b128 a[40:43], v33 offset:17408
    ds_read_b128 a[44:47], v34 offset:17408
    v_mfma_f32_16x16x32_bf16 v[48:51], a[168:171], a[68:71], v[48:51]
    ds_read_b128 a[48:51], v35 offset:17408
    v_mfma_f32_16x16x32_bf16 v[52:55], a[168:171], a[72:75], v[52:55]
    s_waitcnt lgkmcnt(5)
    s_nop 0
    v_mfma_f32_16x16x32_bf16 v[40:43], a[172:175], a[12:15], v[40:43]
    ds_read_b128 a[60:63], v32 offset:18432
    ds_read_b128 a[76:79], v27 offset:34816
    v_mfma_f32_16x16x32_bf16 v[108:111], a[28:31], a[12:15], v[108:111]
    buffer_load_dwordx4 v3, s[12:15], s57 offen offset:1024 sc1 lds
    v_mfma_f32_16x16x32_bf16 v[44:47], a[172:175], a[16:19], v[44:47]
    ds_read_b128 a[64:67], v33 offset:18432
    ds_read_b128 a[68:71], v34 offset:18432
    v_mfma_f32_16x16x32_bf16 v[48:51], a[172:175], a[20:23], v[48:51]
    ds_read_b128 a[72:75], v35 offset:18432
    v_mfma_f32_16x16x32_bf16 v[52:55], a[172:175], a[24:27], v[52:55]
    buffer_load_dwordx4 v3, s[12:15], s57 offen offset:2048 sc1 lds
    s_waitcnt lgkmcnt(5)
    s_nop 0
    v_mfma_f32_16x16x32_bf16 v[40:43], v[236:239], a[36:39], v[40:43]
    ds_read_b128 a[12:15], v32 offset:19456
    ds_read_b128 a[28:31], v27 offset:35840
    v_mfma_f32_16x16x32_bf16 v[108:111], a[52:55], a[36:39], v[108:111]
    v_mfma_f32_16x16x32_bf16 v[44:47], v[236:239], a[40:43], v[44:47]
    ds_read_b128 a[16:19], v33 offset:19456
    ds_read_b128 a[20:23], v34 offset:19456
    v_mfma_f32_16x16x32_bf16 v[48:51], v[236:239], a[44:47], v[48:51]
    ds_read_b128 a[24:27], v35 offset:19456
    v_mfma_f32_16x16x32_bf16 v[52:55], v[236:239], a[48:51], v[52:55]
    buffer_load_dwordx4 v3, s[12:15], s57 offen offset:3072 sc1 lds
    s_waitcnt lgkmcnt(5)
    v_mfma_f32_16x16x32_bf16 v[40:43], a[176:179], a[60:63], v[40:43]
    v_mfma_f32_16x16x32_bf16 v[108:111], a[76:79], a[60:63], v[108:111]
    v_mfma_f32_16x16x32_bf16 v[44:47], a[176:179], a[64:67], v[44:47]
    v_mfma_f32_16x16x32_bf16 v[48:51], a[176:179], a[68:71], v[48:51]
    v_mfma_f32_16x16x32_bf16 v[52:55], a[176:179], a[72:75], v[52:55]
    s_waitcnt lgkmcnt(0)
    v_mfma_f32_16x16x32_bf16 v[40:43], a[228:231], a[12:15], v[40:43]
    v_mfma_f32_16x16x32_bf16 v[108:111], a[28:31], a[12:15], v[108:111]
    s_add_u32 m0, s62, 49152
    s_add_u32 s57, s20, 17801216
    buffer_load_dwordx4 v3, s[12:15], s57 offen offset:0 sc1 lds
    v_mfma_f32_16x16x32_bf16 v[44:47], a[228:231], a[16:19], v[44:47]
    v_mfma_f32_16x16x32_bf16 v[48:51], a[228:231], a[20:23], v[48:51]
    v_mfma_f32_16x16x32_bf16 v[52:55], a[228:231], a[24:27], v[52:55]
    buffer_load_dwordx4 v3, s[12:15], s57 offen offset:1024 sc1 lds
    buffer_load_dwordx4 v3, s[12:15], s57 offen offset:2048 sc1 lds
    buffer_load_dwordx4 v3, s[12:15], s57 offen offset:3072 sc1 lds
    s_add_u32 m0, s62, 65536
    s_add_u32 s57, s20, 17805312
    buffer_load_dwordx4 v3, s[12:15], s57 offen offset:0 sc1 lds
    buffer_load_dwordx4 v3, s[12:15], s57 offen offset:1024 sc1 lds
    buffer_load_dwordx4 v3, s[12:15], s57 offen offset:2048 sc1 lds
    s_waitcnt vmcnt(11)
    s_barrier
    v_add_u32 v32, 0, v28
    v_add_u32 v33, 0, v29
    v_add_u32 v34, 0, v30
    v_add_u32 v35, 0, v31
    ds_read_b128 a[12:15], v32 offset:0
    ds_read_b128 a[28:31], v27 offset:28672
    ds_read_b128 a[16:19], v33 offset:0
    ds_read_b128 a[20:23], v34 offset:0
    ds_read_b128 a[24:27], v35 offset:0
    ds_read_b128 a[36:39], v32 offset:1024
    ds_read_b128 a[52:55], v27 offset:29696
    ds_read_b128 a[40:43], v33 offset:1024
    ds_read_b128 a[44:47], v34 offset:1024
    ds_read_b128 a[48:51], v35 offset:1024
    s_waitcnt lgkmcnt(9)
    v_mfma_f32_16x16x32_bf16 v[40:43], a[180:183], a[12:15], v[40:43]
    ds_read_b128 a[60:63], v32 offset:2048
    ds_read_b128 a[76:79], v27 offset:30720
    s_waitcnt lgkmcnt(10)
    v_mfma_f32_16x16x32_bf16 v[108:111], a[28:31], a[12:15], v[108:111]
    s_waitcnt lgkmcnt(9)
    v_mfma_f32_16x16x32_bf16 v[44:47], a[180:183], a[16:19], v[44:47]
    ds_read_b128 a[64:67], v33 offset:2048
    ds_read_b128 a[68:71], v34 offset:2048
    s_waitcnt lgkmcnt(10)
    v_mfma_f32_16x16x32_bf16 v[48:51], a[180:183], a[20:23], v[48:51]
    ds_read_b128 a[72:75], v35 offset:2048
    s_waitcnt lgkmcnt(10)
    v_mfma_f32_16x16x32_bf16 v[52:55], a[180:183], a[24:27], v[52:55]
    s_waitcnt lgkmcnt(5)
    v_mfma_f32_16x16x32_bf16 v[40:43], a[232:235], a[36:39], v[40:43]
    ds_read_b128 a[12:15], v32 offset:3072
    ds_read_b128 a[28:31], v27 offset:31744
    v_mfma_f32_16x16x32_bf16 v[108:111], a[52:55], a[36:39], v[108:111]
    buffer_load_dwordx4 v3, s[12:15], s57 offen offset:3072 sc1 lds
    v_mfma_f32_16x16x32_bf16 v[44:47], a[232:235], a[40:43], v[44:47]
    ds_read_b128 a[16:19], v33 offset:3072
    ds_read_b128 a[20:23], v34 offset:3072
    v_mfma_f32_16x16x32_bf16 v[48:51], a[232:235], a[44:47], v[48:51]
    ds_read_b128 a[24:27], v35 offset:3072
    v_mfma_f32_16x16x32_bf16 v[52:55], a[232:235], a[48:51], v[52:55]
    buffer_load_dwordx4 a[108:111], v3, s[12:15], s18 offen offset:3072 sc1
    s_waitcnt vmcnt(9)
    s_waitcnt lgkmcnt(0)
    s_barrier
    s_nop 0
    v_mfma_f32_16x16x32_bf16 v[40:43], a[236:239], a[60:63], v[40:43]
    ds_read_b128 a[36:39], v32 offset:16384
    ds_read_b128 a[52:55], v27 offset:24576
    v_mfma_f32_16x16x32_bf16 v[108:111], a[76:79], a[60:63], v[108:111]
    s_add_u32 m0, s61, 143360
    s_add_u32 s56, s17, 5238784
    buffer_load_dwordx4 v3, s[12:15], s56 offen sc1 lds
    v_mfma_f32_16x16x32_bf16 v[44:47], a[236:239], a[64:67], v[44:47]
    ds_read_b128 a[40:43], v33 offset:16384
    ds_read_b128 a[44:47], v34 offset:16384
    v_mfma_f32_16x16x32_bf16 v[48:51], a[236:239], a[68:71], v[48:51]
    ds_read_b128 a[48:51], v35 offset:16384
    v_mfma_f32_16x16x32_bf16 v[52:55], a[236:239], a[72:75], v[52:55]
    s_add_u32 s29, s16, 5156864
    buffer_load_dwordx4 a[136:139], v3, s[12:15], s29 offen offset:0 sc1
    v_mfma_f32_16x16x32_bf16 v[40:43], a[184:187], a[12:15], v[40:43]
    ds_read_b128 a[60:63], v32 offset:17408
    ds_read_b128 a[76:79], v27 offset:25600
    v_mfma_f32_16x16x32_bf16 v[108:111], a[28:31], a[12:15], v[108:111]
    buffer_load_dwordx4 a[140:143], v3, s[12:15], s29 offen offset:1024 sc1
    v_mfma_f32_16x16x32_bf16 v[44:47], a[184:187], a[16:19], v[44:47]
    ds_read_b128 a[64:67], v33 offset:17408
    ds_read_b128 a[68:71], v34 offset:17408
    v_mfma_f32_16x16x32_bf16 v[48:51], a[184:187], a[20:23], v[48:51]
    ds_read_b128 a[72:75], v35 offset:17408
    v_mfma_f32_16x16x32_bf16 v[52:55], a[184:187], a[24:27], v[52:55]
    s_waitcnt lgkmcnt(5)
    s_nop 0
    v_mfma_f32_16x16x32_bf16 v[40:43], a[240:243], a[36:39], v[40:43]
    ds_read_b128 a[12:15], v32 offset:18432
    ds_read_b128 a[28:31], v27 offset:26624
    v_mfma_f32_16x16x32_bf16 v[108:111], a[52:55], a[36:39], v[108:111]
    buffer_load_dwordx4 a[144:147], v3, s[12:15], s29 offen offset:2048 sc1
    v_mfma_f32_16x16x32_bf16 v[44:47], a[240:243], a[40:43], v[44:47]
    ds_read_b128 a[16:19], v33 offset:18432
    ds_read_b128 a[20:23], v34 offset:18432
    v_mfma_f32_16x16x32_bf16 v[48:51], a[240:243], a[44:47], v[48:51]
    ds_read_b128 a[24:27], v35 offset:18432
    v_mfma_f32_16x16x32_bf16 v[52:55], a[240:243], a[48:51], v[52:55]
    buffer_load_dwordx4 a[148:151], v3, s[12:15], s29 offen offset:3072 sc1
    s_waitcnt lgkmcnt(5)
    s_nop 0
    v_mfma_f32_16x16x32_bf16 v[40:43], a[84:87], a[60:63], v[40:43]
    ds_read_b128 a[36:39], v32 offset:19456
    ds_read_b128 a[52:55], v27 offset:27648
    v_mfma_f32_16x16x32_bf16 v[108:111], a[76:79], a[60:63], v[108:111]
    v_mfma_f32_16x16x32_bf16 v[44:47], a[84:87], a[64:67], v[44:47]
    s_add_u32 s8, s58, 20480
    buffer_load_dword v6, v7, s[12:15], s8 offen offset:0 sc1
    ds_read_b128 a[40:43], v33 offset:19456
    ds_read_b128 a[44:47], v34 offset:19456
    v_mfma_f32_16x16x32_bf16 v[48:51], a[84:87], a[68:71], v[48:51]
    ds_read_b128 a[48:51], v35 offset:19456
    v_mfma_f32_16x16x32_bf16 v[52:55], a[84:87], a[72:75], v[52:55]
    s_add_u32 m0, s61, 139264
    s_add_u32 s56, s17, 5242880
    buffer_load_dwordx4 v3, s[12:15], s56 offen sc1 lds
    s_waitcnt vmcnt(12)
    s_waitcnt lgkmcnt(0)
    s_barrier
    s_nop 0
    v_mfma_f32_16x16x32_bf16 v[40:43], a[244:247], a[12:15], v[40:43]
    ds_read_b128 a[60:63], v32 offset:49152
    ds_read_b128 a[76:79], v27 offset:20480
    v_mfma_f32_16x16x32_bf16 v[108:111], a[28:31], a[12:15], v[108:111]
    s_add_u32 s18, s16, 5160960
    buffer_load_dwordx4 a[84:87], v3, s[12:15], s18 offen offset:0 sc1
    v_mfma_f32_16x16x32_bf16 v[44:47], a[244:247], a[16:19], v[44:47]
    ds_read_b128 a[64:67], v33 offset:49152
    ds_read_b128 a[68:71], v34 offset:49152
    v_mfma_f32_16x16x32_bf16 v[48:51], a[244:247], a[20:23], v[48:51]
    ds_read_b128 a[72:75], v35 offset:49152
    v_mfma_f32_16x16x32_bf16 v[52:55], a[244:247], a[24:27], v[52:55]
    buffer_load_dwordx4 a[152:155], v3, s[12:15], s18 offen offset:1024 sc1
    v_mfma_f32_16x16x32_bf16 v[40:43], a[248:251], a[36:39], v[40:43]
    ds_read_b128 a[12:15], v32 offset:50176
    ds_read_b128 a[28:31], v27 offset:21504
    v_mfma_f32_16x16x32_bf16 v[108:111], a[52:55], a[36:39], v[108:111]
    buffer_load_dwordx4 a[156:159], v3, s[12:15], s18 offen offset:2048 sc1
    v_mfma_f32_16x16x32_bf16 v[44:47], a[248:251], a[40:43], v[44:47]
    ds_read_b128 a[16:19], v33 offset:50176
    ds_read_b128 a[20:23], v34 offset:50176
    v_mfma_f32_16x16x32_bf16 v[48:51], a[248:251], a[44:47], v[48:51]
    ds_read_b128 a[24:27], v35 offset:50176
    v_mfma_f32_16x16x32_bf16 v[52:55], a[248:251], a[48:51], v[52:55]
    s_waitcnt lgkmcnt(5)
    s_nop 0
    v_mfma_f32_16x16x32_bf16 v[40:43], a[112:115], a[60:63], v[40:43]
    ds_read_b128 a[36:39], v32 offset:51200
    ds_read_b128 a[52:55], v27 offset:22528
    v_mfma_f32_16x16x32_bf16 v[108:111], a[76:79], a[60:63], v[108:111]
    v_mfma_f32_16x16x32_bf16 v[44:47], a[112:115], a[64:67], v[44:47]
    ds_read_b128 a[40:43], v33 offset:51200
    ds_read_b128 a[44:47], v34 offset:51200
    v_mfma_f32_16x16x32_bf16 v[48:51], a[112:115], a[68:71], v[48:51]
    ds_read_b128 a[48:51], v35 offset:51200
    v_mfma_f32_16x16x32_bf16 v[52:55], a[112:115], a[72:75], v[52:55]
    buffer_load_dwordx4 a[160:163], v3, s[12:15], s18 offen offset:3072 sc1
    s_waitcnt lgkmcnt(5)
    s_nop 0
    v_mfma_f32_16x16x32_bf16 v[40:43], a[116:119], a[12:15], v[40:43]
    ds_read_b128 a[60:63], v32 offset:52224
    ds_read_b128 a[76:79], v27 offset:23552
    v_mfma_f32_16x16x32_bf16 v[108:111], a[28:31], a[12:15], v[108:111]
    v_mfma_f32_16x16x32_bf16 v[44:47], a[116:119], a[16:19], v[44:47]
    ds_read_b128 a[64:67], v33 offset:52224
    ds_read_b128 a[68:71], v34 offset:52224
    v_mfma_f32_16x16x32_bf16 v[48:51], a[116:119], a[20:23], v[48:51]
    ds_read_b128 a[72:75], v35 offset:52224
    v_mfma_f32_16x16x32_bf16 v[52:55], a[116:119], a[24:27], v[52:55]
    s_waitcnt vmcnt(12)
    s_waitcnt lgkmcnt(0)
    s_barrier
    s_nop 0
    v_add_u32 v32, 65536, v28
    v_add_u32 v33, 65536, v29
    v_add_u32 v34, 65536, v30
    v_add_u32 v35, 65536, v31
    v_mfma_f32_16x16x32_bf16 v[40:43], a[188:191], a[36:39], v[40:43]
    ds_read_b128 a[12:15], v32 offset:0
    ds_read_b128 a[28:31], v27 offset:16384
    v_mfma_f32_16x16x32_bf16 v[108:111], a[52:55], a[36:39], v[108:111]
    v_mfma_f32_16x16x32_bf16 v[44:47], a[188:191], a[40:43], v[44:47]
    ds_read_b128 a[16:19], v33 offset:0
    ds_read_b128 a[20:23], v34 offset:0
    v_mfma_f32_16x16x32_bf16 v[48:51], a[188:191], a[44:47], v[48:51]
    ds_read_b128 a[24:27], v35 offset:0
    v_mfma_f32_16x16x32_bf16 v[52:55], a[188:191], a[48:51], v[52:55]
    v_mfma_f32_16x16x32_bf16 v[40:43], a[192:195], a[60:63], v[40:43]
    ds_read_b128 a[36:39], v32 offset:1024
    ds_read_b128 a[52:55], v27 offset:17408
    v_mfma_f32_16x16x32_bf16 v[108:111], a[76:79], a[60:63], v[108:111]
    v_mfma_f32_16x16x32_bf16 v[44:47], a[192:195], a[64:67], v[44:47]
    s_waitcnt vmcnt(5)
    v_cmp_ne_u32 vcc, s47, v6
    s_nop 0
    s_cbranch_vccnz Lslow31
Lback32:
    ds_read_b128 a[40:43], v33 offset:1024
    ds_read_b128 a[44:47], v34 offset:1024
    v_mfma_f32_16x16x32_bf16 v[48:51], a[192:195], a[68:71], v[48:51]
    ds_read_b128 a[48:51], v35 offset:1024
    v_mfma_f32_16x16x32_bf16 v[52:55], a[192:195], a[72:75], v[52:55]
    s_add_u32 m0, s62, 0
    s_add_u32 s57, s19, 15138816
    buffer_load_dwordx4 v3, s[12:15], s57 offen offset:0 sc1 lds
    s_waitcnt lgkmcnt(5)
    v_mfma_f32_16x16x32_bf16 v[40:43], a[4:7], a[12:15], v[40:43]
    ds_read_b128 a[60:63], v32 offset:2048
    ds_read_b128 a[76:79], v27 offset:18432
    v_mfma_f32_16x16x32_bf16 v[108:111], a[28:31], a[12:15], v[108:111]
    buffer_load_dwordx4 v3, s[12:15], s57 offen offset:1024 sc1 lds
    v_mfma_f32_16x16x32_bf16 v[44:47], a[4:7], a[16:19], v[44:47]
    ds_read_b128 a[64:67], v33 offset:2048
    ds_read_b128 a[68:71], v34 offset:2048
    v_mfma_f32_16x16x32_bf16 v[48:51], a[4:7], a[20:23], v[48:51]
    ds_read_b128 a[72:75], v35 offset:2048
    v_mfma_f32_16x16x32_bf16 v[52:55], a[4:7], a[24:27], v[52:55]
    buffer_load_dwordx4 v3, s[12:15], s57 offen offset:2048 sc1 lds
    s_waitcnt lgkmcnt(5)
    s_nop 0
    v_mfma_f32_16x16x32_bf16 v[40:43], a[8:11], a[36:39], v[40:43]
    ds_read_b128 a[12:15], v32 offset:3072
    ds_read_b128 a[28:31], v27 offset:19456
    v_mfma_f32_16x16x32_bf16 v[108:111], a[52:55], a[36:39], v[108:111]
    buffer_load_dwordx4 v3, s[12:15], s57 offen offset:3072 sc1 lds
    v_mfma_f32_16x16x32_bf16 v[44:47], a[8:11], a[40:43], v[44:47]
    ds_read_b128 a[16:19], v33 offset:3072
    ds_read_b128 a[20:23], v34 offset:3072
    v_mfma_f32_16x16x32_bf16 v[48:51], a[8:11], a[44:47], v[48:51]
    ds_read_b128 a[24:27], v35 offset:3072
    v_mfma_f32_16x16x32_bf16 v[52:55], a[8:11], a[48:51], v[52:55]
    s_add_u32 m0, s62, 16384
    s_add_u32 s57, s19, 15142912
    buffer_load_dwordx4 v3, s[12:15], s57 offen offset:0 sc1 lds
    s_waitcnt lgkmcnt(5)
    s_nop 0
    v_mfma_f32_16x16x32_bf16 v[40:43], a[120:123], a[60:63], v[40:43]
    v_mfma_f32_16x16x32_bf16 v[108:111], a[76:79], a[60:63], v[108:111]
    buffer_load_dwordx4 v3, s[12:15], s57 offen offset:1024 sc1 lds
    v_mfma_f32_16x16x32_bf16 v[44:47], a[120:123], a[64:67], v[44:47]
    v_mfma_f32_16x16x32_bf16 v[48:51], a[120:123], a[68:71], v[48:51]
    v_mfma_f32_16x16x32_bf16 v[52:55], a[120:123], a[72:75], v[52:55]
    buffer_load_dwordx4 v3, s[12:15], s57 offen offset:2048 sc1 lds
    s_waitcnt lgkmcnt(0)
    s_nop 0
    v_mfma_f32_16x16x32_bf16 v[40:43], a[196:199], a[12:15], v[40:43]
    v_mfma_f32_16x16x32_bf16 v[108:111], a[28:31], a[12:15], v[108:111]
    buffer_load_dwordx4 v3, s[12:15], s57 offen offset:3072 sc1 lds
    v_mfma_f32_16x16x32_bf16 v[44:47], a[196:199], a[16:19], v[44:47]
    v_mfma_f32_16x16x32_bf16 v[48:51], a[196:199], a[20:23], v[48:51]
    v_mfma_f32_16x16x32_bf16 v[52:55], a[196:199], a[24:27], v[52:55]
    s_add_u32 m0, s62, 32768
    s_add_u32 s57, s19, 15147008
    buffer_load_dwordx4 v3, s[12:15], s57 offen offset:0 sc1 lds
    v_lshlrev_b32 v68, 16, v76
    v_and_b32 v69, 0xffff0000, v76
    v_lshlrev_b32 v70, 16, v77
    v_and_b32 v71, 0xffff0000, v77
    v_lshlrev_b32 v72, 16, v78
    v_and_b32 v73, 0xffff0000, v78
    v_lshlrev_b32 v74, 16, v79
    v_and_b32 v75, 0xffff0000, v79
    v_lshlrev_b32 v80, 16, v84
    v_and_b32 v81, 0xffff0000, v84
    v_lshlrev_b32 v82, 16, v85
    v_and_b32 v83, 0xffff0000, v85
    v_lshlrev_b32 v92, 16, v86
    v_and_b32 v93, 0xffff0000, v86
    v_lshlrev_b32 v94, 16, v87
    v_and_b32 v95, 0xffff0000, v87
    v_lshlrev_b32 v96, 16, v88
    v_and_b32 v97, 0xffff0000, v88
    v_lshlrev_b32 v98, 16, v89
    v_and_b32 v99, 0xffff0000, v89
    s_mov_b32 s4, s36
    s_mov_b32 s5, s37
    s_mov_b32 s6, 2621440
    s_mov_b32 s7, 0x20000
    v_add_u32 v100, 0, v2
    v_mul_u32_u24 v101, 6554, v100
    v_lshrrev_b32 v101, 16, v101
    v_mul_u32_u24 v107, 10, v101
    v_sub_u32 v100, v100, v107
    v_mul_u32_u24 v101, 1280, v101
    v_lshl_add_u32 v107, v100, 4, v101
    v_add_u32 v100, 64, v2
    v_mul_u32_u24 v101, 6554, v100
    v_lshrrev_b32 v101, 16, v101
    v_mul_u32_u24 v124, 10, v101
    v_sub_u32 v100, v100, v124
    v_mul_u32_u24 v101, 1280, v101
    v_lshl_add_u32 v124, v100, 4, v101
    v_add_u32 v100, 128, v2
    v_mul_u32_u24 v101, 6554, v100
    v_lshrrev_b32 v101, 16, v101
    v_mul_u32_u24 v125, 10, v101
    v_sub_u32_e64 v100, v100, v125
    v_mul_u32_u24 v101, 1280, v101
    v_lshl_add_u32 v125, v100, 4, v101
    s_lshl_b32 s8, s59, 4
    s_mul_i32 s8, s8, 1280
    s_mul_i32 s10, s43, 160
    s_add_u32 s8, s8, s10
    s_lshl_b32 s9, s3, 5
    s_add_u32 s9, s9, 92160
    v_lshl_add_u32 v104, v5, 3, s9
    v_lshlrev_b32 v105, 3, v5
    v_add_u32 v105, 92288, v105
    s_mul_i32 s9, s3, 2560
    s_add_u32 s9, s9, 92160
    v_add_u32_e64 v106, s9, v3
    v_mov_b32 v126, 160
    v_mad_u32_u24 v100, v36, v126, v104
    v_mad_u32_u24 v101, v37, v126, v104
    v_mad_u32_u24 v102, v38, v126, v104
    v_mad_u32_u24 v103, v39, v126, v104
    v_mad_u32_u24 v105, v36, v126, v105
    buffer_load_dwordx4 v3, s[12:15], s57 offen offset:1024 sc1 lds
    buffer_load_dwordx4 v3, s[12:15], s57 offen offset:2048 sc1 lds
    buffer_load_dwordx4 v3, s[12:15], s57 offen offset:3072 sc1 lds
    s_add_u32 m0, s62, 49152
    s_add_u32 s57, s19, 15151104
    buffer_load_dwordx4 v3, s[12:15], s57 offen offset:0 sc1 lds
    buffer_load_dwordx4 v3, s[12:15], s57 offen offset:1024 sc1 lds
    buffer_load_dwordx4 v3, s[12:15], s57 offen offset:2048 sc1 lds
    s_waitcnt vmcnt(11)
    s_barrier
    v_add_u32 v32, 0, v28
    v_add_u32 v33, 0, v29
    v_add_u32 v34, 0, v30
    v_add_u32 v35, 0, v31
    ds_read_b128 a[12:15], v32 offset:0
    ds_read_b128 a[28:31], v27 offset:12288
    ds_read_b128 a[16:19], v33 offset:0
    ds_read_b128 a[20:23], v34 offset:0
    ds_read_b128 a[24:27], v35 offset:0
    ds_read_b128 a[36:39], v32 offset:1024
    ds_read_b128 a[52:55], v27 offset:13312
    ds_read_b128 a[40:43], v33 offset:1024
    ds_read_b128 a[44:47], v34 offset:1024
    ds_read_b128 a[48:51], v35 offset:1024
    s_waitcnt lgkmcnt(9)
    v_mfma_f32_16x16x32_bf16 v[112:115], a[200:203], a[12:15], 0
    ds_read_b128 a[60:63], v32 offset:2048
    ds_read_b128 a[76:79], v27 offset:14336
    s_waitcnt lgkmcnt(10)
    v_mfma_f32_16x16x32_bf16 v[132:135], a[28:31], a[12:15], 0
    s_waitcnt lgkmcnt(9)
    v_mfma_f32_16x16x32_bf16 v[116:119], a[200:203], a[16:19], 0
    ds_read_b128 a[64:67], v33 offset:2048
    ds_read_b128 a[68:71], v34 offset:2048
    s_waitcnt lgkmcnt(10)
    v_mfma_f32_16x16x32_bf16 v[120:123], a[200:203], a[20:23], 0
    ds_read_b128 a[72:75], v35 offset:2048
    s_waitcnt lgkmcnt(10)
    v_mfma_f32_16x16x32_bf16 v[128:131], a[200:203], a[24:27], 0
    s_waitcnt lgkmcnt(5)
    v_mfma_f32_16x16x32_bf16 v[112:115], a[252:255], a[36:39], v[112:115]
    ds_read_b128 a[12:15], v32 offset:3072
    ds_read_b128 a[28:31], v27 offset:15360
    v_mfma_f32_16x16x32_bf16 v[132:135], a[52:55], a[36:39], v[132:135]
    buffer_load_dwordx4 v3, s[12:15], s57 offen offset:3072 sc1 lds
    v_mfma_f32_16x16x32_bf16 v[116:119], a[252:255], a[40:43], v[116:119]
    ds_read_b128 a[16:19], v33 offset:3072
    ds_read_b128 a[20:23], v34 offset:3072
    v_mfma_f32_16x16x32_bf16 v[120:123], a[252:255], a[44:47], v[120:123]
    ds_read_b128 a[24:27], v35 offset:3072
    v_mfma_f32_16x16x32_bf16 v[128:131], a[252:255], a[48:51], v[128:131]
    s_add_u32 m0, s62, 65536
    s_add_u32 s57, s19, 15155200
    buffer_load_dwordx4 v3, s[12:15], s57 offen offset:0 sc1 lds
    s_waitcnt vmcnt(9)
    s_waitcnt lgkmcnt(0)
    s_barrier
    s_nop 0
    v_mfma_f32_16x16x32_bf16 v[112:115], a[124:127], a[60:63], v[112:115]
    ds_read_b128 a[36:39], v32 offset:16384
    ds_read_b128 a[52:55], v27 offset:61440
    v_mfma_f32_16x16x32_bf16 v[132:135], a[76:79], a[60:63], v[132:135]
    buffer_load_dwordx4 v3, s[12:15], s57 offen offset:1024 sc1 lds
    v_mfma_f32_16x16x32_bf16 v[116:119], a[124:127], a[64:67], v[116:119]
    ds_read_b128 a[40:43], v33 offset:16384
    ds_read_b128 a[44:47], v34 offset:16384
    v_mfma_f32_16x16x32_bf16 v[120:123], a[124:127], a[68:71], v[120:123]
    ds_read_b128 a[48:51], v35 offset:16384
    v_mfma_f32_16x16x32_bf16 v[128:131], a[124:127], a[72:75], v[128:131]
    buffer_load_dwordx4 v3, s[12:15], s57 offen offset:2048 sc1 lds
    v_mfma_f32_16x16x32_bf16 v[112:115], a[204:207], a[12:15], v[112:115]
    ds_read_b128 a[60:63], v32 offset:17408
    ds_read_b128 a[76:79], v27 offset:62464
    v_mfma_f32_16x16x32_bf16 v[132:135], a[28:31], a[12:15], v[132:135]
    buffer_load_dwordx4 v3, s[12:15], s57 offen offset:3072 sc1 lds
    v_mfma_f32_16x16x32_bf16 v[116:119], a[204:207], a[16:19], v[116:119]
    ds_read_b128 a[64:67], v33 offset:17408
    ds_read_b128 a[68:71], v34 offset:17408
    v_mfma_f32_16x16x32_bf16 v[120:123], a[204:207], a[20:23], v[120:123]
    ds_read_b128 a[72:75], v35 offset:17408
    v_mfma_f32_16x16x32_bf16 v[128:131], a[204:207], a[24:27], v[128:131]
    s_waitcnt lgkmcnt(5)
    s_nop 0
    v_mfma_f32_16x16x32_bf16 v[112:115], a[88:91], a[36:39], v[112:115]
    ds_read_b128 a[12:15], v32 offset:18432
    ds_read_b128 a[28:31], v27 offset:63488
    v_mfma_f32_16x16x32_bf16 v[132:135], a[52:55], a[36:39], v[132:135]
    v_mfma_f32_16x16x32_bf16 v[116:119], a[88:91], a[40:43], v[116:119]
    ds_read_b128 a[16:19], v33 offset:18432
    ds_read_b128 a[20:23], v34 offset:18432
    v_mfma_f32_16x16x32_bf16 v[120:123], a[88:91], a[44:47], v[120:123]
    ds_read_b128 a[24:27], v35 offset:18432
    v_mfma_f32_16x16x32_bf16 v[128:131], a[88:91], a[48:51], v[128:131]
    s_waitcnt lgkmcnt(5)
    s_nop 0
    v_mfma_f32_16x16x32_bf16 v[112:115], a[92:95], a[60:63], v[112:115]
    ds_read_b128 a[36:39], v32 offset:19456
    ds_read_b128 a[52:55], v27 offset:64512
    v_mfma_f32_16x16x32_bf16 v[132:135], a[76:79], a[60:63], v[132:135]
    v_mfma_f32_16x16x32_bf16 v[116:119], a[92:95], a[64:67], v[116:119]
    ds_read_b128 a[40:43], v33 offset:19456
    ds_read_b128 a[44:47], v34 offset:19456
    v_mfma_f32_16x16x32_bf16 v[120:123], a[92:95], a[68:71], v[120:123]
    ds_read_b128 a[48:51], v35 offset:19456
    v_mfma_f32_16x16x32_bf16 v[128:131], a[92:95], a[72:75], v[128:131]
    s_waitcnt vmcnt(8)
    s_waitcnt lgkmcnt(0)
    s_barrier
    s_nop 0
    v_mfma_f32_16x16x32_bf16 v[112:115], a[96:99], a[12:15], v[112:115]
    ds_read_b128 a[60:63], v32 offset:32768
    ds_read_b128 a[76:79], v27 offset:57344
    v_mfma_f32_16x16x32_bf16 v[132:135], a[28:31], a[12:15], v[132:135]
    v_mfma_f32_16x16x32_bf16 v[116:119], a[96:99], a[16:19], v[116:119]
    ds_read_b128 a[64:67], v33 offset:32768
    ds_read_b128 a[68:71], v34 offset:32768
    v_mfma_f32_16x16x32_bf16 v[120:123], a[96:99], a[20:23], v[120:123]
    ds_read_b128 a[72:75], v35 offset:32768
    v_mfma_f32_16x16x32_bf16 v[128:131], a[96:99], a[24:27], v[128:131]
    v_mfma_f32_16x16x32_bf16 v[112:115], a[100:103], a[36:39], v[112:115]
    ds_read_b128 a[12:15], v32 offset:33792
    ds_read_b128 a[28:31], v27 offset:58368
    v_mfma_f32_16x16x32_bf16 v[132:135], a[52:55], a[36:39], v[132:135]
    v_mfma_f32_16x16x32_bf16 v[116:119], a[100:103], a[40:43], v[116:119]
    ds_read_b128 a[16:19], v33 offset:33792
    ds_read_b128 a[20:23], v34 offset:33792
    v_mfma_f32_16x16x32_bf16 v[120:123], a[100:103], a[44:47], v[120:123]
    ds_read_b128 a[24:27], v35 offset:33792
    v_mfma_f32_16x16x32_bf16 v[128:131], a[100:103], a[48:51], v[128:131]
    s_waitcnt lgkmcnt(5)
    s_nop 0
    v_mfma_f32_16x16x32_bf16 v[112:115], a[104:107], a[60:63], v[112:115]
    ds_read_b128 a[36:39], v32 offset:34816
    ds_read_b128 a[52:55], v27 offset:59392
    v_mfma_f32_16x16x32_bf16 v[132:135], a[76:79], a[60:63], v[132:135]
    v_mfma_f32_16x16x32_bf16 v[116:119], a[104:107], a[64:67], v[116:119]
    ds_read_b128 a[40:43], v33 offset:34816
    ds_read_b128 a[44:47], v34 offset:34816
    v_mfma_f32_16x16x32_bf16 v[120:123], a[104:107], a[68:71], v[120:123]
    ds_read_b128 a[48:51], v35 offset:34816
    v_mfma_f32_16x16x32_bf16 v[128:131], a[104:107], a[72:75], v[128:131]
    s_waitcnt lgkmcnt(5)
    s_nop 0
    v_mfma_f32_16x16x32_bf16 v[112:115], a[128:131], a[12:15], v[112:115]
    ds_read_b128 a[60:63], v32 offset:35840
    ds_read_b128 a[76:79], v27 offset:60416
    v_mfma_f32_16x16x32_bf16 v[132:135], a[28:31], a[12:15], v[132:135]
    v_mfma_f32_16x16x32_bf16 v[116:119], a[128:131], a[16:19], v[116:119]
    ds_read_b128 a[64:67], v33 offset:35840
    ds_read_b128 a[68:71], v34 offset:35840
    v_mfma_f32_16x16x32_bf16 v[120:123], a[128:131], a[20:23], v[120:123]
    ds_read_b128 a[72:75], v35 offset:35840
    v_mfma_f32_16x16x32_bf16 v[128:131], a[128:131], a[24:27], v[128:131]
    s_waitcnt vmcnt(4)
    s_waitcnt lgkmcnt(0)
    s_barrier
    s_nop 0
    v_mfma_f32_16x16x32_bf16 v[112:115], a[132:135], a[36:39], v[112:115]
    ds_read_b128 a[12:15], v32 offset:49152
    ds_read_b128 a[28:31], v27 offset:53248
    v_mfma_f32_16x16x32_bf16 v[132:135], a[52:55], a[36:39], v[132:135]
    v_mfma_f32_16x16x32_bf16 v[116:119], a[132:135], a[40:43], v[116:119]
    ds_read_b128 a[16:19], v33 offset:49152
    ds_read_b128 a[20:23], v34 offset:49152
    v_mfma_f32_16x16x32_bf16 v[120:123], a[132:135], a[44:47], v[120:123]
    ds_read_b128 a[24:27], v35 offset:49152
    v_mfma_f32_16x16x32_bf16 v[128:131], a[132:135], a[48:51], v[128:131]
    v_mfma_f32_16x16x32_bf16 v[112:115], a[108:111], a[60:63], v[112:115]
    ds_read_b128 a[36:39], v32 offset:50176
    ds_read_b128 a[52:55], v27 offset:54272
    v_mfma_f32_16x16x32_bf16 v[132:135], a[76:79], a[60:63], v[132:135]
    v_mfma_f32_16x16x32_bf16 v[116:119], a[108:111], a[64:67], v[116:119]
    ds_read_b128 a[40:43], v33 offset:50176
    ds_read_b128 a[44:47], v34 offset:50176
    v_mfma_f32_16x16x32_bf16 v[120:123], a[108:111], a[68:71], v[120:123]
    ds_read_b128 a[48:51], v35 offset:50176
    v_mfma_f32_16x16x32_bf16 v[128:131], a[108:111], a[72:75], v[128:131]
    s_waitcnt lgkmcnt(5)
    s_nop 0
    v_mfma_f32_16x16x32_bf16 v[112:115], a[136:139], a[12:15], v[112:115]
    ds_read_b128 a[60:63], v32 offset:51200
    ds_read_b128 a[76:79], v27 offset:55296
    v_mfma_f32_16x16x32_bf16 v[132:135], a[28:31], a[12:15], v[132:135]
    v_mfma_f32_16x16x32_bf16 v[116:119], a[136:139], a[16:19], v[116:119]
    ds_read_b128 a[64:67], v33 offset:51200
    ds_read_b128 a[68:71], v34 offset:51200
    v_mfma_f32_16x16x32_bf16 v[120:123], a[136:139], a[20:23], v[120:123]
    ds_read_b128 a[72:75], v35 offset:51200
    v_mfma_f32_16x16x32_bf16 v[128:131], a[136:139], a[24:27], v[128:131]
    s_waitcnt lgkmcnt(5)
    s_nop 0
    v_mfma_f32_16x16x32_bf16 v[112:115], a[140:143], a[36:39], v[112:115]
    ds_read_b128 a[12:15], v32 offset:52224
    ds_read_b128 a[28:31], v27 offset:56320
    v_mfma_f32_16x16x32_bf16 v[132:135], a[52:55], a[36:39], v[132:135]
    v_mfma_f32_16x16x32_bf16 v[116:119], a[140:143], a[40:43], v[116:119]
    ds_read_b128 a[16:19], v33 offset:52224
    ds_read_b128 a[20:23], v34 offset:52224
    v_mfma_f32_16x16x32_bf16 v[120:123], a[140:143], a[44:47], v[120:123]
    ds_read_b128 a[24:27], v35 offset:52224
    v_mfma_f32_16x16x32_bf16 v[128:131], a[140:143], a[48:51], v[128:131]
    s_waitcnt vmcnt(0)
    s_waitcnt lgkmcnt(0)
    s_barrier
    s_nop 0
    v_add_u32 v32, 65536, v28
    v_add_u32 v33, 65536, v29
    v_add_u32 v34, 65536, v30
    v_add_u32 v35, 65536, v31
    v_mfma_f32_16x16x32_bf16 v[112:115], a[144:147], a[60:63], v[112:115]
    ds_read_b128 a[36:39], v32 offset:0
    ds_read_b128 a[52:55], v27 offset:49152
    v_mfma_f32_16x16x32_bf16 v[132:135], a[76:79], a[60:63], v[132:135]
    v_mfma_f32_16x16x32_bf16 v[116:119], a[144:147], a[64:67], v[116:119]
    ds_read_b128 a[40:43], v33 offset:0
    ds_read_b128 a[44:47], v34 offset:0
    v_mfma_f32_16x16x32_bf16 v[120:123], a[144:147], a[68:71], v[120:123]
    ds_read_b128 a[48:51], v35 offset:0
    v_mfma_f32_16x16x32_bf16 v[128:131], a[144:147], a[72:75], v[128:131]
    v_mfma_f32_16x16x32_bf16 v[112:115], a[148:151], a[12:15], v[112:115]
    ds_read_b128 a[60:63], v32 offset:1024
    ds_read_b128 a[76:79], v27 offset:50176
    v_mfma_f32_16x16x32_bf16 v[132:135], a[28:31], a[12:15], v[132:135]
    v_mfma_f32_16x16x32_bf16 v[116:119], a[148:151], a[16:19], v[116:119]
    ds_read_b128 a[64:67], v33 offset:1024
    ds_read_b128 a[68:71], v34 offset:1024
    v_mfma_f32_16x16x32_bf16 v[120:123], a[148:151], a[20:23], v[120:123]
    ds_read_b128 a[72:75], v35 offset:1024
    v_mfma_f32_16x16x32_bf16 v[128:131], a[148:151], a[24:27], v[128:131]
    s_waitcnt lgkmcnt(5)
    s_nop 0
    v_mfma_f32_16x16x32_bf16 v[112:115], a[84:87], a[36:39], v[112:115]
    ds_read_b128 a[12:15], v32 offset:2048
    ds_read_b128 a[28:31], v27 offset:51200
    v_mfma_f32_16x16x32_bf16 v[132:135], a[52:55], a[36:39], v[132:135]
    v_mfma_f32_16x16x32_bf16 v[116:119], a[84:87], a[40:43], v[116:119]
    ds_read_b128 a[16:19], v33 offset:2048
    ds_read_b128 a[20:23], v34 offset:2048
    v_mfma_f32_16x16x32_bf16 v[120:123], a[84:87], a[44:47], v[120:123]
    ds_read_b128 a[24:27], v35 offset:2048
    v_mfma_f32_16x16x32_bf16 v[128:131], a[84:87], a[48:51], v[128:131]
    s_waitcnt lgkmcnt(5)
    s_nop 0
    v_mfma_f32_16x16x32_bf16 v[112:115], a[152:155], a[60:63], v[112:115]
    ds_read_b128 a[36:39], v32 offset:3072
    ds_read_b128 a[52:55], v27 offset:52224
    v_mfma_f32_16x16x32_bf16 v[132:135], a[76:79], a[60:63], v[132:135]
    v_mfma_f32_16x16x32_bf16 v[116:119], a[152:155], a[64:67], v[116:119]
    ds_read_b128 a[40:43], v33 offset:3072
    ds_read_b128 a[44:47], v34 offset:3072
    v_mfma_f32_16x16x32_bf16 v[120:123], a[152:155], a[68:71], v[120:123]
    ds_read_b128 a[48:51], v35 offset:3072
    v_mfma_f32_16x16x32_bf16 v[128:131], a[152:155], a[72:75], v[128:131]
    s_waitcnt lgkmcnt(5)
    v_mfma_f32_16x16x32_bf16 v[112:115], a[156:159], a[12:15], v[112:115]
    v_mfma_f32_16x16x32_bf16 v[132:135], a[28:31], a[12:15], v[132:135]
    v_mfma_f32_16x16x32_bf16 v[116:119], a[156:159], a[16:19], v[116:119]
    v_mfma_f32_16x16x32_bf16 v[120:123], a[156:159], a[20:23], v[120:123]
    v_mfma_f32_16x16x32_bf16 v[128:131], a[156:159], a[24:27], v[128:131]
    s_waitcnt lgkmcnt(0)
    v_mfma_f32_16x16x32_bf16 v[112:115], a[160:163], a[36:39], v[112:115]
    v_mfma_f32_16x16x32_bf16 v[132:135], a[52:55], a[36:39], v[132:135]
    v_mfma_f32_16x16x32_bf16 v[116:119], a[160:163], a[40:43], v[116:119]
    v_mfma_f32_16x16x32_bf16 v[120:123], a[160:163], a[44:47], v[120:123]
    v_mfma_f32_16x16x32_bf16 v[128:131], a[160:163], a[48:51], v[128:131]
    v_add_f32_e64 v40, v40, v68
    v_add_f32_e64 v41, v41, v69
    v_mul_f32_e64 v40, v40, v57
    v_mul_f32_e64 v41, v41, v57
    v_fma_f32 v40, v112, v56, v40
    v_fma_f32 v41, v113, v56, v41
    v_add_f32_e64 v42, v42, v70
    v_add_f32_e64 v43, v43, v71
    v_mul_f32_e64 v42, v42, v57
    v_mul_f32_e64 v43, v43, v57
    v_fma_f32 v42, v114, v56, v42
    v_fma_f32 v43, v115, v56, v43
    v_cvt_pk_bf16_f32 v68, v40, v41
    v_cvt_pk_bf16_f32 v69, v42, v43
    ds_write_b64 v100, v[68:69]
    v_pk_add_f32 v[44:45], v[44:45], v[72:73]
    v_pk_mul_f32 v[44:45], v[44:45], v[58:59] op_sel:[0,1] op_sel_hi:[1,1]
    v_pk_fma_f32 v[44:45], v[116:117], v[58:59], v[44:45] op_sel_hi:[1,0,1]
    v_pk_add_f32 v[46:47], v[46:47], v[74:75]
    v_pk_mul_f32 v[46:47], v[46:47], v[58:59] op_sel:[0,1] op_sel_hi:[1,1]
    v_pk_fma_f32 v[46:47], v[118:119], v[58:59], v[46:47] op_sel_hi:[1,0,1]
    v_cvt_pk_bf16_f32 v72, v44, v45
    v_cvt_pk_bf16_f32 v73, v46, v47
    ds_write_b64 v101, v[72:73]
    v_pk_add_f32 v[48:49], v[48:49], v[80:81]
    v_pk_mul_f32 v[48:49], v[48:49], v[60:61] op_sel:[0,1] op_sel_hi:[1,1]
    v_pk_fma_f32 v[48:49], v[120:121], v[60:61], v[48:49] op_sel_hi:[1,0,1]
    v_pk_add_f32 v[50:51], v[50:51], v[82:83]
    v_pk_mul_f32 v[50:51], v[50:51], v[60:61] op_sel:[0,1] op_sel_hi:[1,1]
    v_pk_fma_f32 v[50:51], v[122:123], v[60:61], v[50:51] op_sel_hi:[1,0,1]
    v_cvt_pk_bf16_f32 v80, v48, v49
    v_cvt_pk_bf16_f32 v81, v50, v51
    ds_write_b64 v102, v[80:81]
    v_pk_add_f32 v[52:53], v[52:53], v[92:93]
    v_pk_mul_f32 v[52:53], v[52:53], v[62:63] op_sel:[0,1] op_sel_hi:[1,1]
    v_pk_fma_f32 v[52:53], v[128:129], v[62:63], v[52:53] op_sel_hi:[1,0,1]
    v_pk_add_f32 v[54:55], v[54:55], v[94:95]
    v_pk_mul_f32 v[54:55], v[54:55], v[62:63] op_sel:[0,1] op_sel_hi:[1,1]
    v_pk_fma_f32 v[54:55], v[130:131], v[62:63], v[54:55] op_sel_hi:[1,0,1]
    v_cvt_pk_bf16_f32 v92, v52, v53
    v_cvt_pk_bf16_f32 v93, v54, v55
    ds_write_b64 v103, v[92:93]
    v_pk_add_f32 v[108:109], v[108:109], v[96:97]
    v_pk_mul_f32 v[108:109], v[108:109], v[56:57] op_sel:[0,1] op_sel_hi:[1,1]
    v_pk_fma_f32 v[108:109], v[132:133], v[56:57], v[108:109] op_sel_hi:[1,0,1]
    v_pk_add_f32 v[110:111], v[110:111], v[98:99]
    v_pk_mul_f32 v[110:111], v[110:111], v[56:57] op_sel:[0,1] op_sel_hi:[1,1]
    v_pk_fma_f32 v[110:111], v[134:135], v[56:57], v[110:111] op_sel_hi:[1,0,1]
    v_cvt_pk_bf16_f32 v96, v108, v109
    v_cvt_pk_bf16_f32 v97, v110, v111
    ds_write_b64 v105, v[96:97]
    s_waitcnt lgkmcnt(0)
    s_barrier
    ds_read_b128 v[112:115], v106 offset:0
    ds_read_b128 v[116:119], v106 offset:1024
    ds_read_b128 v[120:123], v106 offset:2048
    s_waitcnt lgkmcnt(2)
    buffer_store_dwordx4 v[112:115], v107, s[4:7], s8 offen sc0 sc1
    s_waitcnt lgkmcnt(1)
    buffer_store_dwordx4 v[116:119], v124, s[4:7], s8 offen sc0 sc1
    s_waitcnt lgkmcnt(0)
    s_mov_b32 exec_lo, 0xffffffff
    s_mov_b32 exec_hi, 0x0
    buffer_store_dwordx4 v[120:123], v125, s[4:7], s8 offen sc0 sc1
    s_mov_b64 exec, -1
    s_cmp_eq_u32 s2, 0
    s_cselect_b32 s48, s60, 1073741824
    s_mov_b64 exec, 1
    buffer_store_dword v23, v24, s[12:15], s48 offen sc1
    s_mov_b64 exec, -1
Lend:
    s_endpgm
Lslow1:
    s_mov_b32 s70, 100000
Lloop3:
    s_sleep 1
    buffer_load_dword v104, v3, s[12:15], s18 offen offset:0 sc1
    buffer_load_dword v105, v3, s[12:15], s18 offen offset:1024 sc1
    s_waitcnt vmcnt(0)
    v_cmp_ne_u32 vcc, s47, v104
    v_cmp_ne_u32 s[64:65], s47, v105
    s_nop 1
    s_or_b64 vcc, vcc, s[64:65]
    s_nop 1
    s_cbranch_vccz Lback2
    s_sub_u32 s70, s70, 1
    s_cmp_lg_u32 s70, 0
    s_cbranch_scc1 Lloop3
    s_branch Lback2
Lslow4:
    s_mov_b32 s70, 100000
Lloop6:
    s_sleep 1
    buffer_load_dword v16, v3, s[12:15], s24 offen offset:0 sc1
    buffer_load_dword v17, v3, s[12:15], s24 offen offset:1024 sc1
    s_waitcnt vmcnt(0)
    v_cmp_ne_u32 vcc, s47, v16
    v_cmp_ne_u32 s[64:65], s47, v17
    s_nop 1
    s_or_b64 vcc, vcc, s[64:65]
    s_nop 1
    s_cbranch_vccz Lback5
    s_sub_u32 s70, s70, 1
    s_cmp_lg_u32 s70, 0
    s_cbranch_scc1 Lloop6
    s_branch Lback5
Lslow7:
    s_mov_b32 s70, 100000
Lloop9:
    s_sleep 1
    buffer_load_dword v6, v7, s[12:15], s8 offen offset:0 sc1
    s_waitcnt vmcnt(0)
    v_cmp_ne_u32 vcc, s47, v6
    s_nop 1
    s_cbranch_vccz Lback8
    s_sub_u32 s70, s70, 1
    s_cmp_lg_u32 s70, 0
    s_cbranch_scc1 Lloop9
    s_branch Lback8
Lslow10:
    s_mov_b32 s70, 100000
Lloop12:
    s_sleep 1
    buffer_load_dword v16, v3, s[12:15], s10 offen offset:0 sc1
    buffer_load_dword v17, v3, s[12:15], s10 offen offset:1024 sc1
    s_waitcnt vmcnt(0)
    v_cmp_ne_u32 vcc, s47, v16
    v_cmp_ne_u32 s[64:65], s47, v17
    s_nop 1
    s_or_b64 vcc, vcc, s[64:65]
    s_nop 1
    s_cbranch_vccz Lback11
    s_sub_u32 s70, s70, 1
    s_cmp_lg_u32 s70, 0
    s_cbranch_scc1 Lloop12
    s_branch Lback11
Lslow13:
    s_mov_b32 s70, 100000
Lloop15:
    s_sleep 1
    buffer_load_dword v16, v7, s[12:15], s8 offen offset:0 sc1
    s_waitcnt vmcnt(0)
    v_cmp_ne_u32 vcc, s47, v16
    s_nop 1
    s_cbranch_vccz Lback14
    s_sub_u32 s70, s70, 1
    s_cmp_lg_u32 s70, 0
    s_cbranch_scc1 Lloop15
    s_branch Lback14
Lslow16:
    s_mov_b32 s70, 100000
Lloop18:
    s_sleep 1
    buffer_load_dword v6, v19, s[12:15], s8 offen offset:0 sc1
    s_waitcnt vmcnt(0)
    v_cmp_ne_u32 vcc, s47, v6
    s_nop 1
    s_cbranch_vccz Lback17
    s_sub_u32 s70, s70, 1
    s_cmp_lg_u32 s70, 0
    s_cbranch_scc1 Lloop18
    s_branch Lback17
Lslow19:
    s_mov_b32 s70, 100000
Lloop21:
    s_sleep 1
    buffer_load_dword v6, v19, s[12:15], s8 offen offset:0 sc1
    s_waitcnt vmcnt(0)
    v_cmp_ne_u32 vcc, s47, v6
    s_nop 1
    s_cbranch_vccz Lback20
    s_sub_u32 s70, s70, 1
    s_cmp_lg_u32 s70, 0
    s_cbranch_scc1 Lloop21
    s_branch Lback20
Lslow22:
    s_mov_b32 s70, 100000
Lloop24:
    s_sleep 1
    buffer_load_dword v18, v7, s[12:15], s9 offen offset:0 sc1
    s_waitcnt vmcnt(0)
    v_cmp_ne_u32 vcc, s47, v18
    s_nop 1
    s_cbranch_vccz Lback23
    s_sub_u32 s70, s70, 1
    s_cmp_lg_u32 s70, 0
    s_cbranch_scc1 Lloop24
    s_branch Lback23
Lslow25:
    s_mov_b32 s70, 100000
Lloop27:
    s_sleep 1
    buffer_load_dword v6, v7, s[12:15], s10 offen offset:0 sc1
    s_waitcnt vmcnt(0)
    v_cmp_ne_u32 vcc, s47, v6
    s_nop 1
    s_cbranch_vccz Lback26
    s_sub_u32 s70, s70, 1
    s_cmp_lg_u32 s70, 0
    s_cbranch_scc1 Lloop27
    s_branch Lback26
Lslow28:
    s_mov_b32 s70, 100000
Lloop30:
    s_sleep 1
    buffer_load_dword v6, v7, s[12:15], s8 offen offset:0 sc1
    s_waitcnt vmcnt(0)
    v_cmp_ne_u32 vcc, s47, v6
    s_nop 1
    s_cbranch_vccz Lback29
    s_sub_u32 s70, s70, 1
    s_cmp_lg_u32 s70, 0
    s_cbranch_scc1 Lloop30
    s_branch Lback29
Lslow31:
    s_mov_b32 s70, 100000
Lloop33:
    s_sleep 1
    buffer_load_dword v6, v7, s[12:15], s8 offen offset:0 sc1
    s_waitcnt vmcnt(0)
    v_cmp_ne_u32 vcc, s47, v6
    s_nop 1
    s_cbranch_vccz Lback32
    s_sub_u32 s70, s70, 1
    s_cmp_lg_u32 s70, 0
    s_cbranch_scc1 Lloop33
    s_branch Lback32
    s_endpgm
.section .rodata,"a"
.p2align 6
.amdhsa_kernel gated_mix__linear_kernel_hedgehog__mixer_s_mlp__prompt_kernel
  .amdhsa_next_free_vgpr 512
  .amdhsa_next_free_sgpr 102
  .amdhsa_accum_offset 256
  .amdhsa_group_segment_fixed_size 0
  .amdhsa_kernarg_size 104
  .amdhsa_user_sgpr_count 2
  .amdhsa_user_sgpr_kernarg_segment_ptr 1
  .amdhsa_system_sgpr_workgroup_id_x 1
.end_amdhsa_kernel
```
